```python
import torch

def _softmax(x, axis=-1):
    return torch.softmax(x, dim=axis)
def _gelu(x):
    return torch.nn.functional.gelu(x, approximate="tanh")
def _silu(x):
    return torch.nn.functional.silu(x)
def _sigmoid(x):
    return torch.sigmoid(x)
def _layernorm(x, axis=-1, eps=1e-5):
    m = x.mean(dim=axis, keepdim=True)
    v = x.var(dim=axis, keepdim=True, unbiased=False)
    return (x - m) / torch.sqrt(v + eps)
def _scatter_add(tgt, idx, src, axis=0):
    return tgt.clone().index_add_(axis, idx, src)
def _segment_sum(src, seg, n):
    out = torch.zeros((n,) + src.shape[1:], dtype=src.dtype)
    return out.index_add_(0, seg, src)
def _pad(x, pw):
    flat = tuple(v for pair in reversed(pw) for v in pair)
    return torch.nn.functional.pad(x, flat)

kernel_name = 'standalone__modern_conv_block_replknet__vision'

def setup_inputs():

    _w = (lambda a: (lambda t: t.to(torch.bfloat16) if t.is_floating_point() else t)(torch.as_tensor(a)))
    H = W = 512
    C = 96
    K = 1
    return {
        "x": _w((lambda *s: torch.randn(*s, dtype=torch.bfloat16) * 0.05)(1, H, W, C)),
        "dw_large": _w((lambda *s: torch.randn(*s, dtype=torch.bfloat16) * 0.4)(K, K, C) * (1.0 / K)),
        "dw_small": _w((lambda *s: torch.randn(*s, dtype=torch.bfloat16) * 0.4)(5, 5, C) * 0.2),
        "w1": _w((lambda *s: torch.randn(*s, dtype=torch.bfloat16) * 0.4)(C, 4 * C) * (C ** -0.5)),
        "w2": _w((lambda *s: torch.randn(*s, dtype=torch.bfloat16) * 0.1)(4 * C, C) * ((4 * C) ** -0.5)),
    }

def reference(x, dw_large, dw_small, w1, w2):
    B, H, W, C = x.shape
    Kl = dw_large.shape[0]
    pl = (Kl - 1) // 2
    xpl = _pad(x, ((0,0),(pl,pl),(pl,pl),(0,0)))
    out = torch.zeros_like(x)
    for i in range(Kl):
        for j in range(Kl):
            out = out + xpl[:, i:i+H, j:j+W, :] * dw_large[i, j][None, None, None, :]
    Ks = dw_small.shape[0]
    ps = (Ks - 1) // 2
    xps = _pad(x, ((0,0),(ps,ps),(ps,ps),(0,0)))
    for i in range(Ks):
        for j in range(Ks):
            out = out + xps[:, i:i+H, j:j+W, :] * dw_small[i, j][None, None, None, :]
    h = _layernorm(out, axis=-1)
    h = _gelu(torch.einsum('bhwc,ce->bhwe', h, w1))
    h = torch.einsum('bhwe,ec->bhwc', h, w2)
    return x + h
```

```asm
; @launch grid=(256,1,1) block=(512,1,1) lds=163520
.amdgcn_target "amdgcn-amd-amdhsa--gfx950"
.text
.globl standalone__modern_conv_block_replknet__vision_kernel
.p2align 8
.type standalone__modern_conv_block_replknet__vision_kernel,@function
standalone__modern_conv_block_replknet__vision_kernel:
    s_cmp_ge_u32 s2, 256
    s_cbranch_scc1 Lend
    s_load_dwordx8 s[4:11], s[0:1], 0
    s_load_dwordx4 s[12:15], s[0:1], 32
    s_load_dwordx4 s[56:59], s[0:1], 48
    v_lshrrev_b32 v16, 6, v0
    v_and_b32 v17, 63, v0
    v_readfirstlane_b32 s71, v16
    s_getpc_b64 s[60:61]
    v_lshlrev_b32 v38, 6, v0
    v_min_u32 v38, 32192, v38
    global_load_dword v39, v38, s[60:61]
    s_and_b32 s72, s2, 7
    s_lshl_b32 s72, s72, 5
    s_lshr_b32 s73, s2, 3
    s_add_u32 s72, s72, s73
    s_lshr_b32 s39, s72, 4
    s_and_b32 s38, s72, 15
    s_lshr_b32 s36, s71, 2
    s_and_b32 s37, s71, 3
    s_mov_b32 s64, s71
    s_mul_i32 s88, s37, 3072
    s_movk_i32 s89, 1024
    s_mov_b32 s80, -1
    s_mov_b32 s81, 0xffff
    v_lshlrev_b32 v14, 4, v17
    s_cmp_eq_u32 s38, 0
    s_cselect_b32 s70, 0, 384
    s_cselect_b32 s74, 384, 0
    s_cselect_b32 s75, 24, 0
    v_subrev_u32 v12, s74, v14
    v_cmp_le_u32 vcc, s75, v17
    s_nop 1
    v_cndmask_b32 v12, 2.0, v12, vcc
    s_cmp_eq_u32 s38, 15
    s_cselect_b32 s75, 24, 64
    v_cmp_gt_u32 vcc, s75, v17
    s_nop 1
    v_cndmask_b32 v13, 2.0, v14, vcc
    v_mul_u32_u24 v18, 683, v0
    v_lshrrev_b32 v18, 16, v18
    v_mul_u32_u24 v19, 96, v18
    v_sub_u32 v19, v0, v19
    v_mul_u32_u24 v20, 960, v18
    v_lshl_add_u32 v20, v19, 1, v20
    v_lshlrev_b32 v21, 1, v19
    s_lshl_b32 s71, s39, 5
    s_add_u32 s71, s71, s64
    s_sub_u32 s71, s71, 2
    s_mul_i32 s85, s71, 98304
    s_mul_i32 s72, s38, 6144
    s_add_u32 s85, s85, s72
    s_cmp_lt_u32 s71, 512
    s_cselect_b32 s85, s85, 0x80000000
    s_cmp_ge_u32 s64, 24
    s_cselect_b32 s72, 24, 0
    s_sub_u32 s71, s64, s72
    s_cmp_ge_u32 s71, 12
    s_cselect_b32 s72, 12, 0
    s_sub_u32 s71, s71, s72
    s_and_b32 s72, s64, 4
    s_lshl_b32 s72, s72, 1
    s_mul_i32 s71, s71, 7104
    s_add_u32 s71, s71, s72
    s_add_u32 s86, s71, 78272
    s_waitcnt lgkmcnt(0)
    s_mov_b32 s16, s4
    s_and_b32 s17, s5, 0xffff
    s_mov_b32 s18, 50331648
    s_mov_b32 s19, 0x20000
    s_mov_b32 s28, s8
    s_and_b32 s29, s9, 0xffff
    s_mov_b32 s30, 4800
    s_mov_b32 s31, 0x20000
    s_mov_b32 s32, s6
    s_and_b32 s33, s7, 0xffff
    s_mov_b32 s34, 192
    s_mov_b32 s35, 0x20000
    s_mov_b32 s20, s14
    s_and_b32 s21, s15, 0xffff
    s_mov_b32 s22, 0
    s_mov_b32 s23, 0x20000
    buffer_load_ushort v24, v20, s[28:31], 0 offen offset:0
    buffer_load_ushort v25, v20, s[28:31], 0 offen offset:192
    buffer_load_ushort v26, v20, s[28:31], 0 offen offset:384
    buffer_load_ushort v27, v20, s[28:31], 0 offen offset:576
    buffer_load_ushort v28, v20, s[28:31], 0 offen offset:768
    buffer_load_ushort v29, v21, s[32:35], 0 offen
    s_mov_b64 s[4:5], s[56:57]
    s_mov_b64 s[6:7], s[58:59]
    s_cmp_eq_u32 s64, 3
    s_cselect_b32 s62, s2, 36
    v_mov_b32 v48, 0
    v_lshlrev_b32 v49, 2, v17
    s_cmp_lt_u32 s62, 36
    s_cbranch_scc0 Lprep_noload
    s_mul_i32 s73, s62, 21846
    s_lshr_b32 s73, s73, 16
    s_mul_i32 s74, s73, 3
    s_sub_u32 s77, s62, s74
    s_mov_b32 s28, s10
    s_and_b32 s29, s11, 0xffff
    s_mov_b32 s30, 73728
    s_mov_b32 s31, 0x20000
    s_mov_b32 s32, s12
    s_and_b32 s33, s13, 0xffff
    s_mov_b32 s34, 73728
    s_mov_b32 s35, 0x20000
    s_add_u32 s74, s73, 1
    s_cmp_eq_u32 s74, 12
    s_cselect_b32 s74, 0, s74
    s_lshl_b32 s74, s74, 6
    s_mul_i32 s75, s73, 6144
    v_lshrrev_b32 v50, 5, v17
    v_and_b32 v51, 31, v17
    v_mul_u32_u24 v52, 6144, v50
    v_lshl_add_u32 v52, v51, 1, v52
    v_add_u32 v53, 3072, v52
    v_mul_u32_u24 v54, 768, v50
    v_and_b32 v50, 19, v51
    v_lshl_add_u32 v54, v50, 1, v54
    v_and_b32 v50, 4, v51
    v_lshl_add_u32 v54, v50, 2, v54
    v_and_b32 v50, 8, v51
    v_add_u32 v54, v54, v50
    s_mov_b32 s60, s77
    s_cmp_eq_u32 s77, 0
    s_cbranch_scc0 Lprep_t1
    s_add_u32 s76, s74, 0
    buffer_load_ushort v64, v52, s[28:31], s76 offen offset:0
    buffer_load_ushort v65, v52, s[28:31], s76 offen offset:768
    buffer_load_ushort v66, v52, s[28:31], s76 offen offset:1536
    buffer_load_ushort v67, v52, s[28:31], s76 offen offset:2304
    buffer_load_ushort v68, v53, s[28:31], s76 offen offset:0
    buffer_load_ushort v69, v53, s[28:31], s76 offen offset:768
    buffer_load_ushort v70, v53, s[28:31], s76 offen offset:1536
    buffer_load_ushort v71, v53, s[28:31], s76 offen offset:2304
    s_add_u32 s76, s74, 12288
    buffer_load_ushort v72, v52, s[28:31], s76 offen offset:0
    buffer_load_ushort v73, v52, s[28:31], s76 offen offset:768
    buffer_load_ushort v74, v52, s[28:31], s76 offen offset:1536
    buffer_load_ushort v75, v52, s[28:31], s76 offen offset:2304
    buffer_load_ushort v76, v53, s[28:31], s76 offen offset:0
    buffer_load_ushort v77, v53, s[28:31], s76 offen offset:768
    buffer_load_ushort v78, v53, s[28:31], s76 offen offset:1536
    buffer_load_ushort v79, v53, s[28:31], s76 offen offset:2304
    s_add_u32 s76, s74, 24576
    buffer_load_ushort v80, v52, s[28:31], s76 offen offset:0
    buffer_load_ushort v81, v52, s[28:31], s76 offen offset:768
    buffer_load_ushort v82, v52, s[28:31], s76 offen offset:1536
    buffer_load_ushort v83, v52, s[28:31], s76 offen offset:2304
    buffer_load_ushort v84, v53, s[28:31], s76 offen offset:0
    buffer_load_ushort v85, v53, s[28:31], s76 offen offset:768
    buffer_load_ushort v86, v53, s[28:31], s76 offen offset:1536
    buffer_load_ushort v87, v53, s[28:31], s76 offen offset:2304
    s_add_u32 s76, s74, 36864
    buffer_load_ushort v88, v52, s[28:31], s76 offen offset:0
    buffer_load_ushort v89, v52, s[28:31], s76 offen offset:768
    buffer_load_ushort v90, v52, s[28:31], s76 offen offset:1536
    buffer_load_ushort v91, v52, s[28:31], s76 offen offset:2304
    buffer_load_ushort v92, v53, s[28:31], s76 offen offset:0
    buffer_load_ushort v93, v53, s[28:31], s76 offen offset:768
    buffer_load_ushort v94, v53, s[28:31], s76 offen offset:1536
    buffer_load_ushort v95, v53, s[28:31], s76 offen offset:2304
    s_branch Lprep_noload
Lprep_t1:
    s_cmp_eq_u32 s77, 1
    s_cbranch_scc0 Lprep_t2
    s_add_u32 s76, s74, 49152
    buffer_load_ushort v64, v52, s[28:31], s76 offen offset:0
    buffer_load_ushort v65, v52, s[28:31], s76 offen offset:768
    buffer_load_ushort v66, v52, s[28:31], s76 offen offset:1536
    buffer_load_ushort v67, v52, s[28:31], s76 offen offset:2304
    buffer_load_ushort v68, v53, s[28:31], s76 offen offset:0
    buffer_load_ushort v69, v53, s[28:31], s76 offen offset:768
    buffer_load_ushort v70, v53, s[28:31], s76 offen offset:1536
    buffer_load_ushort v71, v53, s[28:31], s76 offen offset:2304
    s_add_u32 s76, s74, 61440
    buffer_load_ushort v72, v52, s[28:31], s76 offen offset:0
    buffer_load_ushort v73, v52, s[28:31], s76 offen offset:768
    buffer_load_ushort v74, v52, s[28:31], s76 offen offset:1536
    buffer_load_ushort v75, v52, s[28:31], s76 offen offset:2304
    buffer_load_ushort v76, v53, s[28:31], s76 offen offset:0
    buffer_load_ushort v77, v53, s[28:31], s76 offen offset:768
    buffer_load_ushort v78, v53, s[28:31], s76 offen offset:1536
    buffer_load_ushort v79, v53, s[28:31], s76 offen offset:2304
    s_add_u32 s76, s75, 0
    buffer_load_ushort v80, v54, s[32:35], s76 offen offset:0
    buffer_load_ushort v81, v54, s[32:35], s76 offen offset:192
    buffer_load_ushort v82, v54, s[32:35], s76 offen offset:384
    buffer_load_ushort v83, v54, s[32:35], s76 offen offset:576
    buffer_load_ushort v84, v54, s[32:35], s76 offen offset:1536
    buffer_load_ushort v85, v54, s[32:35], s76 offen offset:1728
    buffer_load_ushort v86, v54, s[32:35], s76 offen offset:1920
    buffer_load_ushort v87, v54, s[32:35], s76 offen offset:2112
    s_add_u32 s76, s75, 64
    buffer_load_ushort v88, v54, s[32:35], s76 offen offset:0
    buffer_load_ushort v89, v54, s[32:35], s76 offen offset:192
    buffer_load_ushort v90, v54, s[32:35], s76 offen offset:384
    buffer_load_ushort v91, v54, s[32:35], s76 offen offset:576
    buffer_load_ushort v92, v54, s[32:35], s76 offen offset:1536
    buffer_load_ushort v93, v54, s[32:35], s76 offen offset:1728
    buffer_load_ushort v94, v54, s[32:35], s76 offen offset:1920
    buffer_load_ushort v95, v54, s[32:35], s76 offen offset:2112
    s_branch Lprep_noload
Lprep_t2:
    s_add_u32 s76, s75, 128
    buffer_load_ushort v64, v54, s[32:35], s76 offen offset:0
    buffer_load_ushort v65, v54, s[32:35], s76 offen offset:192
    buffer_load_ushort v66, v54, s[32:35], s76 offen offset:384
    buffer_load_ushort v67, v54, s[32:35], s76 offen offset:576
    buffer_load_ushort v68, v54, s[32:35], s76 offen offset:1536
    buffer_load_ushort v69, v54, s[32:35], s76 offen offset:1728
    buffer_load_ushort v70, v54, s[32:35], s76 offen offset:1920
    buffer_load_ushort v71, v54, s[32:35], s76 offen offset:2112
    s_add_u32 s76, s75, 3072
    buffer_load_ushort v72, v54, s[32:35], s76 offen offset:0
    buffer_load_ushort v73, v54, s[32:35], s76 offen offset:192
    buffer_load_ushort v74, v54, s[32:35], s76 offen offset:384
    buffer_load_ushort v75, v54, s[32:35], s76 offen offset:576
    buffer_load_ushort v76, v54, s[32:35], s76 offen offset:1536
    buffer_load_ushort v77, v54, s[32:35], s76 offen offset:1728
    buffer_load_ushort v78, v54, s[32:35], s76 offen offset:1920
    buffer_load_ushort v79, v54, s[32:35], s76 offen offset:2112
    s_add_u32 s76, s75, 3136
    buffer_load_ushort v80, v54, s[32:35], s76 offen offset:0
    buffer_load_ushort v81, v54, s[32:35], s76 offen offset:192
    buffer_load_ushort v82, v54, s[32:35], s76 offen offset:384
    buffer_load_ushort v83, v54, s[32:35], s76 offen offset:576
    buffer_load_ushort v84, v54, s[32:35], s76 offen offset:1536
    buffer_load_ushort v85, v54, s[32:35], s76 offen offset:1728
    buffer_load_ushort v86, v54, s[32:35], s76 offen offset:1920
    buffer_load_ushort v87, v54, s[32:35], s76 offen offset:2112
    s_add_u32 s76, s75, 3200
    buffer_load_ushort v88, v54, s[32:35], s76 offen offset:0
    buffer_load_ushort v89, v54, s[32:35], s76 offen offset:192
    buffer_load_ushort v90, v54, s[32:35], s76 offen offset:384
    buffer_load_ushort v91, v54, s[32:35], s76 offen offset:576
    buffer_load_ushort v92, v54, s[32:35], s76 offen offset:1536
    buffer_load_ushort v93, v54, s[32:35], s76 offen offset:1728
    buffer_load_ushort v94, v54, s[32:35], s76 offen offset:1920
    buffer_load_ushort v95, v54, s[32:35], s76 offen offset:2112
Lprep_noload:
    s_mov_b64 exec, s[80:81]
    s_mov_b32 m0, s86
    s_sub_u32 s71, s85, s70
    buffer_load_dwordx4 v12, s[16:19], s71 offen nt lds
    s_add_u32 m0, s86, 784
    s_add_u32 s71, s85, 384
    buffer_load_dwordx4 v14, s[16:19], s71 offen nt lds
    s_add_u32 m0, s86, 1568
    s_add_u32 s71, s85, 1152
    buffer_load_dwordx4 v14, s[16:19], s71 offen nt lds
    s_add_u32 m0, s86, 2352
    s_add_u32 s71, s85, 1920
    buffer_load_dwordx4 v14, s[16:19], s71 offen nt lds
    s_add_u32 m0, s86, 3136
    s_add_u32 s71, s85, 2688
    buffer_load_dwordx4 v14, s[16:19], s71 offen nt lds
    s_add_u32 m0, s86, 3920
    s_add_u32 s71, s85, 3456
    buffer_load_dwordx4 v14, s[16:19], s71 offen nt lds
    s_add_u32 m0, s86, 4704
    s_add_u32 s71, s85, 4224
    buffer_load_dwordx4 v14, s[16:19], s71 offen nt lds
    s_add_u32 m0, s86, 5488
    s_add_u32 s71, s85, 4992
    buffer_load_dwordx4 v14, s[16:19], s71 offen nt lds
    s_add_u32 m0, s86, 6272
    s_add_u32 s71, s85, 5760
    buffer_load_dwordx4 v13, s[16:19], s71 offen nt lds
    s_mov_b64 exec, -1
    s_mov_b32 s32, s4
    s_and_b32 s33, s5, 0xffff
    s_mov_b32 s34, 256
    s_mov_b32 s35, 0x20000
    s_mov_b32 s24, s6
    s_and_b32 s25, s7, 0xffff
    s_mov_b32 s26, 147456
    s_mov_b32 s27, 0x20000
    s_mov_b32 s43, 12288
    s_mov_b32 s44, 147456
    s_mov_b32 s45, 1024
    s_mov_b32 s46, s88
    s_mov_b32 s42, 12288
    v_mov_b32 v11, v14
    s_mov_b32 s49, 0x44e944e9
    s_mov_b32 s50, 0xb780b780
    s_mov_b32 s82, 0x3c2aaaab
    s_mov_b32 s83, 0x3727c5ac
    s_mov_b32 s84, 0xbef00000
    s_lshl_b32 s71, s39, 5
    s_lshl_b32 s72, s36, 3
    s_add_u32 s71, s71, s72
    s_lshl_b32 s72, s37, 1
    s_add_u32 s71, s71, s72
    s_mul_i32 s71, s71, 98304
    s_mul_i32 s72, s38, 6144
    s_add_u32 s51, s71, s72
    s_mov_b32 s57, s51
    s_mov_b32 s66, 0
    s_mov_b32 s41, 29120
    s_mov_b32 s40, 1
    s_mov_b32 s47, 0
    s_xor_b32 s65, s36, 1
    s_lshl_b32 s63, s36, 3
    s_mov_b32 s87, 0
    s_mov_b32 s51, s57
    s_add_u32 s52, s51, 98304
    s_mov_b32 s53, 0
    s_mov_b32 s22, 0
    s_mov_b32 s56, 0
    v_mov_b32 v6, 0
    s_cmp_eq_u32 s36, 0
    s_cbranch_scc0 Ldry_skip
    v_lshrrev_b32 v37, 4, v14
    v_and_b32 v30, 7, v37
    v_lshrrev_b32 v31, 5, v37
    v_bfe_u32 v32, v37, 4, 1
    s_mul_i32 s71, s37, 48
    s_add_u32 s71, s71, 78272
    v_mul_u32_u24 v33, 784, v30
    v_mul_u32_u24 v34, 384, v31
    v_add3_u32 v1, v33, v34, s71
    v_mul_u32_u24 v33, 6720, v31
    v_lshlrev_b32 v34, 3, v32
    v_sub_u32 v2, v33, v34
    v_and_b32 v35, 31, v37
    v_lshlrev_b32 v36, 4, v31
    v_mul_u32_u24 v33, 192, v35
    v_add_u32 v6, v33, v36
    v_lshrrev_b32 v33, 2, v35
    v_lshl_add_u32 v33, v33, 4, v6
    v_add_u32 v4, 78272, v33
    v_add_u32 v33, 2, v35
    v_lshrrev_b32 v33, 2, v33
    v_lshl_add_u32 v33, v33, 4, v6
    v_add_u32 v3, 78656, v33
    v_and_b32 v33, 15, v37
    v_mul_u32_u24 v33, 192, v33
    v_lshl_add_u32 v33, v32, 5, v33
    v_add_u32 v6, v33, v36
    v_and_b32 v33, 3, v37
    v_bfe_u32 v34, v37, 2, 2
    v_and_b32 v35, 1, v37
    v_mul_u32_u24 v35, 400, v35
    v_bfe_u32 v36, v37, 1, 1
    v_mul_u32_u24 v36, 192, v36
    v_add_u32 v35, v35, v36
    v_bfe_u32 v36, v37, 2, 1
    v_lshlrev_b32 v36, 5, v36
    v_sub_u32 v35, v35, v36
    v_bfe_u32 v36, v37, 3, 2
    v_lshlrev_b32 v36, 2, v36
    v_sub_u32 v35, v35, v36
    s_mul_i32 s71, s37, 4704
    s_add_u32 s71, s71, 48
    v_lshl_add_u32 v35, v31, 4, v35
    v_add_u32 v5, s71, v35
    v_lshl_add_u32 v35, v31, 3, v34
    v_lshlrev_b32 v35, 6, v35
    v_lshl_add_u32 v35, v32, 5, v35
    v_lshl_add_u32 v7, v33, 3, v35
    v_lshl_add_u32 v35, v31, 2, v34
    v_mul_u32_u24 v35, 192, v35
    v_lshl_add_u32 v35, v32, 5, v35
    v_and_b32 v36, 1, v37
    v_lshl_add_u32 v35, v36, 4, v35
    v_bfe_u32 v36, v37, 1, 1
    v_lshl_add_u32 v8, v36, 3, v35
    v_bfe_u32 v35, v37, 3, 1
    v_lshl_add_u32 v35, v35, 2, v33
    v_and_b32 v36, 1, v35
    v_lshlrev_b32 v36, 4, v36
    v_mov_b32 v38, 0x3f80
    v_lshlrev_b32 v36, v36, v38
    v_lshrrev_b32 v35, 1, v35
    v_lshl_add_u32 v35, v32, 2, v35
    v_bfe_u32 v38, v37, 2, 1
    v_cmp_eq_u32 vcc, v38, v31
    s_nop 1
    v_cndmask_b32 v35, 8, v35, vcc
    v_cmp_eq_u32 vcc, 0, v35
    s_nop 1
    v_cndmask_b32 v40, 0, v36, vcc
    v_cmp_eq_u32 vcc, 1, v35
    s_nop 1
    v_cndmask_b32 v41, 0, v36, vcc
    v_cmp_eq_u32 vcc, 2, v35
    s_nop 1
    v_cndmask_b32 v42, 0, v36, vcc
    v_cmp_eq_u32 vcc, 3, v35
    s_nop 1
    v_cndmask_b32 v43, 0, v36, vcc
    v_cmp_eq_u32 vcc, 4, v35
    s_nop 1
    v_cndmask_b32 v44, 0, v36, vcc
    v_cmp_eq_u32 vcc, 5, v35
    s_nop 1
    v_cndmask_b32 v45, 0, v36, vcc
    v_cmp_eq_u32 vcc, 6, v35
    s_nop 1
    v_cndmask_b32 v46, 0, v36, vcc
    v_cmp_eq_u32 vcc, 7, v35
    s_nop 1
    v_cndmask_b32 v47, 0, v36, vcc
    ds_write_b128 v14, v[40:43] offset:18864
    ds_write_b128 v14, v[44:47] offset:19888
    s_cmp_lt_u32 s62, 36
    s_cbranch_scc0 Lprep_nocv
    v_mov_b32 v56, 0
    v_mov_b32 v57, 0
    s_waitcnt vmcnt(9)
    s_cmp_eq_u32 s60, 0
    s_cbranch_scc0 Lprep_c1
    v_mov_b32 v57, 0x3a80
    v_and_b32 v50, 0x7fff, v64
    v_and_b32 v51, 0x7fff, v65
    v_max3_u32 v56, v56, v50, v51
    v_and_b32 v50, 0x7fff, v66
    v_and_b32 v51, 0x7fff, v67
    v_max3_u32 v56, v56, v50, v51
    v_and_b32 v50, 0x7fff, v68
    v_and_b32 v51, 0x7fff, v69
    v_max3_u32 v56, v56, v50, v51
    v_and_b32 v50, 0x7fff, v70
    v_and_b32 v51, 0x7fff, v71
    v_max3_u32 v56, v56, v50, v51
    v_lshl_or_b32 v64, v65, 16, v64
    v_lshl_or_b32 v65, v67, 16, v66
    v_lshl_or_b32 v66, v69, 16, v68
    v_lshl_or_b32 v67, v71, 16, v70
    v_and_b32 v50, 0x7fff, v72
    v_and_b32 v51, 0x7fff, v73
    v_max3_u32 v56, v56, v50, v51
    v_and_b32 v50, 0x7fff, v74
    v_and_b32 v51, 0x7fff, v75
    v_max3_u32 v56, v56, v50, v51
    v_and_b32 v50, 0x7fff, v76
    v_and_b32 v51, 0x7fff, v77
    v_max3_u32 v56, v56, v50, v51
    v_and_b32 v50, 0x7fff, v78
    v_and_b32 v51, 0x7fff, v79
    v_max3_u32 v56, v56, v50, v51
    v_lshl_or_b32 v72, v73, 16, v72
    v_lshl_or_b32 v73, v75, 16, v74
    v_lshl_or_b32 v74, v77, 16, v76
    v_lshl_or_b32 v75, v79, 16, v78
    v_and_b32 v50, 0x7fff, v80
    v_and_b32 v51, 0x7fff, v81
    v_max3_u32 v56, v56, v50, v51
    v_and_b32 v50, 0x7fff, v82
    v_and_b32 v51, 0x7fff, v83
    v_max3_u32 v56, v56, v50, v51
    v_and_b32 v50, 0x7fff, v84
    v_and_b32 v51, 0x7fff, v85
    v_max3_u32 v56, v56, v50, v51
    v_and_b32 v50, 0x7fff, v86
    v_and_b32 v51, 0x7fff, v87
    v_max3_u32 v56, v56, v50, v51
    v_lshl_or_b32 v80, v81, 16, v80
    v_lshl_or_b32 v81, v83, 16, v82
    v_lshl_or_b32 v82, v85, 16, v84
    v_lshl_or_b32 v83, v87, 16, v86
    v_and_b32 v50, 0x7fff, v88
    v_and_b32 v51, 0x7fff, v89
    v_max3_u32 v56, v56, v50, v51
    v_and_b32 v50, 0x7fff, v90
    v_and_b32 v51, 0x7fff, v91
    v_max3_u32 v56, v56, v50, v51
    v_and_b32 v50, 0x7fff, v92
    v_and_b32 v51, 0x7fff, v93
    v_max3_u32 v56, v56, v50, v51
    v_and_b32 v50, 0x7fff, v94
    v_and_b32 v51, 0x7fff, v95
    v_max3_u32 v56, v56, v50, v51
    v_lshl_or_b32 v88, v89, 16, v88
    v_lshl_or_b32 v89, v91, 16, v90
    v_lshl_or_b32 v90, v93, 16, v92
    v_lshl_or_b32 v91, v95, 16, v94
    s_branch Lprep_st
Lprep_c1:
    s_cmp_eq_u32 s60, 1
    s_cbranch_scc0 Lprep_c2
    v_and_b32 v50, 0x7fff, v64
    v_and_b32 v51, 0x7fff, v65
    v_max3_u32 v56, v56, v50, v51
    v_and_b32 v50, 0x7fff, v66
    v_and_b32 v51, 0x7fff, v67
    v_max3_u32 v56, v56, v50, v51
    v_and_b32 v50, 0x7fff, v68
    v_and_b32 v51, 0x7fff, v69
    v_max3_u32 v56, v56, v50, v51
    v_and_b32 v50, 0x7fff, v70
    v_and_b32 v51, 0x7fff, v71
    v_max3_u32 v56, v56, v50, v51
    v_lshl_or_b32 v64, v65, 16, v64
    v_lshl_or_b32 v65, v67, 16, v66
    v_lshl_or_b32 v66, v69, 16, v68
    v_lshl_or_b32 v67, v71, 16, v70
    v_and_b32 v50, 0x7fff, v72
    v_and_b32 v51, 0x7fff, v73
    v_max3_u32 v56, v56, v50, v51
    v_and_b32 v50, 0x7fff, v74
    v_and_b32 v51, 0x7fff, v75
    v_max3_u32 v56, v56, v50, v51
    v_and_b32 v50, 0x7fff, v76
    v_and_b32 v51, 0x7fff, v77
    v_max3_u32 v56, v56, v50, v51
    v_and_b32 v50, 0x7fff, v78
    v_and_b32 v51, 0x7fff, v79
    v_max3_u32 v56, v56, v50, v51
    v_lshl_or_b32 v72, v73, 16, v72
    v_lshl_or_b32 v73, v75, 16, v74
    v_lshl_or_b32 v74, v77, 16, v76
    v_lshl_or_b32 v75, v79, 16, v78
    v_and_b32 v50, 0x7fff, v80
    v_and_b32 v51, 0x7fff, v81
    v_max3_u32 v57, v57, v50, v51
    v_and_b32 v50, 0x7fff, v82
    v_and_b32 v51, 0x7fff, v83
    v_max3_u32 v57, v57, v50, v51
    v_and_b32 v50, 0x7fff, v84
    v_and_b32 v51, 0x7fff, v85
    v_max3_u32 v57, v57, v50, v51
    v_and_b32 v50, 0x7fff, v86
    v_and_b32 v51, 0x7fff, v87
    v_max3_u32 v57, v57, v50, v51
    v_lshlrev_b32 v80, 16, v80
    v_lshlrev_b32 v81, 16, v81
    v_lshlrev_b32 v82, 16, v82
    v_lshlrev_b32 v83, 16, v83
    v_lshlrev_b32 v84, 16, v84
    v_lshlrev_b32 v85, 16, v85
    v_lshlrev_b32 v86, 16, v86
    v_lshlrev_b32 v87, 16, v87
    v_cvt_pk_f16_f32 v80, v80, v81
    v_cvt_pk_f16_f32 v81, v82, v83
    v_cvt_pk_f16_f32 v82, v84, v85
    v_cvt_pk_f16_f32 v83, v86, v87
    v_and_b32 v50, 0x7fff, v88
    v_and_b32 v51, 0x7fff, v89
    v_max3_u32 v57, v57, v50, v51
    v_and_b32 v50, 0x7fff, v90
    v_and_b32 v51, 0x7fff, v91
    v_max3_u32 v57, v57, v50, v51
    v_and_b32 v50, 0x7fff, v92
    v_and_b32 v51, 0x7fff, v93
    v_max3_u32 v57, v57, v50, v51
    v_and_b32 v50, 0x7fff, v94
    v_and_b32 v51, 0x7fff, v95
    v_max3_u32 v57, v57, v50, v51
    v_lshlrev_b32 v88, 16, v88
    v_lshlrev_b32 v89, 16, v89
    v_lshlrev_b32 v90, 16, v90
    v_lshlrev_b32 v91, 16, v91
    v_lshlrev_b32 v92, 16, v92
    v_lshlrev_b32 v93, 16, v93
    v_lshlrev_b32 v94, 16, v94
    v_lshlrev_b32 v95, 16, v95
    v_cvt_pk_f16_f32 v88, v88, v89
    v_cvt_pk_f16_f32 v89, v90, v91
    v_cvt_pk_f16_f32 v90, v92, v93
    v_cvt_pk_f16_f32 v91, v94, v95
    s_branch Lprep_st
Lprep_c2:
    v_mov_b32 v56, 0x3a80
    v_and_b32 v50, 0x7fff, v64
    v_and_b32 v51, 0x7fff, v65
    v_max3_u32 v57, v57, v50, v51
    v_and_b32 v50, 0x7fff, v66
    v_and_b32 v51, 0x7fff, v67
    v_max3_u32 v57, v57, v50, v51
    v_and_b32 v50, 0x7fff, v68
    v_and_b32 v51, 0x7fff, v69
    v_max3_u32 v57, v57, v50, v51
    v_and_b32 v50, 0x7fff, v70
    v_and_b32 v51, 0x7fff, v71
    v_max3_u32 v57, v57, v50, v51
    v_lshlrev_b32 v64, 16, v64
    v_lshlrev_b32 v65, 16, v65
    v_lshlrev_b32 v66, 16, v66
    v_lshlrev_b32 v67, 16, v67
    v_lshlrev_b32 v68, 16, v68
    v_lshlrev_b32 v69, 16, v69
    v_lshlrev_b32 v70, 16, v70
    v_lshlrev_b32 v71, 16, v71
    v_cvt_pk_f16_f32 v64, v64, v65
    v_cvt_pk_f16_f32 v65, v66, v67
    v_cvt_pk_f16_f32 v66, v68, v69
    v_cvt_pk_f16_f32 v67, v70, v71
    v_and_b32 v50, 0x7fff, v72
    v_and_b32 v51, 0x7fff, v73
    v_max3_u32 v57, v57, v50, v51
    v_and_b32 v50, 0x7fff, v74
    v_and_b32 v51, 0x7fff, v75
    v_max3_u32 v57, v57, v50, v51
    v_and_b32 v50, 0x7fff, v76
    v_and_b32 v51, 0x7fff, v77
    v_max3_u32 v57, v57, v50, v51
    v_and_b32 v50, 0x7fff, v78
    v_and_b32 v51, 0x7fff, v79
    v_max3_u32 v57, v57, v50, v51
    v_lshlrev_b32 v72, 16, v72
    v_lshlrev_b32 v73, 16, v73
    v_lshlrev_b32 v74, 16, v74
    v_lshlrev_b32 v75, 16, v75
    v_lshlrev_b32 v76, 16, v76
    v_lshlrev_b32 v77, 16, v77
    v_lshlrev_b32 v78, 16, v78
    v_lshlrev_b32 v79, 16, v79
    v_cvt_pk_f16_f32 v72, v72, v73
    v_cvt_pk_f16_f32 v73, v74, v75
    v_cvt_pk_f16_f32 v74, v76, v77
    v_cvt_pk_f16_f32 v75, v78, v79
    v_and_b32 v50, 0x7fff, v80
    v_and_b32 v51, 0x7fff, v81
    v_max3_u32 v57, v57, v50, v51
    v_and_b32 v50, 0x7fff, v82
    v_and_b32 v51, 0x7fff, v83
    v_max3_u32 v57, v57, v50, v51
    v_and_b32 v50, 0x7fff, v84
    v_and_b32 v51, 0x7fff, v85
    v_max3_u32 v57, v57, v50, v51
    v_and_b32 v50, 0x7fff, v86
    v_and_b32 v51, 0x7fff, v87
    v_max3_u32 v57, v57, v50, v51
    v_lshlrev_b32 v80, 16, v80
    v_lshlrev_b32 v81, 16, v81
    v_lshlrev_b32 v82, 16, v82
    v_lshlrev_b32 v83, 16, v83
    v_lshlrev_b32 v84, 16, v84
    v_lshlrev_b32 v85, 16, v85
    v_lshlrev_b32 v86, 16, v86
    v_lshlrev_b32 v87, 16, v87
    v_cvt_pk_f16_f32 v80, v80, v81
    v_cvt_pk_f16_f32 v81, v82, v83
    v_cvt_pk_f16_f32 v82, v84, v85
    v_cvt_pk_f16_f32 v83, v86, v87
    v_and_b32 v50, 0x7fff, v88
    v_and_b32 v51, 0x7fff, v89
    v_max3_u32 v57, v57, v50, v51
    v_and_b32 v50, 0x7fff, v90
    v_and_b32 v51, 0x7fff, v91
    v_max3_u32 v57, v57, v50, v51
    v_and_b32 v50, 0x7fff, v92
    v_and_b32 v51, 0x7fff, v93
    v_max3_u32 v57, v57, v50, v51
    v_and_b32 v50, 0x7fff, v94
    v_and_b32 v51, 0x7fff, v95
    v_max3_u32 v57, v57, v50, v51
    v_lshlrev_b32 v88, 16, v88
    v_lshlrev_b32 v89, 16, v89
    v_lshlrev_b32 v90, 16, v90
    v_lshlrev_b32 v91, 16, v91
    v_lshlrev_b32 v92, 16, v92
    v_lshlrev_b32 v93, 16, v93
    v_lshlrev_b32 v94, 16, v94
    v_lshlrev_b32 v95, 16, v95
    v_cvt_pk_f16_f32 v88, v88, v89
    v_cvt_pk_f16_f32 v89, v90, v91
    v_cvt_pk_f16_f32 v90, v92, v93
    v_cvt_pk_f16_f32 v91, v94, v95
Lprep_st:
    s_mov_b32 s28, s6
    s_and_b32 s29, s7, 0xffff
    s_mov_b32 s30, 147456
    s_mov_b32 s31, 0x20000
    s_lshl_b32 s73, s62, 12
    buffer_store_dwordx4 v[64:67], v14, s[28:31], s73 offen offset:0 sc0 sc1
    buffer_store_dwordx4 v[72:75], v14, s[28:31], s73 offen offset:1024 sc0 sc1
    buffer_store_dwordx4 v[80:83], v14, s[28:31], s73 offen offset:2048 sc0 sc1
    buffer_store_dwordx4 v[88:91], v14, s[28:31], s73 offen offset:3072 sc0 sc1
    v_max_u32 v50, v56, v57
    v_cmp_lt_u32 vcc, 0x4100, v50
    s_cmp_lg_u64 vcc, 0
    s_cselect_b32 s75, 3, 1
    v_cmp_le_u32 vcc, 0x3a80, v56
    s_cmp_lg_u64 vcc, 0
    s_cselect_b32 s76, 4, 0
    s_or_b32 s75, s75, s76
    v_cmp_le_u32 vcc, 0x3a80, v57
    s_cmp_lg_u64 vcc, 0
    s_cselect_b32 s76, 8, 0
    s_or_b32 s75, s75, s76
    v_mov_b32 v48, s75
    s_branch Ldry_skip
Lprep_nocv:
    s_mov_b32 s59, 0
    s_mov_b32 s68, s41
    s_mov_b32 s69, s40
    s_mov_b32 s56, 1
    s_mov_b32 s65, 0
    s_mov_b32 s48, 1
    s_mov_b32 s74, -1
    s_mov_b32 s53, 0
    s_mov_b32 s58, s42
    s_waitcnt lgkmcnt(0)
    s_setvskip -1, 0
    s_cmp_eq_u32 s37, 0
    s_cbranch_scc1 Lc1
    s_cmp_eq_u32 s37, 1
    s_cbranch_scc1 Ldry0
    s_cmp_eq_u32 s37, 2
    s_cbranch_scc1 Ljoin
    s_branch Ldry3
Ldry_ret:
    s_setvskip 0, 0
    s_mov_b64 exec, -1
    s_setprio 0
    s_mov_b32 s42, s58
    s_mov_b32 s66, 0
    s_mov_b32 s41, 29120
    s_mov_b32 s40, 1
    s_mov_b32 s47, 0
    s_xor_b32 s65, s36, 1
    s_lshl_b32 s63, s36, 3
    s_mov_b32 s87, 0
    s_mov_b32 s51, s57
    s_add_u32 s52, s51, 98304
    s_mov_b32 s53, 0
    s_mov_b32 s22, 0
    s_mov_b32 s56, 0
    s_mov_b32 s41, s68
    s_mov_b32 s40, s69
    s_cmp_eq_u32 s59, 1
    s_cbranch_scc1 Ldry_B
    s_cmp_eq_u32 s59, 2
    s_cbranch_scc1 Ldry_B2
    s_cmp_eq_u32 s59, 3
    s_cbranch_scc1 Ldry_B3
    s_cmp_eq_u32 s59, 4
    s_cbranch_scc1 Ldry_A4
Ldry_skip:
    s_waitcnt vmcnt(9)
    v_cmp_eq_u32 vcc, 2, v18
    v_lshlrev_b32 v29, 16, v29
    s_nop 0
    v_cndmask_b32 v29, 0, v29, vcc
    v_or_b32 v26, v26, v29
    v_mov_b32 v29, 0
    v_mov_b32 v30, 0
    v_mov_b32 v31, 0
    v_lshrrev_b32 v33, 2, v19
    v_mul_u32_u24 v33, 784, v33
    v_lshl_add_u32 v33, v18, 5, v33
    v_and_b32 v34, 1, v19
    v_mul_u32_u24 v34, 400, v34
    v_bfe_u32 v35, v19, 1, 1
    v_mul_u32_u24 v35, 192, v35
    v_add3_u32 v33, v33, v34, v35
    v_cmp_gt_u32 vcc, 480, v0
    s_and_saveexec_b64 s[72:73], vcc
    ds_write_b128 v33, v[24:27] offset:48
    ds_write_b128 v33, v[28:31] offset:64
    s_mov_b64 exec, -1
    v_mov_b32 v28, 0
    v_cmp_eq_u32 vcc, 4, v18
    s_and_saveexec_b64 s[72:73], vcc
    ds_write_b128 v33, v[28:31] offset:80
    ds_write_b128 v33, v[28:31] offset:96
    v_and_b32 v34, 3, v19
    v_cmp_eq_u32 vcc, 2, v34
    s_and_b64 exec, exec, vcc
    ds_write_b128 v33, v[28:31] offset:112
    s_mov_b64 exec, -1
    v_mov_b32 v33, 0
    ds_write_b128 v33, v[28:31] offset:0
    ds_write_b128 v33, v[28:31] offset:16
    ds_write_b128 v33, v[28:31] offset:32
    ds_write_b128 v33, v[28:31] offset:29104
    s_cmp_eq_u32 s36, 0
    s_cbranch_scc0 Lpro_w4
    s_lshl_b32 s71, s37, 1
    s_add_u32 s71, s71, s63
    s_add_u32 s71, s71, 0
    s_cmp_ge_u32 s71, 12
    s_cselect_b32 s72, 12, 0
    s_sub_u32 s71, s71, s72
    s_mul_i32 s55, s71, 7104
    s_lshl_b32 s71, s37, 1
    s_add_u32 s71, s71, s63
    s_add_u32 s71, s71, 2
    s_cmp_ge_u32 s71, 12
    s_cselect_b32 s72, 12, 0
    s_sub_u32 s71, s71, s72
    s_mul_i32 s54, s71, 7104
    s_add_u32 s71, s37, 1
    s_and_b32 s71, s71, 2
    s_lshl_b32 s71, s71, 2
    s_add_u32 s54, s54, s71
    s_mov_b32 s71, 7104
    v_bfe_u32 v22, v14, 7, 2
    v_lshlrev_b32 v22, 1, v22
    v_mov_b32 v20, 0
    v_mov_b32 v21, 0
    v_add_u32 v18, s63, v22
    v_subrev_u32 v19, 12, v18
    v_min_u32 v18, v18, v19
    v_mad_u32_u24 v18, v18, s71, v1
    v_and_b32 v19, 4, v22
    v_lshl_add_u32 v104, v19, 1, v18
    v_add_u32 v22, 2, v22
    v_add_u32 v18, s63, v22
    v_subrev_u32 v19, 12, v18
    v_min_u32 v18, v18, v19
    v_mad_u32_u24 v18, v18, s71, v1
    v_and_b32 v19, 4, v22
    v_lshl_add_u32 v105, v19, 1, v18
    v_add_u32 v22, 2, v22
    v_add_u32 v18, s63, v22
    v_subrev_u32 v19, 12, v18
    v_min_u32 v18, v18, v19
    v_mad_u32_u24 v18, v18, s71, v1
    v_and_b32 v19, 4, v22
    v_lshl_add_u32 v106, v19, 1, v18
    v_mov_b32 v107, v5
    v_bfe_u32 v108, v14, 4, 2
    v_mul_u32_u24 v108, 0x5555, v108
    v_add_u32 v109, s54, v3
    v_add_u32 v110, v104, v2
    v_add_u32 v111, s55, v4
    s_lshl_b32 s71, s37, 11
    v_add_u32 v22, s71, v14
    s_lshl_b32 s71, s36, 2
    s_add_u32 s71, s71, 29104
    v_mov_b32 v18, s71
    v_mov_b32 v23, 1
    s_waitcnt vmcnt(0) lgkmcnt(0)
    s_cmp_lt_u32 s62, 36
    s_cbranch_scc0 Lflag_done
    s_lshl_b32 s73, s62, 2
    s_mov_b64 exec, 1
    buffer_store_dword v48, v49, s[32:35], s73 offen sc0 sc1
    s_mov_b64 exec, -1
Lflag_done:
    s_mov_b32 s42, 98304
    s_lshl_b32 s64, s37, 1
    s_add_u32 s64, s64, 20
    s_barrier
    s_branch Lc1
Lpro_w4:
    s_mov_b64 exec, s[80:81]
    s_and_b32 s64, s37, 1
    s_add_u32 s64, s64, 8
    s_lshl_b32 s71, s39, 5
    s_add_u32 s71, s71, s64
    s_sub_u32 s71, s71, 2
    s_mul_i32 s85, s71, 98304
    s_mul_i32 s72, s38, 6144
    s_add_u32 s85, s85, s72
    s_cmp_lt_u32 s71, 512
    s_cselect_b32 s85, s85, 0x80000000
    s_cmp_ge_u32 s64, 24
    s_cselect_b32 s72, 24, 0
    s_sub_u32 s71, s64, s72
    s_cmp_ge_u32 s71, 12
    s_cselect_b32 s72, 12, 0
    s_sub_u32 s71, s71, s72
    s_and_b32 s72, s64, 4
    s_lshl_b32 s72, s72, 1
    s_mul_i32 s71, s71, 7104
    s_add_u32 s71, s71, s72
    s_add_u32 s86, s71, 78272
    s_cmp_lt_u32 s37, 2
    s_cbranch_scc0 Lpro_h0
    s_mov_b32 m0, s86
    s_sub_u32 s71, s85, s70
    buffer_load_dwordx4 v12, s[16:19], s71 offen nt lds
    s_add_u32 m0, s86, 784
    s_add_u32 s71, s85, 384
    buffer_load_dwordx4 v14, s[16:19], s71 offen nt lds
    s_add_u32 m0, s86, 1568
    s_add_u32 s71, s85, 1152
    buffer_load_dwordx4 v14, s[16:19], s71 offen nt lds
    s_add_u32 m0, s86, 2352
    s_add_u32 s71, s85, 1920
    buffer_load_dwordx4 v14, s[16:19], s71 offen nt lds
    s_add_u32 m0, s86, 3136
    s_add_u32 s71, s85, 2688
    buffer_load_dwordx4 v14, s[16:19], s71 offen nt lds
    s_branch Lpro_g0
Lpro_h0:
    s_add_u32 m0, s86, 3920
    s_add_u32 s71, s85, 3456
    buffer_load_dwordx4 v14, s[16:19], s71 offen nt lds
    s_add_u32 m0, s86, 4704
    s_add_u32 s71, s85, 4224
    buffer_load_dwordx4 v14, s[16:19], s71 offen nt lds
    s_add_u32 m0, s86, 5488
    s_add_u32 s71, s85, 4992
    buffer_load_dwordx4 v14, s[16:19], s71 offen nt lds
    s_add_u32 m0, s86, 6272
    s_add_u32 s71, s85, 5760
    buffer_load_dwordx4 v13, s[16:19], s71 offen nt lds
    s_add_u32 m0, s86, 6272
    s_add_u32 s71, s85, 5760
    buffer_load_dwordx4 v13, s[16:19], s71 offen nt lds
Lpro_g0:
    s_add_u32 s64, s64, 2
    s_waitcnt vmcnt(5) lgkmcnt(0)
    s_barrier
    s_lshl_b32 s71, s39, 5
    s_add_u32 s71, s71, s64
    s_sub_u32 s71, s71, 2
    s_mul_i32 s85, s71, 98304
    s_mul_i32 s72, s38, 6144
    s_add_u32 s85, s85, s72
    s_cmp_lt_u32 s71, 512
    s_cselect_b32 s85, s85, 0x80000000
    s_cmp_ge_u32 s64, 24
    s_cselect_b32 s72, 24, 0
    s_sub_u32 s71, s64, s72
    s_cmp_ge_u32 s71, 12
    s_cselect_b32 s72, 12, 0
    s_sub_u32 s71, s71, s72
    s_and_b32 s72, s64, 4
    s_lshl_b32 s72, s72, 1
    s_mul_i32 s71, s71, 7104
    s_add_u32 s71, s71, s72
    s_add_u32 s86, s71, 78272
    s_cmp_lt_u32 s37, 2
    s_cbranch_scc0 Lpro_h1
    s_mov_b32 m0, s86
    s_sub_u32 s71, s85, s70
    buffer_load_dwordx4 v12, s[16:19], s71 offen nt lds
    s_add_u32 m0, s86, 784
    s_add_u32 s71, s85, 384
    buffer_load_dwordx4 v14, s[16:19], s71 offen nt lds
    s_add_u32 m0, s86, 1568
    s_add_u32 s71, s85, 1152
    buffer_load_dwordx4 v14, s[16:19], s71 offen nt lds
    s_add_u32 m0, s86, 2352
    s_add_u32 s71, s85, 1920
    buffer_load_dwordx4 v14, s[16:19], s71 offen nt lds
    s_add_u32 m0, s86, 3136
    s_add_u32 s71, s85, 2688
    buffer_load_dwordx4 v14, s[16:19], s71 offen nt lds
    s_branch Lpro_g1
Lpro_h1:
    s_add_u32 m0, s86, 3920
    s_add_u32 s71, s85, 3456
    buffer_load_dwordx4 v14, s[16:19], s71 offen nt lds
    s_add_u32 m0, s86, 4704
    s_add_u32 s71, s85, 4224
    buffer_load_dwordx4 v14, s[16:19], s71 offen nt lds
    s_add_u32 m0, s86, 5488
    s_add_u32 s71, s85, 4992
    buffer_load_dwordx4 v14, s[16:19], s71 offen nt lds
    s_add_u32 m0, s86, 6272
    s_add_u32 s71, s85, 5760
    buffer_load_dwordx4 v13, s[16:19], s71 offen nt lds
    s_add_u32 m0, s86, 6272
    s_add_u32 s71, s85, 5760
    buffer_load_dwordx4 v13, s[16:19], s71 offen nt lds
Lpro_g1:
    s_add_u32 s64, s64, 2
    s_mov_b64 exec, -1
    s_waitcnt vmcnt(5)
    s_barrier
    s_waitcnt vmcnt(0)
    s_barrier
    v_lshrrev_b32 v37, 4, v14
    v_and_b32 v30, 7, v37
    v_lshrrev_b32 v31, 5, v37
    v_bfe_u32 v32, v37, 4, 1
    s_mul_i32 s71, s37, 48
    s_add_u32 s71, s71, 78272
    v_mul_u32_u24 v33, 784, v30
    v_mul_u32_u24 v34, 384, v31
    v_add3_u32 v1, v33, v34, s71
    v_mul_u32_u24 v33, 6720, v31
    v_lshlrev_b32 v34, 3, v32
    v_sub_u32 v2, v33, v34
    v_and_b32 v35, 31, v37
    v_lshlrev_b32 v36, 4, v31
    v_mul_u32_u24 v33, 192, v35
    v_add_u32 v6, v33, v36
    v_lshrrev_b32 v33, 2, v35
    v_lshl_add_u32 v33, v33, 4, v6
    v_add_u32 v4, 78272, v33
    v_add_u32 v33, 2, v35
    v_lshrrev_b32 v33, 2, v33
    v_lshl_add_u32 v33, v33, 4, v6
    v_add_u32 v3, 78656, v33
    v_and_b32 v33, 15, v37
    v_mul_u32_u24 v33, 192, v33
    v_lshl_add_u32 v33, v32, 5, v33
    v_add_u32 v6, v33, v36
    v_and_b32 v33, 3, v37
    v_bfe_u32 v34, v37, 2, 2
    v_and_b32 v35, 1, v37
    v_mul_u32_u24 v35, 400, v35
    v_bfe_u32 v36, v37, 1, 1
    v_mul_u32_u24 v36, 192, v36
    v_add_u32 v35, v35, v36
    v_bfe_u32 v36, v37, 2, 1
    v_lshlrev_b32 v36, 5, v36
    v_sub_u32 v35, v35, v36
    v_bfe_u32 v36, v37, 3, 2
    v_lshlrev_b32 v36, 2, v36
    v_sub_u32 v35, v35, v36
    s_mul_i32 s71, s37, 4704
    s_add_u32 s71, s71, 48
    v_lshl_add_u32 v35, v31, 4, v35
    v_add_u32 v5, s71, v35
    v_lshl_add_u32 v35, v31, 3, v34
    v_lshlrev_b32 v35, 6, v35
    v_lshl_add_u32 v35, v32, 5, v35
    v_lshl_add_u32 v7, v33, 3, v35
    v_lshl_add_u32 v35, v31, 2, v34
    v_mul_u32_u24 v35, 192, v35
    v_lshl_add_u32 v35, v32, 5, v35
    v_and_b32 v36, 1, v37
    v_lshl_add_u32 v35, v36, 4, v35
    v_bfe_u32 v36, v37, 1, 1
    v_lshl_add_u32 v8, v36, 3, v35
    s_mov_b32 s59, 1
    s_mov_b32 s68, s41
    s_mov_b32 s69, s40
    s_mov_b32 s56, 1
    s_mov_b32 s65, 0
    s_mov_b32 s48, 1
    s_mov_b32 s74, -1
    s_mov_b32 s53, 0
    s_mov_b32 s58, s42
    s_waitcnt lgkmcnt(0)
    s_setvskip -1, 0
    s_cmp_eq_u32 s37, 0
    s_cbranch_scc1 Lbody2P
    s_cmp_eq_u32 s37, 1
    s_cbranch_scc1 Lq12
    s_cmp_eq_u32 s37, 2
    s_cbranch_scc1 Lhalf2
    s_branch Lq32
Ldry_B:
    v_mov_b32 v18, 29112
    s_cmp_eq_u32 s37, 0
    s_cbranch_scc0 Lmode_wait
    v_lshrrev_b32 v20, 2, v14
    s_mov_b32 s71, 300
    s_mov_b32 s3, 2
Lpoll_g:
    buffer_load_dword v19, v20, s[32:35], 0 offen sc1
    s_waitcnt vmcnt(0)
    v_cmp_ne_u32 vcc, 0, v19
    s_bcnt1_i32_b64 s73, vcc
    s_cmp_eq_u32 s73, 36
    s_cbranch_scc1 Lpoll_ok
    s_sleep 12
    s_sub_u32 s71, s71, 1
    s_cmp_lg_u32 s71, 0
    s_cbranch_scc1 Lpoll_g
    s_branch Lmode_set
Lpoll_ok:
    v_cmp_eq_u32 vcc, 13, v19
    s_bcnt1_i32_b64 s73, vcc
    s_cmp_eq_u32 s73, 36
    s_cbranch_scc0 Lmode_set
    s_mov_b32 s3, 1
Lmode_set:
    v_mov_b32 v19, s3
    ds_write_b32 v18, v19
Lmode_wait:
    ds_read_b32 v19, v18
    s_waitcnt lgkmcnt(0)
    v_readfirstlane_b32 s3, v19
    s_cmp_eq_u32 s3, 0
    s_cbranch_scc1 Lmode_wait
    s_cmp_eq_u32 s3, 1
    s_cbranch_scc1 Lmode_P
    s_cmp_lt_u32 s37, 2
    s_cselect_b32 s24, s10, s12
    s_cselect_b32 s25, s11, s13
    s_cselect_b32 s43, 64, 6144
    s_mov_b32 s45, 1024
    s_cselect_b32 s45, 12288, s45
    s_cselect_b32 s42, 2, 1
    s_mul_i32 s42, s42, s43
    s_mul_i32 s44, s43, 12
    s_and_b32 s25, s25, 0xffff
    s_mov_b32 s26, 73728
    s_mov_b32 s27, 0x20000
    s_and_b32 s74, s37, 1
    s_mul_i32 s74, s74, 3
    s_mul_i32 s46, s74, s45
    v_lshrrev_b32 v20, 6, v14
    v_mul_u32_u24 v20, 768, v20
    v_and_b32 v21, 48, v14
    v_add_u32 v20, v20, v21
    s_cmp_lt_u32 s37, 2
    s_cselect_b64 vcc, -1, 0
    v_cndmask_b32 v11, v14, v20, vcc
Lmode_P:
    s_add_u32 m0, 41408, s88
    s_add_u32 s79, s42, s46
    buffer_load_dwordx4 v11, s[24:27], s79 offen sc1 lds
    s_add_u32 m0, m0, s89
    s_add_u32 s79, s79, s45
    buffer_load_dwordx4 v11, s[24:27], s79 offen sc1 lds
    s_add_u32 m0, m0, s89
    s_add_u32 s79, s79, s45
    buffer_load_dwordx4 v11, s[24:27], s79 offen sc1 lds
    s_add_u32 s42, s42, s43
    s_cmp_eq_u32 s42, s44
    s_cselect_b32 s42, 0, s42
    s_add_u32 m0, 53696, s88
    s_add_u32 s79, s42, s46
    buffer_load_dwordx4 v11, s[24:27], s79 offen sc1 lds
    s_add_u32 m0, m0, s89
    s_add_u32 s79, s79, s45
    buffer_load_dwordx4 v11, s[24:27], s79 offen sc1 lds
    s_add_u32 m0, m0, s89
    s_add_u32 s79, s79, s45
    buffer_load_dwordx4 v11, s[24:27], s79 offen sc1 lds
    s_add_u32 s42, s42, s43
    s_cmp_eq_u32 s42, s44
    s_cselect_b32 s42, 0, s42
    s_add_u32 m0, 65984, s88
    s_add_u32 s79, s42, s46
    buffer_load_dwordx4 v11, s[24:27], s79 offen sc1 lds
    s_add_u32 m0, m0, s89
    s_add_u32 s79, s79, s45
    buffer_load_dwordx4 v11, s[24:27], s79 offen sc1 lds
    s_add_u32 m0, m0, s89
    s_add_u32 s79, s79, s45
    buffer_load_dwordx4 v11, s[24:27], s79 offen sc1 lds
    s_add_u32 s42, s42, s43
    s_cmp_eq_u32 s42, s44
    s_cselect_b32 s42, 0, s42
    s_mov_b32 s59, 2
    s_mov_b32 s68, s41
    s_mov_b32 s69, s40
    s_mov_b32 s56, 1
    s_mov_b32 s65, 0
    s_mov_b32 s48, 1
    s_mov_b32 s74, -1
    s_mov_b32 s53, 0
    s_mov_b32 s58, s42
    s_waitcnt lgkmcnt(0)
    s_setvskip -1, 0
    s_cmp_eq_u32 s37, 0
    s_cbranch_scc1 Lbody1P
    s_cmp_eq_u32 s37, 1
    s_cbranch_scc1 Lq11
    s_cmp_eq_u32 s37, 2
    s_cbranch_scc1 Lhalf1
    s_branch Lq31
Ldry_B2:
    s_waitcnt vmcnt(6)
    s_barrier
    s_waitcnt vmcnt(0)
    s_barrier
    s_sub_u32 s41, 82816, s41
    s_sub_u32 s78, 82816, s41
    s_add_u32 m0, s78, s88
    s_add_u32 s79, s42, s46
    buffer_load_dwordx4 v11, s[24:27], s79 offen sc1 lds
    s_add_u32 m0, m0, s89
    s_add_u32 s79, s79, s45
    buffer_load_dwordx4 v11, s[24:27], s79 offen sc1 lds
    s_add_u32 m0, m0, s89
    s_add_u32 s79, s79, s45
    buffer_load_dwordx4 v11, s[24:27], s79 offen sc1 lds
    s_add_u32 s42, s42, s43
    s_cmp_eq_u32 s42, s44
    s_cselect_b32 s42, 0, s42
    s_add_u32 s78, s78, 12288
    s_add_u32 m0, s78, s88
    s_add_u32 s79, s42, s46
    buffer_load_dwordx4 v11, s[24:27], s79 offen sc1 lds
    s_add_u32 m0, m0, s89
    s_add_u32 s79, s79, s45
    buffer_load_dwordx4 v11, s[24:27], s79 offen sc1 lds
    s_add_u32 m0, m0, s89
    s_add_u32 s79, s79, s45
    buffer_load_dwordx4 v11, s[24:27], s79 offen sc1 lds
    s_add_u32 s42, s42, s43
    s_cmp_eq_u32 s42, s44
    s_cselect_b32 s42, 0, s42
    s_lshl_b32 s64, s37, 1
    s_add_u32 s64, s64, 12
    s_mov_b64 exec, s[80:81]
    s_lshl_b32 s71, s39, 5
    s_add_u32 s71, s71, s64
    s_sub_u32 s71, s71, 2
    s_mul_i32 s85, s71, 98304
    s_mul_i32 s72, s38, 6144
    s_add_u32 s85, s85, s72
    s_cmp_lt_u32 s71, 512
    s_cselect_b32 s85, s85, 0x80000000
    s_cmp_ge_u32 s64, 24
    s_cselect_b32 s72, 24, 0
    s_sub_u32 s71, s64, s72
    s_cmp_ge_u32 s71, 12
    s_cselect_b32 s72, 12, 0
    s_sub_u32 s71, s71, s72
    s_and_b32 s72, s64, 4
    s_lshl_b32 s72, s72, 1
    s_mul_i32 s71, s71, 7104
    s_add_u32 s71, s71, s72
    s_add_u32 s86, s71, 78272
    s_mov_b32 m0, s86
    s_sub_u32 s71, s85, s70
    buffer_load_dwordx4 v12, s[16:19], s71 offen nt lds
    s_add_u32 m0, s86, 784
    s_add_u32 s71, s85, 384
    buffer_load_dwordx4 v14, s[16:19], s71 offen nt lds
    s_add_u32 m0, s86, 1568
    s_add_u32 s71, s85, 1152
    buffer_load_dwordx4 v14, s[16:19], s71 offen nt lds
    s_add_u32 m0, s86, 2352
    s_add_u32 s71, s85, 1920
    buffer_load_dwordx4 v14, s[16:19], s71 offen nt lds
    s_add_u32 m0, s86, 3136
    s_add_u32 s71, s85, 2688
    buffer_load_dwordx4 v14, s[16:19], s71 offen nt lds
    s_add_u32 m0, s86, 3920
    s_add_u32 s71, s85, 3456
    buffer_load_dwordx4 v14, s[16:19], s71 offen nt lds
    s_add_u32 m0, s86, 4704
    s_add_u32 s71, s85, 4224
    buffer_load_dwordx4 v14, s[16:19], s71 offen nt lds
    s_add_u32 m0, s86, 5488
    s_add_u32 s71, s85, 4992
    buffer_load_dwordx4 v14, s[16:19], s71 offen nt lds
    s_add_u32 m0, s86, 6272
    s_add_u32 s71, s85, 5760
    buffer_load_dwordx4 v13, s[16:19], s71 offen nt lds
    s_add_u32 s64, s64, 1
    s_lshl_b32 s71, s39, 5
    s_add_u32 s71, s71, s64
    s_sub_u32 s71, s71, 2
    s_mul_i32 s85, s71, 98304
    s_mul_i32 s72, s38, 6144
    s_add_u32 s85, s85, s72
    s_cmp_lt_u32 s71, 512
    s_cselect_b32 s85, s85, 0x80000000
    s_cmp_ge_u32 s64, 24
    s_cselect_b32 s72, 24, 0
    s_sub_u32 s71, s64, s72
    s_cmp_ge_u32 s71, 12
    s_cselect_b32 s72, 12, 0
    s_sub_u32 s71, s71, s72
    s_and_b32 s72, s64, 4
    s_lshl_b32 s72, s72, 1
    s_mul_i32 s71, s71, 7104
    s_add_u32 s71, s71, s72
    s_add_u32 s86, s71, 78272
    s_mov_b32 m0, s86
    s_sub_u32 s71, s85, s70
    buffer_load_dwordx4 v12, s[16:19], s71 offen nt lds
    s_add_u32 m0, s86, 784
    s_add_u32 s71, s85, 384
    buffer_load_dwordx4 v14, s[16:19], s71 offen nt lds
    s_add_u32 m0, s86, 1568
    s_add_u32 s71, s85, 1152
    buffer_load_dwordx4 v14, s[16:19], s71 offen nt lds
    s_add_u32 m0, s86, 2352
    s_add_u32 s71, s85, 1920
    buffer_load_dwordx4 v14, s[16:19], s71 offen nt lds
    s_add_u32 m0, s86, 3136
    s_add_u32 s71, s85, 2688
    buffer_load_dwordx4 v14, s[16:19], s71 offen nt lds
    s_add_u32 m0, s86, 3920
    s_add_u32 s71, s85, 3456
    buffer_load_dwordx4 v14, s[16:19], s71 offen nt lds
    s_add_u32 m0, s86, 4704
    s_add_u32 s71, s85, 4224
    buffer_load_dwordx4 v14, s[16:19], s71 offen nt lds
    s_add_u32 m0, s86, 5488
    s_add_u32 s71, s85, 4992
    buffer_load_dwordx4 v14, s[16:19], s71 offen nt lds
    s_add_u32 m0, s86, 6272
    s_add_u32 s71, s85, 5760
    buffer_load_dwordx4 v13, s[16:19], s71 offen nt lds
    s_add_u32 s64, s64, 7
    s_mov_b64 exec, -1
    s_waitcnt vmcnt(18)
    s_barrier
    s_sub_u32 s41, 82816, s41
    s_sub_u32 s78, 82816, s41
    s_add_u32 m0, s78, s88
    s_add_u32 s79, s42, s46
    buffer_load_dwordx4 v11, s[24:27], s79 offen sc1 lds
    s_add_u32 m0, m0, s89
    s_add_u32 s79, s79, s45
    buffer_load_dwordx4 v11, s[24:27], s79 offen sc1 lds
    s_add_u32 m0, m0, s89
    s_add_u32 s79, s79, s45
    buffer_load_dwordx4 v11, s[24:27], s79 offen sc1 lds
    s_add_u32 s42, s42, s43
    s_cmp_eq_u32 s42, s44
    s_cselect_b32 s42, 0, s42
    s_add_u32 s78, s78, 12288
    s_add_u32 m0, s78, s88
    s_add_u32 s79, s42, s46
    buffer_load_dwordx4 v11, s[24:27], s79 offen sc1 lds
    s_add_u32 m0, m0, s89
    s_add_u32 s79, s79, s45
    buffer_load_dwordx4 v11, s[24:27], s79 offen sc1 lds
    s_add_u32 m0, m0, s89
    s_add_u32 s79, s79, s45
    buffer_load_dwordx4 v11, s[24:27], s79 offen sc1 lds
    s_add_u32 s42, s42, s43
    s_cmp_eq_u32 s42, s44
    s_cselect_b32 s42, 0, s42
    s_mov_b32 s59, 3
    s_mov_b32 s68, s41
    s_mov_b32 s69, s40
    s_mov_b32 s56, 1
    s_mov_b32 s65, 0
    s_mov_b32 s48, 1
    s_mov_b32 s74, -1
    s_mov_b32 s53, 0
    s_mov_b32 s58, s42
    s_waitcnt lgkmcnt(0)
    s_setvskip -1, 0
    s_cmp_eq_u32 s37, 0
    s_cbranch_scc1 LconvP
    s_cmp_eq_u32 s37, 1
    s_cbranch_scc1 Ldry1
    s_cmp_eq_u32 s37, 2
    s_cbranch_scc1 Lbody0P
    s_branch Lhalf0
Ldry_B3:
    s_cmp_eq_u32 s3, 1
    s_cbranch_scc0 LouterR
    s_branch LouterP
Lc1:
    s_setprio 3
    s_nop 0
    v_add_u32 v92, 1568, v107
    v_add_u32 v93, 3136, v107
    ds_read2_b32 v[64:65], v107 offset0:0 offset1:1
    ds_read2_b32 v[66:67], v107 offset0:2 offset1:3
    ds_read_b64 v[56:57], v104 offset:0
    ds_read_b64 v[58:59], v104 offset:192
    ds_read_b64 v[60:61], v104 offset:784
    ds_read_b64 v[62:63], v104 offset:976
    ds_read2_b32 v[76:77], v107 offset0:196 offset1:197
    ds_read2_b32 v[78:79], v107 offset0:198 offset1:199
    ds_read_b64 v[68:69], v104 offset:8
    ds_read_b64 v[70:71], v104 offset:200
    ds_read_b64 v[72:73], v104 offset:792
    ds_read_b64 v[74:75], v104 offset:984
    v_mfma_f32_32x32x8_bf16 v[160:175], v[20:21], v[20:21], 0
    v_mfma_f32_32x32x8_bf16 v[176:191], v[20:21], v[20:21], 0
    v_mfma_f32_32x32x8_bf16 v[192:207], v[20:21], v[20:21], 0
    v_mfma_f32_32x32x8_bf16 v[208:223], v[20:21], v[20:21], 0
    v_mfma_f32_32x32x8_bf16 v[224:239], v[20:21], v[20:21], 0
    v_mfma_f32_32x32x8_bf16 v[240:255], v[20:21], v[20:21], 0
    s_waitcnt lgkmcnt(6)
    s_nop 0
    v_smfmac_f32_32x32x32_bf16 v[160:175], v[64:67], v[56:63], v108
    ds_read2_b32 v[64:65], v92 offset0:0 offset1:1
    ds_read2_b32 v[66:67], v92 offset0:2 offset1:3
    ds_read_b64 v[56:57], v104 offset:16
    ds_read_b64 v[58:59], v104 offset:208
    ds_read_b64 v[60:61], v104 offset:800
    ds_read_b64 v[62:63], v104 offset:992
    s_waitcnt lgkmcnt(6)
    s_nop 0
    v_smfmac_f32_32x32x32_bf16 v[176:191], v[76:79], v[68:75], v108
    ds_read2_b32 v[76:77], v92 offset0:196 offset1:197
    ds_read2_b32 v[78:79], v92 offset0:198 offset1:199
    ds_read_b64 v[68:69], v104 offset:24
    ds_read_b64 v[70:71], v104 offset:216
    ds_read_b64 v[72:73], v104 offset:808
    ds_read_b64 v[74:75], v104 offset:1000
    s_waitcnt lgkmcnt(6)
    s_nop 0
    v_smfmac_f32_32x32x32_bf16 v[192:207], v[64:67], v[56:63], v108
    ds_read2_b32 v[64:65], v93 offset0:0 offset1:1
    ds_read2_b32 v[66:67], v93 offset0:2 offset1:3
    ds_read_b64 v[56:57], v104 offset:32
    ds_read_b64 v[58:59], v104 offset:224
    ds_read_b64 v[60:61], v104 offset:816
    ds_read_b64 v[62:63], v104 offset:1008
    s_waitcnt lgkmcnt(6)
    s_nop 0
    v_smfmac_f32_32x32x32_bf16 v[208:223], v[76:79], v[68:75], v108
    ds_read2_b32 v[76:77], v93 offset0:196 offset1:197
    ds_read2_b32 v[78:79], v93 offset0:198 offset1:199
    ds_read_b64 v[68:69], v104 offset:40
    ds_read_b64 v[70:71], v104 offset:232
    ds_read_b64 v[72:73], v104 offset:824
    ds_read_b64 v[74:75], v104 offset:1016
    s_waitcnt lgkmcnt(6)
    s_nop 0
    v_smfmac_f32_32x32x32_bf16 v[224:239], v[64:67], v[56:63], v108
    ds_read2_b32 v[64:65], v107 offset0:8 offset1:9
    ds_read2_b32 v[66:67], v107 offset0:10 offset1:11
    ds_read_b64 v[56:57], v104 offset:7104
    ds_read_b64 v[58:59], v104 offset:7296
    ds_read_b64 v[60:61], v104 offset:7888
    ds_read_b64 v[62:63], v104 offset:8080
    s_waitcnt lgkmcnt(6)
    s_nop 0
    v_smfmac_f32_32x32x32_bf16 v[240:255], v[76:79], v[68:75], v108
    ds_read2_b32 v[76:77], v107 offset0:204 offset1:205
    ds_read2_b32 v[78:79], v107 offset0:206 offset1:207
    ds_read_b64 v[68:69], v104 offset:7112
    ds_read_b64 v[70:71], v104 offset:7304
    ds_read_b64 v[72:73], v104 offset:7896
    ds_read_b64 v[74:75], v104 offset:8088
    s_waitcnt lgkmcnt(6)
    s_nop 0
    v_smfmac_f32_32x32x32_bf16 v[160:175], v[64:67], v[56:63], v108
    ds_read2_b32 v[64:65], v92 offset0:8 offset1:9
    ds_read2_b32 v[66:67], v92 offset0:10 offset1:11
    ds_read_b64 v[56:57], v104 offset:7120
    ds_read_b64 v[58:59], v104 offset:7312
    ds_read_b64 v[60:61], v104 offset:7904
    ds_read_b64 v[62:63], v104 offset:8096
    s_waitcnt lgkmcnt(6)
    s_nop 0
    v_smfmac_f32_32x32x32_bf16 v[176:191], v[76:79], v[68:75], v108
    ds_read2_b32 v[76:77], v92 offset0:204 offset1:205
    ds_read2_b32 v[78:79], v92 offset0:206 offset1:207
    ds_read_b64 v[68:69], v104 offset:7128
    ds_read_b64 v[70:71], v104 offset:7320
    ds_read_b64 v[72:73], v104 offset:7912
    ds_read_b64 v[74:75], v104 offset:8104
    s_waitcnt lgkmcnt(6)
    s_nop 0
    v_smfmac_f32_32x32x32_bf16 v[192:207], v[64:67], v[56:63], v108
    ds_read2_b32 v[64:65], v93 offset0:8 offset1:9
    ds_read2_b32 v[66:67], v93 offset0:10 offset1:11
    ds_read_b64 v[56:57], v104 offset:7136
    ds_read_b64 v[58:59], v104 offset:7328
    ds_read_b64 v[60:61], v104 offset:7920
    ds_read_b64 v[62:63], v104 offset:8112
    s_waitcnt lgkmcnt(6)
    s_nop 0
    v_smfmac_f32_32x32x32_bf16 v[208:223], v[76:79], v[68:75], v108
    ds_read2_b32 v[76:77], v93 offset0:204 offset1:205
    ds_read2_b32 v[78:79], v93 offset0:206 offset1:207
    ds_read_b64 v[68:69], v104 offset:7144
    ds_read_b64 v[70:71], v104 offset:7336
    ds_read_b64 v[72:73], v104 offset:7928
    ds_read_b64 v[74:75], v104 offset:8120
    s_waitcnt lgkmcnt(6)
    s_nop 0
    v_smfmac_f32_32x32x32_bf16 v[224:239], v[64:67], v[56:63], v108
    s_or_b32 s71, s56, s36
    s_cbranch_scc1 Lr_4
    s_barrier
Lr_4:
    s_nop 0
    ds_read2_b32 v[64:65], v107 offset0:16 offset1:17
    ds_read2_b32 v[66:67], v107 offset0:18 offset1:19
    ds_read_b64 v[56:57], v105 offset:0
    ds_read_b64 v[58:59], v105 offset:192
    ds_read_b64 v[60:61], v105 offset:784
    ds_read_b64 v[62:63], v105 offset:976
    s_waitcnt lgkmcnt(6)
    s_nop 0
    v_smfmac_f32_32x32x32_bf16 v[240:255], v[76:79], v[68:75], v108
    ds_read2_b32 v[76:77], v107 offset0:212 offset1:213
    ds_read2_b32 v[78:79], v107 offset0:214 offset1:215
    ds_read_b64 v[68:69], v105 offset:8
    ds_read_b64 v[70:71], v105 offset:200
    ds_read_b64 v[72:73], v105 offset:792
    ds_read_b64 v[74:75], v105 offset:984
    s_waitcnt lgkmcnt(6)
    s_nop 0
    v_smfmac_f32_32x32x32_bf16 v[160:175], v[64:67], v[56:63], v108
    ds_read2_b32 v[64:65], v92 offset0:16 offset1:17
    ds_read2_b32 v[66:67], v92 offset0:18 offset1:19
    ds_read_b64 v[56:57], v105 offset:16
    ds_read_b64 v[58:59], v105 offset:208
    ds_read_b64 v[60:61], v105 offset:800
    ds_read_b64 v[62:63], v105 offset:992
    s_waitcnt lgkmcnt(6)
    s_nop 0
    v_smfmac_f32_32x32x32_bf16 v[176:191], v[76:79], v[68:75], v108
    ds_read2_b32 v[76:77], v92 offset0:212 offset1:213
    ds_read2_b32 v[78:79], v92 offset0:214 offset1:215
    ds_read_b64 v[68:69], v105 offset:24
    ds_read_b64 v[70:71], v105 offset:216
    ds_read_b64 v[72:73], v105 offset:808
    ds_read_b64 v[74:75], v105 offset:1000
    s_waitcnt lgkmcnt(6)
    s_nop 0
    v_smfmac_f32_32x32x32_bf16 v[192:207], v[64:67], v[56:63], v108
    ds_read2_b32 v[64:65], v93 offset0:16 offset1:17
    ds_read2_b32 v[66:67], v93 offset0:18 offset1:19
    ds_read_b64 v[56:57], v105 offset:32
    ds_read_b64 v[58:59], v105 offset:224
    ds_read_b64 v[60:61], v105 offset:816
    ds_read_b64 v[62:63], v105 offset:1008
    s_waitcnt lgkmcnt(6)
    s_nop 0
    v_smfmac_f32_32x32x32_bf16 v[208:223], v[76:79], v[68:75], v108
    ds_read2_b32 v[76:77], v93 offset0:212 offset1:213
    ds_read2_b32 v[78:79], v93 offset0:214 offset1:215
    ds_read_b64 v[68:69], v105 offset:40
    ds_read_b64 v[70:71], v105 offset:232
    ds_read_b64 v[72:73], v105 offset:824
    ds_read_b64 v[74:75], v105 offset:1016
    s_waitcnt lgkmcnt(6)
    s_nop 0
    v_smfmac_f32_32x32x32_bf16 v[224:239], v[64:67], v[56:63], v108
    ds_read2_b32 v[64:65], v107 offset0:24 offset1:25
    ds_read2_b32 v[66:67], v107 offset0:26 offset1:27
    ds_read_b64 v[56:57], v105 offset:7104
    ds_read_b64 v[58:59], v105 offset:7296
    ds_read_b64 v[60:61], v105 offset:7888
    ds_read_b64 v[62:63], v105 offset:8080
    s_waitcnt lgkmcnt(6)
    s_nop 0
    v_smfmac_f32_32x32x32_bf16 v[240:255], v[76:79], v[68:75], v108
    ds_read2_b32 v[76:77], v107 offset0:220 offset1:221
    ds_read2_b32 v[78:79], v107 offset0:222 offset1:223
    ds_read_b64 v[68:69], v105 offset:7112
    ds_read_b64 v[70:71], v105 offset:7304
    ds_read_b64 v[72:73], v105 offset:7896
    ds_read_b64 v[74:75], v105 offset:8088
    s_cmp_lg_u32 s56, 0
    s_cbranch_scc1 Ldry_ret
Ldry0:
    s_waitcnt lgkmcnt(6)
    s_nop 0
    v_smfmac_f32_32x32x32_bf16 v[160:175], v[64:67], v[56:63], v108
    ds_read2_b32 v[64:65], v92 offset0:24 offset1:25
    ds_read2_b32 v[66:67], v92 offset0:26 offset1:27
    ds_read_b64 v[56:57], v105 offset:7120
    ds_read_b64 v[58:59], v105 offset:7312
    ds_read_b64 v[60:61], v105 offset:7904
    ds_read_b64 v[62:63], v105 offset:8096
    s_waitcnt lgkmcnt(6)
    s_nop 0
    v_smfmac_f32_32x32x32_bf16 v[176:191], v[76:79], v[68:75], v108
    ds_read2_b32 v[76:77], v92 offset0:220 offset1:221
    ds_read2_b32 v[78:79], v92 offset0:222 offset1:223
    ds_read_b64 v[68:69], v105 offset:7128
    ds_read_b64 v[70:71], v105 offset:7320
    ds_read_b64 v[72:73], v105 offset:7912
    ds_read_b64 v[74:75], v105 offset:8104
    s_waitcnt lgkmcnt(6)
    s_nop 0
    v_smfmac_f32_32x32x32_bf16 v[192:207], v[64:67], v[56:63], v108
    ds_read2_b32 v[64:65], v93 offset0:24 offset1:25
    ds_read2_b32 v[66:67], v93 offset0:26 offset1:27
    ds_read_b64 v[56:57], v105 offset:7136
    ds_read_b64 v[58:59], v105 offset:7328
    ds_read_b64 v[60:61], v105 offset:7920
    ds_read_b64 v[62:63], v105 offset:8112
    s_waitcnt lgkmcnt(6)
    s_nop 0
    v_smfmac_f32_32x32x32_bf16 v[208:223], v[76:79], v[68:75], v108
    ds_read2_b32 v[76:77], v93 offset0:220 offset1:221
    ds_read2_b32 v[78:79], v93 offset0:222 offset1:223
    ds_read_b64 v[68:69], v105 offset:7144
    ds_read_b64 v[70:71], v105 offset:7336
    ds_read_b64 v[72:73], v105 offset:7928
    ds_read_b64 v[74:75], v105 offset:8120
    s_waitcnt lgkmcnt(6)
    s_nop 0
    v_smfmac_f32_32x32x32_bf16 v[224:239], v[64:67], v[56:63], v108
    s_or_b32 s71, s56, s36
    s_cbranch_scc1 Lr_5
    s_barrier
Lr_5:
    s_nop 0
    ds_read2_b32 v[64:65], v107 offset0:32 offset1:33
    ds_read2_b32 v[66:67], v107 offset0:34 offset1:35
    ds_read_b64 v[56:57], v106 offset:0
    ds_read_b64 v[58:59], v106 offset:192
    ds_read_b64 v[60:61], v106 offset:784
    ds_read_b64 v[62:63], v106 offset:976
    s_waitcnt lgkmcnt(6)
    s_nop 0
    v_smfmac_f32_32x32x32_bf16 v[240:255], v[76:79], v[68:75], v108
    ds_read2_b32 v[76:77], v107 offset0:228 offset1:229
    ds_read2_b32 v[78:79], v107 offset0:230 offset1:231
    ds_read_b64 v[68:69], v106 offset:8
    ds_read_b64 v[70:71], v106 offset:200
    ds_read_b64 v[72:73], v106 offset:792
    ds_read_b64 v[74:75], v106 offset:984
    s_waitcnt lgkmcnt(6)
    s_nop 0
    v_smfmac_f32_32x32x32_bf16 v[160:175], v[64:67], v[56:63], v108
    ds_read2_b32 v[64:65], v92 offset0:32 offset1:33
    ds_read2_b32 v[66:67], v92 offset0:34 offset1:35
    ds_read_b64 v[56:57], v106 offset:16
    ds_read_b64 v[58:59], v106 offset:208
    ds_read_b64 v[60:61], v106 offset:800
    ds_read_b64 v[62:63], v106 offset:992
    s_waitcnt lgkmcnt(6)
    s_nop 0
    v_smfmac_f32_32x32x32_bf16 v[176:191], v[76:79], v[68:75], v108
    ds_read2_b32 v[76:77], v92 offset0:228 offset1:229
    ds_read2_b32 v[78:79], v92 offset0:230 offset1:231
    ds_read_b64 v[68:69], v106 offset:24
    ds_read_b64 v[70:71], v106 offset:216
    ds_read_b64 v[72:73], v106 offset:808
    ds_read_b64 v[74:75], v106 offset:1000
    s_waitcnt lgkmcnt(6)
    s_nop 0
    v_smfmac_f32_32x32x32_bf16 v[192:207], v[64:67], v[56:63], v108
    ds_read2_b32 v[64:65], v93 offset0:32 offset1:33
    ds_read2_b32 v[66:67], v93 offset0:34 offset1:35
    ds_read_b64 v[56:57], v106 offset:32
    ds_read_b64 v[58:59], v106 offset:224
    ds_read_b64 v[60:61], v106 offset:816
    ds_read_b64 v[62:63], v106 offset:1008
    s_waitcnt lgkmcnt(6)
    s_nop 0
    v_smfmac_f32_32x32x32_bf16 v[208:223], v[76:79], v[68:75], v108
    ds_read2_b32 v[76:77], v93 offset0:228 offset1:229
    ds_read2_b32 v[78:79], v93 offset0:230 offset1:231
    ds_read_b64 v[68:69], v106 offset:40
    ds_read_b64 v[70:71], v106 offset:232
    ds_read_b64 v[72:73], v106 offset:824
    ds_read_b64 v[74:75], v106 offset:1016
    s_cmp_eq_u32 s36, 0
    s_cbranch_scc1 Lt_6
    s_barrier
    s_nop 0
    s_sub_u32 s41, 82816, s41
Lt_6:
    s_waitcnt lgkmcnt(6)
    s_nop 0
    v_smfmac_f32_32x32x32_bf16 v[224:239], v[64:67], v[56:63], v108
    ds_read2_b32 v[64:65], v107 offset0:40 offset1:41
    ds_read2_b32 v[66:67], v107 offset0:42 offset1:43
    ds_read_b64 v[56:57], v106 offset:7104
    ds_read_b64 v[58:59], v106 offset:7296
    ds_read_b64 v[60:61], v106 offset:7888
    ds_read_b64 v[62:63], v106 offset:8080
    s_waitcnt lgkmcnt(6)
    s_nop 0
    v_smfmac_f32_32x32x32_bf16 v[240:255], v[76:79], v[68:75], v108
    ds_read2_b32 v[76:77], v107 offset0:236 offset1:237
    ds_read2_b32 v[78:79], v107 offset0:238 offset1:239
    ds_read_b64 v[68:69], v106 offset:7112
    ds_read_b64 v[70:71], v106 offset:7304
    ds_read_b64 v[72:73], v106 offset:7896
    ds_read_b64 v[74:75], v106 offset:8088
    s_waitcnt lgkmcnt(6)
    s_nop 0
    v_smfmac_f32_32x32x32_bf16 v[160:175], v[64:67], v[56:63], v108
    ds_read2_b32 v[64:65], v92 offset0:40 offset1:41
    ds_read2_b32 v[66:67], v92 offset0:42 offset1:43
    ds_read_b64 v[56:57], v106 offset:7120
    ds_read_b64 v[58:59], v106 offset:7312
    ds_read_b64 v[60:61], v106 offset:7904
    ds_read_b64 v[62:63], v106 offset:8096
    s_waitcnt lgkmcnt(6)
    s_nop 0
    v_smfmac_f32_32x32x32_bf16 v[176:191], v[76:79], v[68:75], v108
    ds_read2_b32 v[76:77], v92 offset0:236 offset1:237
    ds_read2_b32 v[78:79], v92 offset0:238 offset1:239
    ds_read_b64 v[68:69], v106 offset:7128
    ds_read_b64 v[70:71], v106 offset:7320
    ds_read_b64 v[72:73], v106 offset:7912
    ds_read_b64 v[74:75], v106 offset:8104
    s_waitcnt lgkmcnt(6)
    s_nop 0
    v_smfmac_f32_32x32x32_bf16 v[192:207], v[64:67], v[56:63], v108
    ds_read2_b32 v[64:65], v93 offset0:40 offset1:41
    ds_read2_b32 v[66:67], v93 offset0:42 offset1:43
    ds_read_b64 v[56:57], v106 offset:7136
    ds_read_b64 v[58:59], v106 offset:7328
    ds_read_b64 v[60:61], v106 offset:7920
    ds_read_b64 v[62:63], v106 offset:8112
    s_waitcnt lgkmcnt(6)
    s_nop 0
    v_smfmac_f32_32x32x32_bf16 v[208:223], v[76:79], v[68:75], v108
    ds_read2_b32 v[76:77], v93 offset0:236 offset1:237
    ds_read2_b32 v[78:79], v93 offset0:238 offset1:239
    ds_read_b64 v[68:69], v106 offset:7144
    ds_read_b64 v[70:71], v106 offset:7336
    ds_read_b64 v[72:73], v106 offset:7928
    ds_read_b64 v[74:75], v106 offset:8120
    s_waitcnt lgkmcnt(6)
    s_nop 0
    v_smfmac_f32_32x32x32_bf16 v[224:239], v[64:67], v[56:63], v108
    ds_read_b64 v[32:33], v109 offset:0
    ds_read_b64 v[34:35], v109 offset:8
    ds_read_b64 v[36:37], v109 offset:32
    ds_read_b64 v[38:39], v109 offset:40
    ds_read_b64 v[40:41], v109 offset:64
    ds_read_b64 v[42:43], v109 offset:72
    ds_read_b64 v[44:45], v109 offset:96
    ds_read_b64 v[46:47], v109 offset:104
    ds_read_b64 v[48:49], v109 offset:128
    s_waitcnt lgkmcnt(8)
    s_nop 0
    ds_read_b64 v[50:51], v109 offset:136
    ds_read_b64 v[52:53], v109 offset:160
    ds_read_b64 v[54:55], v109 offset:168
    ds_read_b64 v[92:93], v109 offset:7104
    ds_read_b64 v[94:95], v109 offset:7112
    ds_read_b64 v[96:97], v109 offset:7136
    ds_read_b64 v[98:99], v109 offset:7144
    s_waitcnt lgkmcnt(8)
    s_nop 0
    ds_read_b64 v[100:101], v109 offset:7168
    ds_read_b64 v[102:103], v109 offset:7176
    ds_read_b64 v[80:81], v109 offset:7200
    ds_read_b64 v[82:83], v109 offset:7208
    ds_read_b64 v[84:85], v109 offset:7232
    ds_read_b64 v[86:87], v109 offset:7240
    ds_read_b64 v[88:89], v109 offset:7264
    s_waitcnt lgkmcnt(8)
    s_nop 0
    ds_read_b64 v[90:91], v109 offset:7272
    v_smfmac_f32_32x32x32_bf16 v[240:255], v[76:79], v[68:75], v108
    s_mov_b32 s22, 50331648
    s_mov_b32 s87, 1572864
    v_pk_add_f32 v[56:57], v[160:161], v[162:163]
    v_pk_mul_f32 v[64:65], v[160:161], v[160:161]
    v_pk_fma_f32 v[64:65], v[162:163], v[162:163], v[64:65]
    v_pk_add_f32 v[58:59], v[164:165], v[166:167]
    v_pk_mul_f32 v[66:67], v[164:165], v[164:165]
    v_pk_fma_f32 v[66:67], v[166:167], v[166:167], v[66:67]
    v_pk_add_f32 v[60:61], v[168:169], v[170:171]
    v_pk_mul_f32 v[68:69], v[168:169], v[168:169]
    v_pk_fma_f32 v[68:69], v[170:171], v[170:171], v[68:69]
    v_pk_add_f32 v[62:63], v[172:173], v[174:175]
    v_pk_mul_f32 v[70:71], v[172:173], v[172:173]
    v_pk_fma_f32 v[70:71], v[174:175], v[174:175], v[70:71]
    v_pk_add_f32 v[56:57], v[56:57], v[176:177]
    v_pk_fma_f32 v[64:65], v[176:177], v[176:177], v[64:65]
    v_pk_add_f32 v[56:57], v[56:57], v[178:179]
    v_pk_fma_f32 v[64:65], v[178:179], v[178:179], v[64:65]
    v_pk_add_f32 v[58:59], v[58:59], v[180:181]
    v_pk_fma_f32 v[66:67], v[180:181], v[180:181], v[66:67]
    v_pk_add_f32 v[58:59], v[58:59], v[182:183]
    v_pk_fma_f32 v[66:67], v[182:183], v[182:183], v[66:67]
    v_pk_add_f32 v[60:61], v[60:61], v[184:185]
    v_pk_fma_f32 v[68:69], v[184:185], v[184:185], v[68:69]
    v_pk_add_f32 v[60:61], v[60:61], v[186:187]
    v_pk_fma_f32 v[68:69], v[186:187], v[186:187], v[68:69]
    v_pk_add_f32 v[62:63], v[62:63], v[188:189]
    v_pk_fma_f32 v[70:71], v[188:189], v[188:189], v[70:71]
    v_pk_add_f32 v[62:63], v[62:63], v[190:191]
    v_pk_fma_f32 v[70:71], v[190:191], v[190:191], v[70:71]
    v_pk_add_f32 v[56:57], v[56:57], v[192:193]
    v_pk_fma_f32 v[64:65], v[192:193], v[192:193], v[64:65]
    v_pk_add_f32 v[56:57], v[56:57], v[194:195]
    v_pk_fma_f32 v[64:65], v[194:195], v[194:195], v[64:65]
    v_pk_add_f32 v[58:59], v[58:59], v[196:197]
    v_pk_fma_f32 v[66:67], v[196:197], v[196:197], v[66:67]
    v_pk_add_f32 v[58:59], v[58:59], v[198:199]
    v_pk_fma_f32 v[66:67], v[198:199], v[198:199], v[66:67]
    v_pk_add_f32 v[60:61], v[60:61], v[200:201]
    v_pk_fma_f32 v[68:69], v[200:201], v[200:201], v[68:69]
    v_pk_add_f32 v[60:61], v[60:61], v[202:203]
    v_pk_fma_f32 v[68:69], v[202:203], v[202:203], v[68:69]
    v_pk_add_f32 v[62:63], v[62:63], v[204:205]
    v_pk_fma_f32 v[70:71], v[204:205], v[204:205], v[70:71]
    v_pk_add_f32 v[62:63], v[62:63], v[206:207]
    v_pk_fma_f32 v[70:71], v[206:207], v[206:207], v[70:71]
    v_pk_add_f32 v[56:57], v[56:57], v[208:209]
    v_pk_fma_f32 v[64:65], v[208:209], v[208:209], v[64:65]
    v_pk_add_f32 v[56:57], v[56:57], v[210:211]
    v_pk_fma_f32 v[64:65], v[210:211], v[210:211], v[64:65]
    v_pk_add_f32 v[58:59], v[58:59], v[212:213]
    v_pk_fma_f32 v[66:67], v[212:213], v[212:213], v[66:67]
    v_pk_add_f32 v[58:59], v[58:59], v[214:215]
    v_pk_fma_f32 v[66:67], v[214:215], v[214:215], v[66:67]
    v_pk_add_f32 v[60:61], v[60:61], v[216:217]
    v_pk_fma_f32 v[68:69], v[216:217], v[216:217], v[68:69]
    v_pk_add_f32 v[60:61], v[60:61], v[218:219]
    v_pk_fma_f32 v[68:69], v[218:219], v[218:219], v[68:69]
    v_pk_add_f32 v[62:63], v[62:63], v[220:221]
    v_pk_fma_f32 v[70:71], v[220:221], v[220:221], v[70:71]
    v_pk_add_f32 v[62:63], v[62:63], v[222:223]
    v_pk_fma_f32 v[70:71], v[222:223], v[222:223], v[70:71]
    v_pk_add_f32 v[56:57], v[56:57], v[224:225]
    v_pk_fma_f32 v[64:65], v[224:225], v[224:225], v[64:65]
    v_pk_add_f32 v[56:57], v[56:57], v[226:227]
    v_pk_fma_f32 v[64:65], v[226:227], v[226:227], v[64:65]
    v_pk_add_f32 v[58:59], v[58:59], v[228:229]
    v_pk_fma_f32 v[66:67], v[228:229], v[228:229], v[66:67]
    v_pk_add_f32 v[58:59], v[58:59], v[230:231]
    v_pk_fma_f32 v[66:67], v[230:231], v[230:231], v[66:67]
    v_pk_add_f32 v[60:61], v[60:61], v[232:233]
    v_pk_fma_f32 v[68:69], v[232:233], v[232:233], v[68:69]
    v_pk_add_f32 v[60:61], v[60:61], v[234:235]
    v_pk_fma_f32 v[68:69], v[234:235], v[234:235], v[68:69]
    v_pk_add_f32 v[62:63], v[62:63], v[236:237]
    v_pk_fma_f32 v[70:71], v[236:237], v[236:237], v[70:71]
    v_pk_add_f32 v[62:63], v[62:63], v[238:239]
    v_pk_fma_f32 v[70:71], v[238:239], v[238:239], v[70:71]
    v_pk_add_f32 v[56:57], v[56:57], v[240:241]
    v_pk_fma_f32 v[64:65], v[240:241], v[240:241], v[64:65]
    v_pk_add_f32 v[56:57], v[56:57], v[242:243]
    v_pk_fma_f32 v[64:65], v[242:243], v[242:243], v[64:65]
    v_pk_add_f32 v[58:59], v[58:59], v[244:245]
    v_pk_fma_f32 v[66:67], v[244:245], v[244:245], v[66:67]
    v_pk_add_f32 v[58:59], v[58:59], v[246:247]
    v_pk_fma_f32 v[66:67], v[246:247], v[246:247], v[66:67]
    v_pk_add_f32 v[60:61], v[60:61], v[248:249]
    v_pk_fma_f32 v[68:69], v[248:249], v[248:249], v[68:69]
    v_pk_add_f32 v[60:61], v[60:61], v[250:251]
    v_pk_fma_f32 v[68:69], v[250:251], v[250:251], v[68:69]
    v_pk_add_f32 v[62:63], v[62:63], v[252:253]
    v_pk_fma_f32 v[70:71], v[252:253], v[252:253], v[70:71]
    v_pk_add_f32 v[62:63], v[62:63], v[254:255]
    v_pk_fma_f32 v[70:71], v[254:255], v[254:255], v[70:71]
    v_add_f32 v24, v56, v57
    v_add_f32 v28, v64, v65
    v_add_f32 v25, v58, v59
    v_add_f32 v29, v66, v67
    v_add_f32 v26, v60, v61
    v_add_f32 v30, v68, v69
    v_add_f32 v27, v62, v63
    v_add_f32 v31, v70, v71
    s_waitcnt lgkmcnt(0)
    s_cmp_lg_u32 s56, 0
    s_cbranch_scc1 Ldry_ret
    s_branch Ljoin
Lw1wait:
    s_barrier
    s_nop 0
    ds_read_b32 v19, v18 offset:8
    s_waitcnt lgkmcnt(0)
    v_readfirstlane_b32 s3, v19
    s_cmp_eq_u32 s3, 1
    s_cbranch_scc1 Lw1wait_retP
    s_cmp_lt_u32 s37, 2
    s_cselect_b32 s24, s10, s12
    s_cselect_b32 s25, s11, s13
    s_nop 0
    s_cselect_b32 s43, 64, 6144
    s_mov_b32 s45, 1024
    s_cselect_b32 s45, 12288, s45
    s_cselect_b32 s42, 9, 8
    s_mul_i32 s42, s42, s43
    s_mul_i32 s44, s43, 12
    s_nop 0
    s_and_b32 s25, s25, 0xffff
    s_mov_b32 s26, 73728
    s_mov_b32 s27, 0x20000
    s_and_b32 s74, s37, 1
    s_mul_i32 s74, s74, 3
    s_mul_i32 s46, s74, s45
    v_lshrrev_b32 v20, 6, v14
    v_mul_u32_u24 v20, 768, v20
    v_and_b32 v21, 48, v14
    v_add_u32 v20, v20, v21
    s_cmp_lt_u32 s37, 2
    s_cselect_b64 vcc, -1, 0
    v_cndmask_b32 v11, v14, v20, vcc
    s_branch Lw1wait_retR
LouterP:
    s_lshl_b32 s71, s37, 1
    s_add_u32 s71, s71, s63
    s_add_u32 s71, s71, 0
    s_cmp_ge_u32 s71, 12
    s_cselect_b32 s72, 12, 0
    s_sub_u32 s71, s71, s72
    s_mul_i32 s55, s71, 7104
    s_lshl_b32 s71, s37, 1
    s_add_u32 s71, s71, s63
    s_add_u32 s71, s71, 2
    s_cmp_ge_u32 s71, 12
    s_cselect_b32 s72, 12, 0
    s_sub_u32 s71, s71, s72
    s_mul_i32 s54, s71, 7104
    s_add_u32 s71, s37, 1
    s_and_b32 s71, s71, 2
    s_lshl_b32 s71, s71, 2
    s_add_u32 s54, s54, s71
    s_mov_b32 s71, 7104
    v_bfe_u32 v22, v14, 7, 2
    v_lshlrev_b32 v22, 1, v22
    v_mov_b32 v20, 0
    v_mov_b32 v21, 0
    v_add_u32 v18, s63, v22
    v_subrev_u32 v19, 12, v18
    v_min_u32 v18, v18, v19
    v_mad_u32_u24 v18, v18, s71, v1
    v_and_b32_e64 v19, 4, v22
    v_lshl_add_u32 v104, v19, 1, v18
    v_add_u32 v22, 2, v22
    v_add_u32 v18, s63, v22
    v_subrev_u32 v19, 12, v18
    v_min_u32 v18, v18, v19
    v_mad_u32_u24 v18, v18, s71, v1
    v_and_b32_e64 v19, 4, v22
    v_lshl_add_u32 v105, v19, 1, v18
    v_add_u32 v22, 2, v22
    v_add_u32 v18, s63, v22
    v_subrev_u32 v19, 12, v18
    v_min_u32 v18, v18, v19
    v_mad_u32_u24 v18, v18, s71, v1
    v_and_b32_e64 v19, 4, v22
    v_lshl_add_u32 v106, v19, 1, v18
    v_mov_b32_e64 v107, v5
    v_bfe_u32 v108, v14, 4, 2
    v_mul_u32_u24 v108, 0x5555, v108
    v_add_u32 v109, s54, v3
    v_add_u32 v110, v104, v2
    v_add_u32 v111, s55, v4
    s_lshl_b32 s71, s37, 11
    v_add_u32 v22, s71, v14
    s_lshl_b32 s71, s36, 2
    s_add_u32 s71, s71, 29104
    v_mov_b32 v18, s71
    v_mov_b32 v23, 1
    s_waitcnt vmcnt(0)
    s_barrier
    s_sub_u32 s41, 82816, s41
    s_cmp_eq_u32 s36, 0
    s_cbranch_scc0 Lno_wP
    s_sub_u32 s78, 82816, s41
    s_add_u32 m0, s78, s88
    s_add_u32 s79, s42, s46
    buffer_load_dwordx4 v11, s[24:27], s79 offen sc1 lds
    s_add_u32 m0, m0, s89
    s_add_u32 s79, s79, s45
    buffer_load_dwordx4 v11, s[24:27], s79 offen sc1 lds
    s_add_u32 m0, m0, s89
    s_add_u32 s79, s79, s45
    buffer_load_dwordx4 v11, s[24:27], s79 offen sc1 lds
    s_add_u32 s42, s42, s43
    s_cmp_eq_u32 s42, s44
    s_cselect_b32 s42, 0, s42
    s_nop 0
    s_add_u32 s78, s78, 12288
    s_add_u32 m0, s78, s88
    s_add_u32 s79, s42, s46
    buffer_load_dwordx4 v11, s[24:27], s79 offen sc1 lds
    s_add_u32 m0, m0, s89
    s_add_u32 s79, s79, s45
    buffer_load_dwordx4 v11, s[24:27], s79 offen sc1 lds
    s_add_u32 m0, m0, s89
    s_add_u32 s79, s79, s45
    buffer_load_dwordx4 v11, s[24:27], s79 offen sc1 lds
    s_add_u32 s42, s42, s43
    s_cmp_eq_u32 s42, s44
    s_cselect_b32 s42, 0, s42
Lno_wP:
    s_cmp_eq_u32 s47, 0
    s_cbranch_scc1 Lc1
LconvP:
    s_setprio 3
    ds_read2_b32 v[64:65], v107 offset0:0 offset1:1
    ds_read2_b32 v[66:67], v107 offset0:2 offset1:3
    ds_read_b64 v[56:57], v104 offset:0
    ds_read_b64 v[58:59], v104 offset:192
    ds_read_b64 v[60:61], v104 offset:784
    ds_read_b64 v[62:63], v104 offset:976
    ds_read2_b32 v[76:77], v107 offset0:8 offset1:9
    ds_read2_b32 v[78:79], v107 offset0:10 offset1:11
    ds_read_b64 v[68:69], v104 offset:7104
    ds_read_b64 v[70:71], v104 offset:7296
    ds_read_b64 v[72:73], v104 offset:7888
    ds_read_b64 v[74:75], v104 offset:8080
    v_mfma_f32_32x32x16_f16 v[208:223], v[44:47], v[28:31], v[208:223]
    v_cvt_pk_bf16_f32 v112, v160, v161
    v_cvt_pk_bf16_f32 v113, v162, v163
    v_cvt_pk_bf16_f32 v114, v164, v165
    v_cvt_pk_bf16_f32 v115, v166, v167
    v_mfma_f32_32x32x16_f16 v[224:239], v[48:51], v[28:31], v[224:239]
    v_cvt_pk_bf16_f32 v116, v168, v169
    v_cvt_pk_bf16_f32 v117, v170, v171
    v_cvt_pk_bf16_f32 v118, v172, v173
    v_cvt_pk_bf16_f32 v119, v174, v175
    v_mfma_f32_32x32x16_f16 v[240:255], v[52:55], v[28:31], v[240:255]
    v_mfma_f32_32x32x8_bf16 v[160:175], v[20:21], v[20:21], 0
    s_waitcnt lgkmcnt(6)
    s_nop 0
    v_smfmac_f32_32x32x32_bf16 v[160:175], v[64:67], v[56:63], v108
    ds_read2_b32 v[64:65], v107 offset0:16 offset1:17
    ds_read2_b32 v[66:67], v107 offset0:18 offset1:19
    ds_read_b64 v[56:57], v105 offset:0
    ds_read_b64 v[58:59], v105 offset:192
    ds_read_b64 v[60:61], v105 offset:784
    ds_read_b64 v[62:63], v105 offset:976
    v_permlane16_swap_b32 v112, v116
    v_permlane16_swap_b32 v113, v117
    v_permlane16_swap_b32 v114, v118
    v_permlane16_swap_b32 v115, v119
    buffer_store_dwordx4 v[112:115], v6, s[20:23], s51 offen offset:0 sc0 sc1
    buffer_store_dwordx4 v[116:119], v6, s[20:23], s51 offen offset:3072 sc0 sc1
    s_waitcnt lgkmcnt(6)
    s_nop 0
    v_smfmac_f32_32x32x32_bf16 v[160:175], v[76:79], v[68:75], v108
    ds_read2_b32 v[76:77], v107 offset0:24 offset1:25
    ds_read2_b32 v[78:79], v107 offset0:26 offset1:27
    ds_read_b64 v[68:69], v105 offset:7104
    ds_read_b64 v[70:71], v105 offset:7296
    ds_read_b64 v[72:73], v105 offset:7888
    ds_read_b64 v[74:75], v105 offset:8080
    s_waitcnt lgkmcnt(6)
    s_nop 0
    v_smfmac_f32_32x32x32_bf16 v[160:175], v[64:67], v[56:63], v108
    ds_read2_b32 v[64:65], v107 offset0:32 offset1:33
    ds_read2_b32 v[66:67], v107 offset0:34 offset1:35
    ds_read_b64 v[56:57], v106 offset:0
    ds_read_b64 v[58:59], v106 offset:192
    ds_read_b64 v[60:61], v106 offset:784
    ds_read_b64 v[62:63], v106 offset:976
    v_cvt_pk_bf16_f32 v120, v176, v177
    v_cvt_pk_bf16_f32 v121, v178, v179
    v_cvt_pk_bf16_f32 v122, v180, v181
    v_cvt_pk_bf16_f32 v123, v182, v183
    v_cvt_pk_bf16_f32 v124, v184, v185
    v_cvt_pk_bf16_f32 v125, v186, v187
    v_cvt_pk_bf16_f32 v126, v188, v189
    v_cvt_pk_bf16_f32 v127, v190, v191
    s_waitcnt lgkmcnt(6)
    s_nop 0
    v_smfmac_f32_32x32x32_bf16 v[160:175], v[76:79], v[68:75], v108
    ds_read2_b32 v[76:77], v107 offset0:40 offset1:41
    ds_read2_b32 v[78:79], v107 offset0:42 offset1:43
    ds_read_b64 v[68:69], v106 offset:7104
    ds_read_b64 v[70:71], v106 offset:7296
    ds_read_b64 v[72:73], v106 offset:7888
    ds_read_b64 v[74:75], v106 offset:8080
    v_mfma_f32_32x32x8_bf16 v[176:191], v[20:21], v[20:21], 0
    s_waitcnt lgkmcnt(6)
    s_nop 0
    v_smfmac_f32_32x32x32_bf16 v[160:175], v[64:67], v[56:63], v108
    ds_read2_b32 v[64:65], v107 offset0:196 offset1:197
    ds_read2_b32 v[66:67], v107 offset0:198 offset1:199
    ds_read_b64 v[56:57], v104 offset:8
    ds_read_b64 v[58:59], v104 offset:200
    ds_read_b64 v[60:61], v104 offset:792
    ds_read_b64 v[62:63], v104 offset:984
    s_waitcnt lgkmcnt(6)
    s_nop 0
    v_smfmac_f32_32x32x32_bf16 v[160:175], v[76:79], v[68:75], v108
    ds_read2_b32 v[76:77], v107 offset0:204 offset1:205
    ds_read2_b32 v[78:79], v107 offset0:206 offset1:207
    ds_read_b64 v[68:69], v104 offset:7112
    ds_read_b64 v[70:71], v104 offset:7304
    ds_read_b64 v[72:73], v104 offset:7896
    ds_read_b64 v[74:75], v104 offset:8088
    s_waitcnt lgkmcnt(6)
    s_nop 0
    v_smfmac_f32_32x32x32_bf16 v[176:191], v[64:67], v[56:63], v108
    ds_read2_b32 v[64:65], v107 offset0:212 offset1:213
    ds_read2_b32 v[66:67], v107 offset0:214 offset1:215
    ds_read_b64 v[56:57], v105 offset:8
    ds_read_b64 v[58:59], v105 offset:200
    ds_read_b64 v[60:61], v105 offset:792
    ds_read_b64 v[62:63], v105 offset:984
    v_permlane16_swap_b32 v120, v124
    v_permlane16_swap_b32 v121, v125
    v_permlane16_swap_b32 v122, v126
    v_permlane16_swap_b32 v123, v127
    buffer_store_dwordx4 v[120:123], v6, s[20:23], s51 offen offset:64 sc0 sc1
    buffer_store_dwordx4 v[124:127], v6, s[20:23], s51 offen offset:3136 sc0 sc1
    s_waitcnt lgkmcnt(6)
    s_nop 0
    v_smfmac_f32_32x32x32_bf16 v[176:191], v[76:79], v[68:75], v108
    ds_read2_b32 v[76:77], v107 offset0:220 offset1:221
    ds_read2_b32 v[78:79], v107 offset0:222 offset1:223
    ds_read_b64 v[68:69], v105 offset:7112
    ds_read_b64 v[70:71], v105 offset:7304
    ds_read_b64 v[72:73], v105 offset:7896
    ds_read_b64 v[74:75], v105 offset:8088
    s_waitcnt lgkmcnt(6)
    s_nop 0
    v_smfmac_f32_32x32x32_bf16 v[176:191], v[64:67], v[56:63], v108
    ds_read2_b32 v[64:65], v107 offset0:228 offset1:229
    ds_read2_b32 v[66:67], v107 offset0:230 offset1:231
    ds_read_b64 v[56:57], v106 offset:8
    ds_read_b64 v[58:59], v106 offset:200
    ds_read_b64 v[60:61], v106 offset:792
    ds_read_b64 v[62:63], v106 offset:984
    v_cvt_pk_bf16_f32 v128, v192, v193
    v_cvt_pk_bf16_f32 v129, v194, v195
    v_cvt_pk_bf16_f32 v130, v196, v197
    v_cvt_pk_bf16_f32 v131, v198, v199
    v_cvt_pk_bf16_f32 v132, v200, v201
    v_cvt_pk_bf16_f32 v133, v202, v203
    v_cvt_pk_bf16_f32 v134, v204, v205
    v_cvt_pk_bf16_f32 v135, v206, v207
    s_waitcnt lgkmcnt(6)
    s_nop 0
    v_smfmac_f32_32x32x32_bf16 v[176:191], v[76:79], v[68:75], v108
    ds_read2_b32 v[76:77], v107 offset0:236 offset1:237
    ds_read2_b32 v[78:79], v107 offset0:238 offset1:239
    ds_read_b64 v[68:69], v106 offset:7112
    ds_read_b64 v[70:71], v106 offset:7304
    ds_read_b64 v[72:73], v106 offset:7896
    ds_read_b64 v[74:75], v106 offset:8088
    v_mfma_f32_32x32x8_bf16 v[192:207], v[20:21], v[20:21], 0
    v_add_u32 v107, 1568, v107
    s_waitcnt lgkmcnt(6)
    s_nop 0
    v_smfmac_f32_32x32x32_bf16 v[176:191], v[64:67], v[56:63], v108
    ds_read2_b32 v[64:65], v107 offset0:0 offset1:1
    ds_read2_b32 v[66:67], v107 offset0:2 offset1:3
    ds_read_b64 v[56:57], v104 offset:16
    ds_read_b64 v[58:59], v104 offset:208
    ds_read_b64 v[60:61], v104 offset:800
    ds_read_b64 v[62:63], v104 offset:992
    s_waitcnt lgkmcnt(6)
    s_nop 0
    v_smfmac_f32_32x32x32_bf16 v[176:191], v[76:79], v[68:75], v108
    ds_read2_b32 v[76:77], v107 offset0:8 offset1:9
    ds_read2_b32 v[78:79], v107 offset0:10 offset1:11
    ds_read_b64 v[68:69], v104 offset:7120
    ds_read_b64 v[70:71], v104 offset:7312
    ds_read_b64 v[72:73], v104 offset:7904
    ds_read_b64 v[74:75], v104 offset:8096
    s_waitcnt lgkmcnt(6)
    s_nop 0
    v_smfmac_f32_32x32x32_bf16 v[192:207], v[64:67], v[56:63], v108
    ds_read2_b32 v[64:65], v107 offset0:16 offset1:17
    ds_read2_b32 v[66:67], v107 offset0:18 offset1:19
    ds_read_b64 v[56:57], v105 offset:16
    ds_read_b64 v[58:59], v105 offset:208
    ds_read_b64 v[60:61], v105 offset:800
    ds_read_b64 v[62:63], v105 offset:992
    v_permlane16_swap_b32 v128, v132
    v_permlane16_swap_b32 v129, v133
    v_permlane16_swap_b32 v130, v134
    v_permlane16_swap_b32 v131, v135
    buffer_store_dwordx4 v[128:131], v6, s[20:23], s51 offen offset:128 sc0 sc1
    buffer_store_dwordx4 v[132:135], v6, s[20:23], s51 offen offset:3200 sc0 sc1
    s_waitcnt lgkmcnt(6)
    s_nop 0
    v_smfmac_f32_32x32x32_bf16 v[192:207], v[76:79], v[68:75], v108
    ds_read2_b32 v[76:77], v107 offset0:24 offset1:25
    ds_read2_b32 v[78:79], v107 offset0:26 offset1:27
    ds_read_b64 v[68:69], v105 offset:7120
    ds_read_b64 v[70:71], v105 offset:7312
    ds_read_b64 v[72:73], v105 offset:7904
    ds_read_b64 v[74:75], v105 offset:8096
    s_waitcnt lgkmcnt(6)
    s_nop 0
    v_smfmac_f32_32x32x32_bf16 v[192:207], v[64:67], v[56:63], v108
    ds_read2_b32 v[64:65], v107 offset0:32 offset1:33
    ds_read2_b32 v[66:67], v107 offset0:34 offset1:35
    ds_read_b64 v[56:57], v106 offset:16
    ds_read_b64 v[58:59], v106 offset:208
    ds_read_b64 v[60:61], v106 offset:800
    ds_read_b64 v[62:63], v106 offset:992
    v_cvt_pk_bf16_f32 v136, v208, v209
    v_cvt_pk_bf16_f32 v137, v210, v211
    v_cvt_pk_bf16_f32 v138, v212, v213
    v_cvt_pk_bf16_f32 v139, v214, v215
    v_cvt_pk_bf16_f32 v140, v216, v217
    v_cvt_pk_bf16_f32 v141, v218, v219
    v_cvt_pk_bf16_f32 v142, v220, v221
    v_cvt_pk_bf16_f32 v143, v222, v223
    s_waitcnt lgkmcnt(6)
    s_nop 0
    v_smfmac_f32_32x32x32_bf16 v[192:207], v[76:79], v[68:75], v108
    ds_read2_b32 v[76:77], v107 offset0:40 offset1:41
    ds_read2_b32 v[78:79], v107 offset0:42 offset1:43
    ds_read_b64 v[68:69], v106 offset:7120
    ds_read_b64 v[70:71], v106 offset:7312
    ds_read_b64 v[72:73], v106 offset:7904
    ds_read_b64 v[74:75], v106 offset:8096
    v_mfma_f32_32x32x8_bf16 v[208:223], v[20:21], v[20:21], 0
    s_waitcnt lgkmcnt(6)
    s_nop 0
    v_smfmac_f32_32x32x32_bf16 v[192:207], v[64:67], v[56:63], v108
    ds_read2_b32 v[64:65], v107 offset0:196 offset1:197
    ds_read2_b32 v[66:67], v107 offset0:198 offset1:199
    ds_read_b64 v[56:57], v104 offset:24
    ds_read_b64 v[58:59], v104 offset:216
    ds_read_b64 v[60:61], v104 offset:808
    ds_read_b64 v[62:63], v104 offset:1000
    s_waitcnt lgkmcnt(6)
    s_nop 0
    v_smfmac_f32_32x32x32_bf16 v[192:207], v[76:79], v[68:75], v108
    ds_read2_b32 v[76:77], v107 offset0:204 offset1:205
    ds_read2_b32 v[78:79], v107 offset0:206 offset1:207
    ds_read_b64 v[68:69], v104 offset:7128
    ds_read_b64 v[70:71], v104 offset:7320
    ds_read_b64 v[72:73], v104 offset:7912
    ds_read_b64 v[74:75], v104 offset:8104
    s_cmp_lg_u32 s56, 0
    s_cbranch_scc1 Ldry_ret
Ldry1:
    s_waitcnt lgkmcnt(6)
    s_nop 0
    v_smfmac_f32_32x32x32_bf16 v[208:223], v[64:67], v[56:63], v108
    ds_read2_b32 v[64:65], v107 offset0:212 offset1:213
    ds_read2_b32 v[66:67], v107 offset0:214 offset1:215
    ds_read_b64 v[56:57], v105 offset:24
    ds_read_b64 v[58:59], v105 offset:216
    ds_read_b64 v[60:61], v105 offset:808
    ds_read_b64 v[62:63], v105 offset:1000
    v_permlane16_swap_b32 v136, v140
    v_permlane16_swap_b32 v137, v141
    v_permlane16_swap_b32 v138, v142
    v_permlane16_swap_b32 v139, v143
    buffer_store_dwordx4 v[136:139], v6, s[20:23], s52 offen offset:0 sc0 sc1
    buffer_store_dwordx4 v[140:143], v6, s[20:23], s52 offen offset:3072 sc0 sc1
    s_waitcnt lgkmcnt(6)
    s_nop 0
    v_smfmac_f32_32x32x32_bf16 v[208:223], v[76:79], v[68:75], v108
    ds_read2_b32 v[76:77], v107 offset0:220 offset1:221
    ds_read2_b32 v[78:79], v107 offset0:222 offset1:223
    ds_read_b64 v[68:69], v105 offset:7128
    ds_read_b64 v[70:71], v105 offset:7320
    ds_read_b64 v[72:73], v105 offset:7912
    ds_read_b64 v[74:75], v105 offset:8104
    s_waitcnt lgkmcnt(6)
    s_nop 0
    v_smfmac_f32_32x32x32_bf16 v[208:223], v[64:67], v[56:63], v108
    ds_read2_b32 v[64:65], v107 offset0:228 offset1:229
    ds_read2_b32 v[66:67], v107 offset0:230 offset1:231
    ds_read_b64 v[56:57], v106 offset:24
    ds_read_b64 v[58:59], v106 offset:216
    ds_read_b64 v[60:61], v106 offset:808
    ds_read_b64 v[62:63], v106 offset:1000
    v_cvt_pk_bf16_f32 v144, v224, v225
    v_cvt_pk_bf16_f32 v145, v226, v227
    v_cvt_pk_bf16_f32 v146, v228, v229
    v_cvt_pk_bf16_f32 v147, v230, v231
    v_cvt_pk_bf16_f32 v148, v232, v233
    v_cvt_pk_bf16_f32 v149, v234, v235
    v_cvt_pk_bf16_f32 v150, v236, v237
    v_cvt_pk_bf16_f32 v151, v238, v239
    s_waitcnt lgkmcnt(6)
    s_nop 0
    v_smfmac_f32_32x32x32_bf16 v[208:223], v[76:79], v[68:75], v108
    ds_read2_b32 v[76:77], v107 offset0:236 offset1:237
    ds_read2_b32 v[78:79], v107 offset0:238 offset1:239
    ds_read_b64 v[68:69], v106 offset:7128
    ds_read_b64 v[70:71], v106 offset:7320
    ds_read_b64 v[72:73], v106 offset:7912
    ds_read_b64 v[74:75], v106 offset:8104
    v_mfma_f32_32x32x8_bf16 v[224:239], v[20:21], v[20:21], 0
    v_add_u32 v107, 1568, v107
    s_waitcnt lgkmcnt(6)
    s_nop 0
    v_smfmac_f32_32x32x32_bf16 v[208:223], v[64:67], v[56:63], v108
    ds_read2_b32 v[64:65], v107 offset0:0 offset1:1
    ds_read2_b32 v[66:67], v107 offset0:2 offset1:3
    ds_read_b64 v[56:57], v104 offset:32
    ds_read_b64 v[58:59], v104 offset:224
    ds_read_b64 v[60:61], v104 offset:816
    ds_read_b64 v[62:63], v104 offset:1008
    s_waitcnt lgkmcnt(6)
    s_nop 0
    v_smfmac_f32_32x32x32_bf16 v[208:223], v[76:79], v[68:75], v108
    ds_read2_b32 v[76:77], v107 offset0:8 offset1:9
    ds_read2_b32 v[78:79], v107 offset0:10 offset1:11
    ds_read_b64 v[68:69], v104 offset:7136
    ds_read_b64 v[70:71], v104 offset:7328
    ds_read_b64 v[72:73], v104 offset:7920
    ds_read_b64 v[74:75], v104 offset:8112
    s_waitcnt lgkmcnt(6)
    s_nop 0
    v_smfmac_f32_32x32x32_bf16 v[224:239], v[64:67], v[56:63], v108
    ds_read2_b32 v[64:65], v107 offset0:16 offset1:17
    ds_read2_b32 v[66:67], v107 offset0:18 offset1:19
    ds_read_b64 v[56:57], v105 offset:32
    ds_read_b64 v[58:59], v105 offset:224
    ds_read_b64 v[60:61], v105 offset:816
    ds_read_b64 v[62:63], v105 offset:1008
    v_permlane16_swap_b32 v144, v148
    v_permlane16_swap_b32 v145, v149
    v_permlane16_swap_b32 v146, v150
    v_permlane16_swap_b32 v147, v151
    buffer_store_dwordx4 v[144:147], v6, s[20:23], s52 offen offset:64 sc0 sc1
    buffer_store_dwordx4 v[148:151], v6, s[20:23], s52 offen offset:3136 sc0 sc1
    s_waitcnt lgkmcnt(6)
    s_nop 0
    v_smfmac_f32_32x32x32_bf16 v[224:239], v[76:79], v[68:75], v108
    ds_read2_b32 v[76:77], v107 offset0:24 offset1:25
    ds_read2_b32 v[78:79], v107 offset0:26 offset1:27
    ds_read_b64 v[68:69], v105 offset:7136
    ds_read_b64 v[70:71], v105 offset:7328
    ds_read_b64 v[72:73], v105 offset:7920
    ds_read_b64 v[74:75], v105 offset:8112
    s_waitcnt lgkmcnt(6)
    s_nop 0
    v_smfmac_f32_32x32x32_bf16 v[224:239], v[64:67], v[56:63], v108
    ds_read2_b32 v[64:65], v107 offset0:32 offset1:33
    ds_read2_b32 v[66:67], v107 offset0:34 offset1:35
    ds_read_b64 v[56:57], v106 offset:32
    ds_read_b64 v[58:59], v106 offset:224
    ds_read_b64 v[60:61], v106 offset:816
    ds_read_b64 v[62:63], v106 offset:1008
    v_cvt_pk_bf16_f32 v152, v240, v241
    v_cvt_pk_bf16_f32 v153, v242, v243
    v_cvt_pk_bf16_f32 v154, v244, v245
    v_cvt_pk_bf16_f32 v155, v246, v247
    v_cvt_pk_bf16_f32 v156, v248, v249
    v_cvt_pk_bf16_f32 v157, v250, v251
    v_cvt_pk_bf16_f32 v158, v252, v253
    v_cvt_pk_bf16_f32 v159, v254, v255
    s_waitcnt lgkmcnt(6)
    s_nop 0
    v_smfmac_f32_32x32x32_bf16 v[224:239], v[76:79], v[68:75], v108
    ds_read2_b32 v[76:77], v107 offset0:40 offset1:41
    ds_read2_b32 v[78:79], v107 offset0:42 offset1:43
    ds_read_b64 v[68:69], v106 offset:7136
    ds_read_b64 v[70:71], v106 offset:7328
    ds_read_b64 v[72:73], v106 offset:7920
    ds_read_b64 v[74:75], v106 offset:8112
    v_mfma_f32_32x32x8_bf16 v[240:255], v[20:21], v[20:21], 0
    s_waitcnt lgkmcnt(6)
    s_nop 0
    v_smfmac_f32_32x32x32_bf16 v[224:239], v[64:67], v[56:63], v108
    ds_read2_b32 v[64:65], v107 offset0:196 offset1:197
    ds_read2_b32 v[66:67], v107 offset0:198 offset1:199
    ds_read_b64 v[56:57], v104 offset:40
    ds_read_b64 v[58:59], v104 offset:232
    ds_read_b64 v[60:61], v104 offset:824
    ds_read_b64 v[62:63], v104 offset:1016
    s_waitcnt lgkmcnt(6)
    s_nop 0
    v_smfmac_f32_32x32x32_bf16 v[224:239], v[76:79], v[68:75], v108
    ds_read2_b32 v[76:77], v107 offset0:204 offset1:205
    ds_read2_b32 v[78:79], v107 offset0:206 offset1:207
    ds_read_b64 v[68:69], v104 offset:7144
    ds_read_b64 v[70:71], v104 offset:7336
    ds_read_b64 v[72:73], v104 offset:7928
    ds_read_b64 v[74:75], v104 offset:8120
    s_waitcnt lgkmcnt(6)
    s_nop 0
    v_smfmac_f32_32x32x32_bf16 v[240:255], v[64:67], v[56:63], v108
    ds_read2_b32 v[64:65], v107 offset0:212 offset1:213
    ds_read2_b32 v[66:67], v107 offset0:214 offset1:215
    ds_read_b64 v[56:57], v105 offset:40
    ds_read_b64 v[58:59], v105 offset:232
    ds_read_b64 v[60:61], v105 offset:824
    ds_read_b64 v[62:63], v105 offset:1016
    v_permlane16_swap_b32 v152, v156
    v_permlane16_swap_b32 v153, v157
    v_permlane16_swap_b32 v154, v158
    v_permlane16_swap_b32 v155, v159
    buffer_store_dwordx4 v[152:155], v6, s[20:23], s52 offen offset:128 sc0 sc1
    buffer_store_dwordx4 v[156:159], v6, s[20:23], s52 offen offset:3200 sc0 sc1
    s_waitcnt lgkmcnt(6)
    s_nop 0
    v_smfmac_f32_32x32x32_bf16 v[240:255], v[76:79], v[68:75], v108
    ds_read2_b32 v[76:77], v107 offset0:220 offset1:221
    ds_read2_b32 v[78:79], v107 offset0:222 offset1:223
    ds_read_b64 v[68:69], v105 offset:7144
    ds_read_b64 v[70:71], v105 offset:7336
    ds_read_b64 v[72:73], v105 offset:7928
    ds_read_b64 v[74:75], v105 offset:8120
    s_waitcnt lgkmcnt(6)
    s_nop 0
    v_smfmac_f32_32x32x32_bf16 v[240:255], v[64:67], v[56:63], v108
    ds_read2_b32 v[64:65], v107 offset0:228 offset1:229
    ds_read2_b32 v[66:67], v107 offset0:230 offset1:231
    ds_read_b64 v[56:57], v106 offset:40
    ds_read_b64 v[58:59], v106 offset:232
    ds_read_b64 v[60:61], v106 offset:824
    ds_read_b64 v[62:63], v106 offset:1016
    s_or_b32 s71, s65, s56
    s_cbranch_scc1 Lm_1
    s_waitcnt vmcnt(12)
    s_barrier
    s_sub_u32 s41, 82816, s41
    s_cmp_eq_u32 s36, 0
    s_cbranch_scc0 Lm_1
    s_sub_u32 s78, 82816, s41
    s_add_u32 m0, s78, s88
    s_add_u32 s79, s42, s46
    buffer_load_dwordx4 v11, s[24:27], s79 offen sc1 lds
    s_add_u32 m0, m0, s89
    s_add_u32 s79, s79, s45
    buffer_load_dwordx4 v11, s[24:27], s79 offen sc1 lds
    s_add_u32 m0, m0, s89
    s_add_u32 s79, s79, s45
    buffer_load_dwordx4 v11, s[24:27], s79 offen sc1 lds
    s_add_u32 s42, s42, s43
    s_cmp_eq_u32 s42, s44
    s_cselect_b32 s42, 0, s42
    s_nop 0
    s_add_u32 s78, s78, 12288
    s_add_u32 m0, s78, s88
    s_add_u32 s79, s42, s46
    buffer_load_dwordx4 v11, s[24:27], s79 offen sc1 lds
    s_add_u32 m0, m0, s89
    s_add_u32 s79, s79, s45
    buffer_load_dwordx4 v11, s[24:27], s79 offen sc1 lds
    s_add_u32 m0, m0, s89
    s_add_u32 s79, s79, s45
    buffer_load_dwordx4 v11, s[24:27], s79 offen sc1 lds
    s_add_u32 s42, s42, s43
    s_cmp_eq_u32 s42, s44
    s_cselect_b32 s42, 0, s42
Lm_1:
    s_waitcnt lgkmcnt(6)
    v_smfmac_f32_32x32x32_bf16 v[240:255], v[76:79], v[68:75], v108
    ds_read2_b32 v[76:77], v107 offset0:236 offset1:237
    ds_read2_b32 v[78:79], v107 offset0:238 offset1:239
    ds_read_b64 v[68:69], v106 offset:7144
    ds_read_b64 v[70:71], v106 offset:7336
    ds_read_b64 v[72:73], v106 offset:7928
    ds_read_b64 v[74:75], v106 offset:8120
    s_waitcnt lgkmcnt(6)
    s_nop 0
    v_smfmac_f32_32x32x32_bf16 v[240:255], v[64:67], v[56:63], v108
    ds_read_b64 v[32:33], v109 offset:0
    ds_read_b64 v[34:35], v109 offset:8
    ds_read_b64 v[36:37], v109 offset:32
    ds_read_b64 v[38:39], v109 offset:40
    ds_read_b64 v[40:41], v109 offset:64
    ds_read_b64 v[42:43], v109 offset:72
    s_waitcnt lgkmcnt(6)
    s_nop 0
    v_smfmac_f32_32x32x32_bf16 v[240:255], v[76:79], v[68:75], v108
    ds_read_b64 v[44:45], v109 offset:96
    ds_read_b64 v[46:47], v109 offset:104
    ds_read_b64 v[48:49], v109 offset:128
    ds_read_b64 v[50:51], v109 offset:136
    ds_read_b64 v[52:53], v109 offset:160
    ds_read_b64 v[54:55], v109 offset:168
    ds_read_b64 v[92:93], v109 offset:7104
    ds_read_b64 v[94:95], v109 offset:7112
    ds_read_b64 v[96:97], v109 offset:7136
    s_waitcnt lgkmcnt(8)
    s_nop 0
    ds_read_b64 v[98:99], v109 offset:7144
    ds_read_b64 v[100:101], v109 offset:7168
    ds_read_b64 v[102:103], v109 offset:7176
    ds_read_b64 v[80:81], v109 offset:7200
    ds_read_b64 v[82:83], v109 offset:7208
    ds_read_b64 v[84:85], v109 offset:7232
    ds_read_b64 v[86:87], v109 offset:7240
    s_waitcnt lgkmcnt(8)
    s_nop 0
    ds_read_b64 v[88:89], v109 offset:7264
    ds_read_b64 v[90:91], v109 offset:7272
    s_add_u32 s51, s51, s87
    s_nop 0
    s_add_u32 s52, s51, 98304
    s_mov_b32 s22, 50331648
    s_mov_b32 s87, 1572864
    v_pk_add_f32 v[56:57], v[160:161], v[162:163]
    v_pk_mul_f32 v[64:65], v[160:161], v[160:161]
    v_pk_fma_f32 v[64:65], v[162:163], v[162:163], v[64:65]
    v_pk_add_f32 v[58:59], v[164:165], v[166:167]
    v_pk_mul_f32 v[66:67], v[164:165], v[164:165]
    v_pk_fma_f32 v[66:67], v[166:167], v[166:167], v[66:67]
    v_pk_add_f32 v[60:61], v[168:169], v[170:171]
    v_pk_mul_f32 v[68:69], v[168:169], v[168:169]
    v_pk_fma_f32 v[68:69], v[170:171], v[170:171], v[68:69]
    v_pk_add_f32 v[62:63], v[172:173], v[174:175]
    v_pk_mul_f32 v[70:71], v[172:173], v[172:173]
    v_pk_fma_f32 v[70:71], v[174:175], v[174:175], v[70:71]
    v_pk_add_f32 v[56:57], v[56:57], v[176:177]
    v_pk_fma_f32 v[64:65], v[176:177], v[176:177], v[64:65]
    v_pk_add_f32 v[56:57], v[56:57], v[178:179]
    v_pk_fma_f32 v[64:65], v[178:179], v[178:179], v[64:65]
    v_pk_add_f32 v[58:59], v[58:59], v[180:181]
    v_pk_fma_f32 v[66:67], v[180:181], v[180:181], v[66:67]
    v_pk_add_f32 v[58:59], v[58:59], v[182:183]
    v_pk_fma_f32 v[66:67], v[182:183], v[182:183], v[66:67]
    v_pk_add_f32 v[60:61], v[60:61], v[184:185]
    v_pk_fma_f32 v[68:69], v[184:185], v[184:185], v[68:69]
    v_pk_add_f32 v[60:61], v[60:61], v[186:187]
    v_pk_fma_f32 v[68:69], v[186:187], v[186:187], v[68:69]
    v_pk_add_f32 v[62:63], v[62:63], v[188:189]
    v_pk_fma_f32 v[70:71], v[188:189], v[188:189], v[70:71]
    v_pk_add_f32 v[62:63], v[62:63], v[190:191]
    v_pk_fma_f32 v[70:71], v[190:191], v[190:191], v[70:71]
    v_pk_add_f32 v[56:57], v[56:57], v[192:193]
    v_pk_fma_f32 v[64:65], v[192:193], v[192:193], v[64:65]
    v_pk_add_f32 v[56:57], v[56:57], v[194:195]
    v_pk_fma_f32 v[64:65], v[194:195], v[194:195], v[64:65]
    v_pk_add_f32 v[58:59], v[58:59], v[196:197]
    v_pk_fma_f32 v[66:67], v[196:197], v[196:197], v[66:67]
    v_pk_add_f32 v[58:59], v[58:59], v[198:199]
    v_pk_fma_f32 v[66:67], v[198:199], v[198:199], v[66:67]
    v_pk_add_f32 v[60:61], v[60:61], v[200:201]
    v_pk_fma_f32 v[68:69], v[200:201], v[200:201], v[68:69]
    v_pk_add_f32 v[60:61], v[60:61], v[202:203]
    v_pk_fma_f32 v[68:69], v[202:203], v[202:203], v[68:69]
    v_pk_add_f32 v[62:63], v[62:63], v[204:205]
    v_pk_fma_f32 v[70:71], v[204:205], v[204:205], v[70:71]
    v_pk_add_f32 v[62:63], v[62:63], v[206:207]
    v_pk_fma_f32 v[70:71], v[206:207], v[206:207], v[70:71]
    v_pk_add_f32 v[56:57], v[56:57], v[208:209]
    v_pk_fma_f32 v[64:65], v[208:209], v[208:209], v[64:65]
    v_pk_add_f32 v[56:57], v[56:57], v[210:211]
    v_pk_fma_f32 v[64:65], v[210:211], v[210:211], v[64:65]
    v_pk_add_f32 v[58:59], v[58:59], v[212:213]
    v_pk_fma_f32 v[66:67], v[212:213], v[212:213], v[66:67]
    v_pk_add_f32 v[58:59], v[58:59], v[214:215]
    v_pk_fma_f32 v[66:67], v[214:215], v[214:215], v[66:67]
    v_pk_add_f32 v[60:61], v[60:61], v[216:217]
    v_pk_fma_f32 v[68:69], v[216:217], v[216:217], v[68:69]
    v_pk_add_f32 v[60:61], v[60:61], v[218:219]
    v_pk_fma_f32 v[68:69], v[218:219], v[218:219], v[68:69]
    v_pk_add_f32 v[62:63], v[62:63], v[220:221]
    v_pk_fma_f32 v[70:71], v[220:221], v[220:221], v[70:71]
    v_pk_add_f32 v[62:63], v[62:63], v[222:223]
    v_pk_fma_f32 v[70:71], v[222:223], v[222:223], v[70:71]
    v_pk_add_f32 v[56:57], v[56:57], v[224:225]
    v_pk_fma_f32 v[64:65], v[224:225], v[224:225], v[64:65]
    v_pk_add_f32 v[56:57], v[56:57], v[226:227]
    v_pk_fma_f32 v[64:65], v[226:227], v[226:227], v[64:65]
    v_pk_add_f32 v[58:59], v[58:59], v[228:229]
    v_pk_fma_f32 v[66:67], v[228:229], v[228:229], v[66:67]
    v_pk_add_f32 v[58:59], v[58:59], v[230:231]
    v_pk_fma_f32 v[66:67], v[230:231], v[230:231], v[66:67]
    v_pk_add_f32 v[60:61], v[60:61], v[232:233]
    v_pk_fma_f32 v[68:69], v[232:233], v[232:233], v[68:69]
    v_pk_add_f32 v[60:61], v[60:61], v[234:235]
    v_pk_fma_f32 v[68:69], v[234:235], v[234:235], v[68:69]
    v_pk_add_f32 v[62:63], v[62:63], v[236:237]
    v_pk_fma_f32 v[70:71], v[236:237], v[236:237], v[70:71]
    v_pk_add_f32 v[62:63], v[62:63], v[238:239]
    v_pk_fma_f32 v[70:71], v[238:239], v[238:239], v[70:71]
    v_pk_add_f32 v[56:57], v[56:57], v[240:241]
    v_pk_fma_f32 v[64:65], v[240:241], v[240:241], v[64:65]
    v_pk_add_f32 v[56:57], v[56:57], v[242:243]
    v_pk_fma_f32 v[64:65], v[242:243], v[242:243], v[64:65]
    v_pk_add_f32 v[58:59], v[58:59], v[244:245]
    v_pk_fma_f32 v[66:67], v[244:245], v[244:245], v[66:67]
    v_pk_add_f32 v[58:59], v[58:59], v[246:247]
    v_pk_fma_f32 v[66:67], v[246:247], v[246:247], v[66:67]
    v_pk_add_f32 v[60:61], v[60:61], v[248:249]
    v_pk_fma_f32 v[68:69], v[248:249], v[248:249], v[68:69]
    v_pk_add_f32 v[60:61], v[60:61], v[250:251]
    v_pk_fma_f32 v[68:69], v[250:251], v[250:251], v[68:69]
    v_pk_add_f32 v[62:63], v[62:63], v[252:253]
    v_pk_fma_f32 v[70:71], v[252:253], v[252:253], v[70:71]
    v_pk_add_f32 v[62:63], v[62:63], v[254:255]
    v_pk_fma_f32 v[70:71], v[254:255], v[254:255], v[70:71]
    v_add_f32 v24, v56, v57
    v_add_f32 v28, v64, v65
    v_add_f32 v25, v58, v59
    v_add_f32 v29, v66, v67
    v_add_f32 v26, v60, v61
    v_add_f32 v30, v68, v69
    v_add_f32 v27, v62, v63
    v_add_f32 v31, v70, v71
    s_cmp_lg_u32 s56, 0
    s_cbranch_scc1 Ldry_ret
Ljoin:
    ds_write_b64 v22, v[24:25] offset:20912
    ds_write_b64 v22, v[26:27] offset:20920
    ds_write_b64 v22, v[28:29] offset:21936
    ds_write_b64 v22, v[30:31] offset:21944
    s_waitcnt lgkmcnt(4)
    s_mov_b64 exec, 1
    ds_add_u32 v18, v23
    s_mov_b64 exec, -1
    s_add_u32 s53, s53, 4
Lp_2:
    ds_read_b32 v19, v18
    s_waitcnt lgkmcnt(0)
    v_readfirstlane_b32 s74, v19
    s_cmp_ge_u32 s74, s53
    s_cbranch_scc0 Lp_2
    ds_read_b128 v[24:27], v14 offset:20912
    ds_read_b128 v[28:31], v14 offset:21936
    ds_read_b128 v[56:59], v14 offset:22960
    ds_read_b128 v[60:63], v14 offset:23984
    ds_read_b128 v[64:67], v14 offset:25008
    ds_read_b128 v[68:71], v14 offset:26032
    ds_read_b128 v[72:75], v14 offset:27056
    ds_read_b128 v[76:79], v14 offset:28080
    s_waitcnt lgkmcnt(5)
    v_add_f32 v24, v24, v56
    v_add_f32_e64 v25, v25, v57
    v_add_f32 v26, v26, v58
    v_add_f32 v27, v27, v59
    s_waitcnt lgkmcnt(1)
    v_add_f32 v64, v64, v72
    v_add_f32 v65, v65, v73
    v_add_f32 v66, v66, v74
    v_add_f32 v67, v67, v75
    v_add_f32 v24, v24, v64
    v_add_f32 v25, v25, v65
    v_add_f32 v26, v26, v66
    v_add_f32 v27, v27, v67
    v_add_f32 v28, v28, v60
    v_add_f32 v29, v29, v61
    v_add_f32 v30, v30, v62
    v_add_f32 v31, v31, v63
    s_waitcnt lgkmcnt(0)
    v_add_f32 v68, v68, v76
    v_add_f32 v69, v69, v77
    v_add_f32 v70, v70, v78
    v_add_f32 v71, v71, v79
    v_add_f32 v28, v28, v68
    v_add_f32 v29, v29, v69
    v_add_f32 v30, v30, v70
    v_add_f32 v31, v31, v71
    v_mul_f32 v56, s82, v24
    v_mul_f32 v57, s82, v25
    v_mul_f32 v58, s82, v26
    v_mul_f32 v59, s82, v27
    v_mul_f32 v60, v56, v56
    v_mul_f32 v61, v57, v57
    v_mul_f32 v62, v58, v58
    v_mul_f32 v63, v59, v59
    v_fma_f32 v60, v28, s82, -v60
    v_fma_f32 v61, v29, s82, -v61
    v_fma_f32 v62, v30, s82, -v62
    v_fma_f32 v63, v31, s82, -v63
    ds_read_b128 v[24:27], v14 offset:18864
    ds_read_b128 v[28:31], v14 offset:19888
    v_max_f32 v60, 0, v60
    v_max_f32 v61, 0, v61
    v_max_f32 v62, 0, v62
    v_max_f32 v63, 0, v63
    v_add_f32 v60, s83, v60
    v_add_f32 v61, s83, v61
    v_add_f32 v62, s83, v62
    v_add_f32 v63, s83, v63
    v_rsq_f32 v60, v60
    v_rsq_f32 v61, v61
    v_rsq_f32 v62, v62
    v_rsq_f32 v63, v63
    v_mul_f32 v64, s84, v60
    v_mul_f32 v65, s84, v61
    v_mul_f32 v66, s84, v62
    v_mul_f32 v67, s84, v63
    v_mul_f32 v68, -v56, v64
    v_mul_f32 v69, -v57, v65
    v_mul_f32 v70, -v58, v66
    v_mul_f32 v71, -v59, v67
    s_cmp_lg_u32 s56, 0
    s_cbranch_scc1 Ldry_ret
Ldry3:
    v_pk_fma_f32 v[160:161], v[160:161], v[64:65], v[68:69] op_sel:[0,0,0] op_sel_hi:[1,0,0]
    v_pk_fma_f32 v[162:163], v[162:163], v[64:65], v[68:69] op_sel:[0,0,0] op_sel_hi:[1,0,0]
    v_pk_fma_f32 v[164:165], v[164:165], v[64:65], v[68:69] op_sel:[0,1,1] op_sel_hi:[1,1,1]
    v_pk_fma_f32 v[166:167], v[166:167], v[64:65], v[68:69] op_sel:[0,1,1] op_sel_hi:[1,1,1]
    v_pk_fma_f32 v[168:169], v[168:169], v[66:67], v[70:71] op_sel:[0,0,0] op_sel_hi:[1,0,0]
    v_pk_fma_f32 v[170:171], v[170:171], v[66:67], v[70:71] op_sel:[0,0,0] op_sel_hi:[1,0,0]
    v_pk_fma_f32 v[172:173], v[172:173], v[66:67], v[70:71] op_sel:[0,1,1] op_sel_hi:[1,1,1]
    v_pk_fma_f32 v[174:175], v[174:175], v[66:67], v[70:71] op_sel:[0,1,1] op_sel_hi:[1,1,1]
    v_pk_fma_f32 v[176:177], v[176:177], v[64:65], v[68:69] op_sel:[0,0,0] op_sel_hi:[1,0,0]
    v_pk_fma_f32 v[178:179], v[178:179], v[64:65], v[68:69] op_sel:[0,0,0] op_sel_hi:[1,0,0]
    v_pk_fma_f32 v[180:181], v[180:181], v[64:65], v[68:69] op_sel:[0,1,1] op_sel_hi:[1,1,1]
    v_pk_fma_f32 v[182:183], v[182:183], v[64:65], v[68:69] op_sel:[0,1,1] op_sel_hi:[1,1,1]
    v_pk_fma_f32 v[184:185], v[184:185], v[66:67], v[70:71] op_sel:[0,0,0] op_sel_hi:[1,0,0]
    v_pk_fma_f32 v[186:187], v[186:187], v[66:67], v[70:71] op_sel:[0,0,0] op_sel_hi:[1,0,0]
    v_pk_fma_f32 v[188:189], v[188:189], v[66:67], v[70:71] op_sel:[0,1,1] op_sel_hi:[1,1,1]
    v_pk_fma_f32 v[190:191], v[190:191], v[66:67], v[70:71] op_sel:[0,1,1] op_sel_hi:[1,1,1]
    v_pk_fma_f32 v[192:193], v[192:193], v[64:65], v[68:69] op_sel:[0,0,0] op_sel_hi:[1,0,0]
    v_pk_fma_f32 v[194:195], v[194:195], v[64:65], v[68:69] op_sel:[0,0,0] op_sel_hi:[1,0,0]
    v_pk_fma_f32 v[196:197], v[196:197], v[64:65], v[68:69] op_sel:[0,1,1] op_sel_hi:[1,1,1]
    v_pk_fma_f32 v[198:199], v[198:199], v[64:65], v[68:69] op_sel:[0,1,1] op_sel_hi:[1,1,1]
    v_pk_fma_f32 v[200:201], v[200:201], v[66:67], v[70:71] op_sel:[0,0,0] op_sel_hi:[1,0,0]
    v_pk_fma_f32 v[202:203], v[202:203], v[66:67], v[70:71] op_sel:[0,0,0] op_sel_hi:[1,0,0]
    v_pk_fma_f32 v[204:205], v[204:205], v[66:67], v[70:71] op_sel:[0,1,1] op_sel_hi:[1,1,1]
    v_pk_fma_f32 v[206:207], v[206:207], v[66:67], v[70:71] op_sel:[0,1,1] op_sel_hi:[1,1,1]
    v_pk_fma_f32 v[208:209], v[208:209], v[64:65], v[68:69] op_sel:[0,0,0] op_sel_hi:[1,0,0]
    v_pk_fma_f32 v[210:211], v[210:211], v[64:65], v[68:69] op_sel:[0,0,0] op_sel_hi:[1,0,0]
    v_pk_fma_f32 v[212:213], v[212:213], v[64:65], v[68:69] op_sel:[0,1,1] op_sel_hi:[1,1,1]
    v_pk_fma_f32 v[214:215], v[214:215], v[64:65], v[68:69] op_sel:[0,1,1] op_sel_hi:[1,1,1]
    v_pk_fma_f32 v[216:217], v[216:217], v[66:67], v[70:71] op_sel:[0,0,0] op_sel_hi:[1,0,0]
    v_pk_fma_f32 v[218:219], v[218:219], v[66:67], v[70:71] op_sel:[0,0,0] op_sel_hi:[1,0,0]
    v_pk_fma_f32 v[220:221], v[220:221], v[66:67], v[70:71] op_sel:[0,1,1] op_sel_hi:[1,1,1]
    v_pk_fma_f32 v[222:223], v[222:223], v[66:67], v[70:71] op_sel:[0,1,1] op_sel_hi:[1,1,1]
    v_pk_fma_f32 v[224:225], v[224:225], v[64:65], v[68:69] op_sel:[0,0,0] op_sel_hi:[1,0,0]
    v_pk_fma_f32 v[226:227], v[226:227], v[64:65], v[68:69] op_sel:[0,0,0] op_sel_hi:[1,0,0]
    v_pk_fma_f32 v[228:229], v[228:229], v[64:65], v[68:69] op_sel:[0,1,1] op_sel_hi:[1,1,1]
    v_pk_fma_f32 v[230:231], v[230:231], v[64:65], v[68:69] op_sel:[0,1,1] op_sel_hi:[1,1,1]
    v_pk_fma_f32 v[232:233], v[232:233], v[66:67], v[70:71] op_sel:[0,0,0] op_sel_hi:[1,0,0]
    v_pk_fma_f32 v[234:235], v[234:235], v[66:67], v[70:71] op_sel:[0,0,0] op_sel_hi:[1,0,0]
    v_pk_fma_f32 v[236:237], v[236:237], v[66:67], v[70:71] op_sel:[0,1,1] op_sel_hi:[1,1,1]
    v_pk_fma_f32 v[238:239], v[238:239], v[66:67], v[70:71] op_sel:[0,1,1] op_sel_hi:[1,1,1]
    v_pk_fma_f32 v[240:241], v[240:241], v[64:65], v[68:69] op_sel:[0,0,0] op_sel_hi:[1,0,0]
    v_pk_fma_f32 v[242:243], v[242:243], v[64:65], v[68:69] op_sel:[0,0,0] op_sel_hi:[1,0,0]
    v_pk_fma_f32 v[244:245], v[244:245], v[64:65], v[68:69] op_sel:[0,1,1] op_sel_hi:[1,1,1]
    v_pk_fma_f32 v[246:247], v[246:247], v[64:65], v[68:69] op_sel:[0,1,1] op_sel_hi:[1,1,1]
    v_pk_fma_f32 v[248:249], v[248:249], v[66:67], v[70:71] op_sel:[0,0,0] op_sel_hi:[1,0,0]
    v_pk_fma_f32 v[250:251], v[250:251], v[66:67], v[70:71] op_sel:[0,0,0] op_sel_hi:[1,0,0]
    v_pk_fma_f32 v[252:253], v[252:253], v[66:67], v[70:71] op_sel:[0,1,1] op_sel_hi:[1,1,1]
    v_pk_fma_f32 v[254:255], v[254:255], v[66:67], v[70:71] op_sel:[0,1,1] op_sel_hi:[1,1,1]
    v_cvt_pk_bf16_f32 v112, v160, v161
    v_cvt_pk_bf16_f32 v113, v162, v163
    ds_write_b64 v110, v[112:113] offset:0
    v_cvt_pk_bf16_f32 v124, v164, v165
    v_cvt_pk_bf16_f32 v125, v166, v167
    ds_write_b64 v110, v[124:125] offset:192
    v_cvt_pk_bf16_f32 v136, v168, v169
    v_cvt_pk_bf16_f32 v137, v170, v171
    ds_write_b64 v110, v[136:137] offset:384
    v_cvt_pk_bf16_f32 v148, v172, v173
    v_cvt_pk_bf16_f32 v149, v174, v175
    ds_write_b64 v110, v[148:149] offset:576
    v_cvt_pk_bf16_f32 v114, v176, v177
    s_waitcnt lgkmcnt(4)
    s_nop 0
    v_mfma_f32_32x32x16_bf16 v[160:175], v[24:27], v[32:35], 0
    v_cvt_pk_bf16_f32 v115, v178, v179
    ds_write_b64 v110, v[114:115] offset:8
    v_cvt_pk_bf16_f32 v126, v180, v181
    v_cvt_pk_bf16_f32 v127, v182, v183
    ds_write_b64 v110, v[126:127] offset:200
    v_mfma_f32_32x32x16_bf16 v[160:175], v[28:31], v[36:39], v[160:175]
    v_cvt_pk_bf16_f32 v138, v184, v185
    v_cvt_pk_bf16_f32 v139, v186, v187
    ds_write_b64 v110, v[138:139] offset:392
    v_cvt_pk_bf16_f32 v150, v188, v189
    v_cvt_pk_bf16_f32 v151, v190, v191
    ds_write_b64 v110, v[150:151] offset:584
    v_cvt_pk_bf16_f32 v116, v192, v193
    v_mfma_f32_32x32x16_bf16 v[176:191], v[24:27], v[40:43], 0
    v_cvt_pk_bf16_f32 v117, v194, v195
    ds_write_b64 v110, v[116:117] offset:16
    v_cvt_pk_bf16_f32 v128, v196, v197
    v_cvt_pk_bf16_f32 v129, v198, v199
    ds_write_b64 v110, v[128:129] offset:208
    v_mfma_f32_32x32x16_bf16 v[176:191], v[28:31], v[44:47], v[176:191]
    v_cvt_pk_bf16_f32 v140, v200, v201
    v_cvt_pk_bf16_f32 v141, v202, v203
    ds_write_b64 v110, v[140:141] offset:400
    v_cvt_pk_bf16_f32 v152, v204, v205
    v_cvt_pk_bf16_f32 v153, v206, v207
    ds_write_b64 v110, v[152:153] offset:592
    v_cvt_pk_bf16_f32 v118, v208, v209
    v_mfma_f32_32x32x16_bf16 v[192:207], v[24:27], v[48:51], 0
    v_cvt_pk_bf16_f32 v119, v210, v211
    ds_write_b64 v110, v[118:119] offset:24
    v_cvt_pk_bf16_f32 v130, v212, v213
    v_cvt_pk_bf16_f32 v131, v214, v215
    ds_write_b64 v110, v[130:131] offset:216
    v_mfma_f32_32x32x16_bf16 v[192:207], v[28:31], v[52:55], v[192:207]
    v_cvt_pk_bf16_f32 v142, v216, v217
    v_cvt_pk_bf16_f32 v143, v218, v219
    ds_write_b64 v110, v[142:143] offset:408
    v_cvt_pk_bf16_f32 v154, v220, v221
    v_cvt_pk_bf16_f32 v155, v222, v223
    s_waitcnt lgkmcnt(8)
    s_nop 0
    ds_write_b64 v110, v[154:155] offset:600
    v_cvt_pk_bf16_f32 v120, v224, v225
    v_mfma_f32_32x32x16_bf16 v[208:223], v[24:27], v[92:95], 0
    v_cvt_pk_bf16_f32 v121, v226, v227
    ds_write_b64 v110, v[120:121] offset:32
    v_cvt_pk_bf16_f32 v132, v228, v229
    v_cvt_pk_bf16_f32 v133, v230, v231
    ds_write_b64 v110, v[132:133] offset:224
    v_mfma_f32_32x32x16_bf16 v[208:223], v[28:31], v[96:99], v[208:223]
    v_cvt_pk_bf16_f32 v144, v232, v233
    v_cvt_pk_bf16_f32 v145, v234, v235
    ds_write_b64 v110, v[144:145] offset:416
    v_cvt_pk_bf16_f32 v156, v236, v237
    v_cvt_pk_bf16_f32 v157, v238, v239
    ds_write_b64 v110, v[156:157] offset:608
    v_cvt_pk_bf16_f32 v122, v240, v241
    v_mfma_f32_32x32x16_bf16 v[224:239], v[24:27], v[100:103], 0
    v_cvt_pk_bf16_f32 v123, v242, v243
    ds_write_b64 v110, v[122:123] offset:40
    v_cvt_pk_bf16_f32 v134, v244, v245
    v_cvt_pk_bf16_f32 v135, v246, v247
    ds_write_b64 v110, v[134:135] offset:232
    v_mfma_f32_32x32x16_bf16 v[224:239], v[28:31], v[80:83], v[224:239]
    v_cvt_pk_bf16_f32 v146, v248, v249
    v_cvt_pk_bf16_f32 v147, v250, v251
    s_waitcnt lgkmcnt(8)
    s_nop 0
    ds_write_b64 v110, v[146:147] offset:424
    v_cvt_pk_bf16_f32 v158, v252, v253
    v_cvt_pk_bf16_f32 v159, v254, v255
    ds_write_b64 v110, v[158:159] offset:616
    s_mov_b64 exec, 1
    s_nop 0
    ds_add_u32 v18, v23
    s_mov_b64 exec, -1
    s_add_u32 s53, s53, 4
    v_mfma_f32_32x32x16_bf16 v[240:255], v[24:27], v[84:87], 0
    v_mfma_f32_32x32x16_bf16 v[240:255], v[28:31], v[88:91], v[240:255]
    s_cmp_lg_u32 s65, 0
    s_cbranch_scc1 Lw1wait
Lw1wait_retP:
    v_add_u32_e64 v9, s41, v14
    ds_read_b128 v[56:59], v9 offset:12288
    ds_read_b128 v[60:63], v9 offset:13312
    ds_read_b128 v[64:67], v9 offset:14336
    ds_read_b128 v[68:71], v9 offset:15360
    s_waitcnt lgkmcnt(8)
    s_nop 0
    ds_read_b128 v[72:75], v9 offset:16384
    ds_read_b128 v[76:79], v9 offset:17408
    v_mov_b32 v28, 0
    v_mov_b32 v29, 0
    v_mov_b32 v30, 0
    v_mov_b32 v31, 0
Lp_3:
    ds_read_b32 v19, v18
    s_waitcnt lgkmcnt(0)
    v_readfirstlane_b32 s74, v19
    s_cmp_ge_u32 s74, s53
    s_cbranch_scc0 Lp_3
    ds_read_b128 v[112:115], v111 offset:0
    ds_read_b128 v[120:123], v111 offset:32
    ds_read_b128 v[128:131], v111 offset:64
    ds_read_b128 v[136:139], v111 offset:96
    ds_read_b128 v[144:147], v111 offset:128
    ds_read_b128 v[152:155], v111 offset:160
    ds_read_b128 v[116:119], v111 offset:7104
    ds_read_b128 v[124:127], v111 offset:7136
    ds_read_b128 v[132:135], v111 offset:7168
    ds_read_b128 v[140:143], v111 offset:7200
    ds_read_b128 v[148:151], v111 offset:7232
    ds_read_b128 v[156:159], v111 offset:7264
    s_waitcnt lgkmcnt(11)
    s_nop 0
    v_mfma_f32_32x32x16_bf16 v[80:95], v[56:59], v[112:115], 0
    s_waitcnt lgkmcnt(10)
    s_nop 0
    v_mfma_f32_32x32x16_bf16 v[80:95], v[60:63], v[120:123], v[80:95]
    s_waitcnt lgkmcnt(9)
    s_nop 0
    v_mfma_f32_32x32x16_bf16 v[80:95], v[64:67], v[128:131], v[80:95]
    s_waitcnt lgkmcnt(8)
    s_nop 0
    v_mfma_f32_32x32x16_bf16 v[80:95], v[68:71], v[136:139], v[80:95]
    s_waitcnt lgkmcnt(7)
    s_nop 0
    v_mfma_f32_32x32x16_bf16 v[80:95], v[72:75], v[144:147], v[80:95]
    s_waitcnt lgkmcnt(6)
    s_nop 0
    v_mfma_f32_32x32x16_bf16 v[80:95], v[76:79], v[152:155], v[80:95]
    s_waitcnt lgkmcnt(0)
    s_setprio 0
    s_nop 4
    s_cmp_lg_u32 s56, 0
    s_cbranch_scc1 Ldry_ret
    s_sub_u32 s67, s36, s47
    s_max_i32 s67, s67, 0
    s_mov_b32 s48, 9
    s_or_b32 s71, s36, s65
    s_cbranch_scc0 LloopXP
    s_sub_u32 s48, 6, s47
    s_cmp_lg_u32 s65, 0
    s_cselect_b32 s48, 2, s48
    s_branch LloopNP
.p2align 6
LloopXP:
    s_waitcnt vmcnt(0)
Lnowait1P:
    s_barrier
    s_sub_u32 s41, 82816, s41
Lbody1P:
    v_add_u32 v9, s41, v14
    s_cmp_eq_u32 s48, s67
    s_cselect_b32 s71, 0x30000, s41
    v_add_u32 v10, s71, v14
    s_setprio 3
    v_cvt_pk_f16_f32 v20, v80, v81
    v_cvt_pk_f16_f32 v23, v82, v83
    v_mfma_f32_32x32x16_f16 v[208:223], v[44:47], v[28:31], v[208:223]
    ds_read_b128 v[44:47], v9 offset:9216
    v_pk_fma_f16 v19, v20, v20, s49
    v_pk_fma_f16 v22, v23, v23, s49
    v_pk_mul_f16 v18, v20, v19
    v_pk_mul_f16 v21, v23, v22
    v_exp_f16 v19, v18
    v_exp_f16 v22, v21
    v_exp_f16_sdwa v19, v18 dst_sel:WORD_1 dst_unused:UNUSED_PRESERVE src0_sel:WORD_1
    v_mfma_f32_32x32x16_bf16 v[96:111], v[56:59], v[116:119], 0
    ds_read_b128 v[32:35], v9 offset:6144
    ds_read_b128 v[56:59], v9 offset:0
    v_exp_f16_sdwa v22, v21 dst_sel:WORD_1 dst_unused:UNUSED_PRESERVE src0_sel:WORD_1
    v_pk_fma_f16 v18, v19, s50, s50
    v_pk_fma_f16 v21, v22, s50, s50
    v_rcp_f16 v19, v18
    v_rcp_f16 v22, v21
    v_mfma_f32_32x32x16_f16 v[224:239], v[48:51], v[28:31], v[224:239]
    ds_read_b128 v[36:39], v9 offset:7168
    ds_read_b128 v[48:51], v9 offset:10240
    v_rcp_f16_sdwa v19, v18 dst_sel:WORD_1 dst_unused:UNUSED_PRESERVE src0_sel:WORD_1
    v_rcp_f16_sdwa v22, v21 dst_sel:WORD_1 dst_unused:UNUSED_PRESERVE src0_sel:WORD_1
    v_pk_mul_f16 v24, v20, v19
    v_pk_mul_f16 v25, v23, v22
    v_cvt_pk_f16_f32 v20, v84, v85
    v_cvt_pk_f16_f32 v23, v86, v87
    v_mfma_f32_32x32x16_bf16 v[96:111], v[60:63], v[124:127], v[96:111]
    ds_read_b128 v[40:43], v9 offset:8192
    ds_read_b128 v[60:63], v9 offset:1024
    v_pk_fma_f16 v19, v20, v20, s49
    v_pk_fma_f16 v22, v23, v23, s49
    v_pk_mul_f16 v18, v20, v19
    v_pk_mul_f16 v21, v23, v22
    v_exp_f16 v19, v18
    v_exp_f16 v22, v21
    v_mfma_f32_32x32x16_f16 v[240:255], v[52:55], v[28:31], v[240:255]
    ds_read_b128 v[52:55], v9 offset:11264
    v_exp_f16_sdwa v19, v18 dst_sel:WORD_1 dst_unused:UNUSED_PRESERVE src0_sel:WORD_1
    v_exp_f16_sdwa v22, v21 dst_sel:WORD_1 dst_unused:UNUSED_PRESERVE src0_sel:WORD_1
    v_pk_fma_f16 v18, v19, s50, s50
    v_pk_fma_f16 v21, v22, s50, s50
    v_rcp_f16 v19, v18
    v_rcp_f16 v22, v21
    v_mfma_f32_32x32x16_bf16 v[96:111], v[64:67], v[132:135], v[96:111]
    ds_read_b128 v[64:67], v9 offset:2048
    v_rcp_f16_sdwa v19, v18 dst_sel:WORD_1 dst_unused:UNUSED_PRESERVE src0_sel:WORD_1
    v_rcp_f16_sdwa v22, v21 dst_sel:WORD_1 dst_unused:UNUSED_PRESERVE src0_sel:WORD_1
    v_pk_mul_f16 v26, v20, v19
    v_pk_mul_f16 v27, v23, v22
    v_cvt_pk_f16_f32 v20, v88, v89
    v_mfma_f32_32x32x16_bf16 v[96:111], v[68:71], v[140:143], v[96:111]
    ds_read_b128 v[68:71], v9 offset:3072
    v_cvt_pk_f16_f32 v23, v90, v91
    v_pk_fma_f16 v19, v20, v20, s49
    v_pk_fma_f16 v22, v23, v23, s49
    v_pk_mul_f16 v18, v20, v19
    v_pk_mul_f16 v21, v23, v22
    v_exp_f16_e64 v19, v18
    v_exp_f16 v22, v21
    s_waitcnt lgkmcnt(5)
    v_mfma_f32_32x32x16_f16 v[160:175], v[32:35], v[24:27], v[160:175]
    s_sub_u32 s78, 82816, s41
    s_add_u32 m0, s78, s88
    s_add_u32 s79, s42, s46
    buffer_load_dwordx4 v11, s[24:27], s79 offen sc1 lds
    v_exp_f16_sdwa v19, v18 dst_sel:WORD_1 dst_unused:UNUSED_PRESERVE src0_sel:WORD_1
    v_exp_f16_sdwa v22, v21 dst_sel:WORD_1 dst_unused:UNUSED_PRESERVE src0_sel:WORD_1
    v_pk_fma_f16 v18, v19, s50, s50
    v_pk_fma_f16 v21, v22, s50, s50
    v_rcp_f16_e64 v19, v18
    v_mfma_f32_32x32x16_bf16 v[96:111], v[72:75], v[148:151], v[96:111]
    ds_read_b128 v[72:75], v9 offset:4096
    v_rcp_f16_e64 v22, v21
    v_rcp_f16_sdwa v19, v18 dst_sel:WORD_1 dst_unused:UNUSED_PRESERVE src0_sel:WORD_1
    v_rcp_f16_sdwa v22, v21 dst_sel:WORD_1 dst_unused:UNUSED_PRESERVE src0_sel:WORD_1
    v_pk_mul_f16 v28, v20, v19
    v_pk_mul_f16 v29, v23, v22
    v_cvt_pk_f16_f32 v20, v92, v93
    v_mfma_f32_32x32x16_f16 v[176:191], v[36:39], v[24:27], v[176:191]
    s_add_u32 m0, m0, s89
    s_add_u32 s79, s79, s45
    buffer_load_dwordx4 v11, s[24:27], s79 offen sc1 lds
    v_cvt_pk_f16_f32 v23, v94, v95
    v_pk_fma_f16 v19, v20, v20, s49
    v_pk_fma_f16 v22, v23, v23, s49
    v_pk_mul_f16 v18, v20, v19
    v_pk_mul_f16 v21, v23, v22
    v_exp_f16 v19, v18
    v_exp_f16 v22, v21
    v_mfma_f32_32x32x16_bf16 v[96:111], v[76:79], v[156:159], v[96:111]
    ds_read_b128 v[76:79], v9 offset:5120
    v_exp_f16_sdwa v19, v18 dst_sel:WORD_1 dst_unused:UNUSED_PRESERVE src0_sel:WORD_1
    v_exp_f16_sdwa v22, v21 dst_sel:WORD_1 dst_unused:UNUSED_PRESERVE src0_sel:WORD_1
    v_pk_fma_f16 v18, v19, s50, s50
    v_pk_fma_f16 v21, v22, s50, s50
    v_rcp_f16 v19, v18
    s_waitcnt lgkmcnt(2)
    v_mfma_f32_32x32x16_f16 v[192:207], v[40:43], v[24:27], v[192:207]
    s_add_u32 m0, m0, s89
    s_add_u32 s79, s79, s45
    buffer_load_dwordx4 v11, s[24:27], s79 offen sc1 lds
    s_add_u32 s42, s42, s43
    s_cmp_eq_u32 s42, s44
    s_cselect_b32 s42, 0, s42
    v_rcp_f16 v22, v21
    v_rcp_f16_sdwa v19, v18 dst_sel:WORD_1 dst_unused:UNUSED_PRESERVE src0_sel:WORD_1
    v_rcp_f16_sdwa v22, v21 dst_sel:WORD_1 dst_unused:UNUSED_PRESERVE src0_sel:WORD_1
    v_pk_mul_f16 v30, v20, v19
    v_pk_mul_f16 v31, v23, v22
    s_cmp_lg_u32 s56, 0
    s_cbranch_scc1 Ldry_ret
Lq11:
    s_setprio 2
    s_nop 0
    v_cvt_pk_f16_f32 v20, v96, v97
    v_cvt_pk_f16_f32 v23, v98, v99
    v_mfma_f32_32x32x16_f16 v[160:175], v[44:47], v[28:31], v[160:175]
    v_pk_fma_f16 v19, v20, v20, s49
    v_pk_fma_f16 v22, v23, v23, s49
    v_pk_mul_f16 v18, v20, v19
    v_pk_mul_f16 v21, v23, v22
    v_exp_f16 v19, v18
    v_exp_f16 v22, v21
    v_exp_f16_sdwa v19, v18 dst_sel:WORD_1 dst_unused:UNUSED_PRESERVE src0_sel:WORD_1
    v_mfma_f32_32x32x16_bf16 v[80:95], v[56:59], v[112:115], 0
    s_add_u32 s78, s78, 12288
    s_add_u32 m0, s78, s88
    s_add_u32 s79, s42, s46
    buffer_load_dwordx4 v11, s[24:27], s79 offen sc1 lds
    v_exp_f16_sdwa v22, v21 dst_sel:WORD_1 dst_unused:UNUSED_PRESERVE src0_sel:WORD_1
    v_pk_fma_f16 v18, v19, s50, s50
    v_pk_fma_f16 v21, v22, s50, s50
    v_rcp_f16 v19, v18
    v_rcp_f16 v22, v21
    v_mfma_f32_32x32x16_f16 v[176:191], v[48:51], v[28:31], v[176:191]
    v_rcp_f16_sdwa v19, v18 dst_sel:WORD_1 dst_unused:UNUSED_PRESERVE src0_sel:WORD_1
    v_rcp_f16_sdwa v22, v21 dst_sel:WORD_1 dst_unused:UNUSED_PRESERVE src0_sel:WORD_1
    v_pk_mul_f16 v24, v20, v19
    v_pk_mul_f16 v25, v23, v22
    v_cvt_pk_f16_f32 v20, v100, v101
    v_cvt_pk_f16_f32 v23, v102, v103
    v_mfma_f32_32x32x16_bf16 v[80:95], v[60:63], v[120:123], v[80:95]
    s_add_u32 m0, m0, s89
    s_add_u32 s79, s79, s45
    buffer_load_dwordx4 v11, s[24:27], s79 offen sc1 lds
    v_pk_fma_f16 v19, v20, v20, s49
    v_pk_fma_f16 v22, v23, v23, s49
    v_pk_mul_f16 v18, v20, v19
    v_pk_mul_f16 v21, v23, v22
    v_exp_f16 v19, v18
    v_exp_f16 v22, v21
    v_mfma_f32_32x32x16_f16 v[192:207], v[52:55], v[28:31], v[192:207]
    v_exp_f16_sdwa v19, v18 dst_sel:WORD_1 dst_unused:UNUSED_PRESERVE src0_sel:WORD_1
    v_exp_f16_sdwa v22, v21 dst_sel:WORD_1 dst_unused:UNUSED_PRESERVE src0_sel:WORD_1
    v_pk_fma_f16 v18, v19, s50, s50
    v_pk_fma_f16 v21, v22, s50, s50
    v_rcp_f16 v19, v18
    v_rcp_f16 v22, v21
    v_mfma_f32_32x32x16_bf16 v[80:95], v[64:67], v[128:131], v[80:95]
    s_add_u32 m0, m0, s89
    s_add_u32 s79, s79, s45
    buffer_load_dwordx4 v11, s[24:27], s79 offen sc1 lds
    s_add_u32 s42, s42, s43
    s_cmp_eq_u32 s42, s44
    s_cselect_b32 s42, 0, s42
    s_nop 0
    v_rcp_f16_sdwa v19, v18 dst_sel:WORD_1 dst_unused:UNUSED_PRESERVE src0_sel:WORD_1
    v_rcp_f16_sdwa v22, v21 dst_sel:WORD_1 dst_unused:UNUSED_PRESERVE src0_sel:WORD_1
    v_pk_mul_f16 v26, v20, v19
    v_pk_mul_f16 v27, v23, v22
    v_cvt_pk_f16_f32 v20, v104, v105
    v_mfma_f32_32x32x16_bf16 v[80:95], v[68:71], v[136:139], v[80:95]
    v_cvt_pk_f16_f32 v23, v106, v107
    v_pk_fma_f16 v19, v20, v20, s49
    v_pk_fma_f16 v22, v23, v23, s49
    v_pk_mul_f16 v18, v20, v19
    v_pk_mul_f16 v21, v23, v22
    v_exp_f16 v19, v18
    v_exp_f16 v22, v21
    v_mfma_f32_32x32x16_f16 v[208:223], v[32:35], v[24:27], v[208:223]
    v_exp_f16_sdwa v19, v18 dst_sel:WORD_1 dst_unused:UNUSED_PRESERVE src0_sel:WORD_1
    v_exp_f16_sdwa v22, v21 dst_sel:WORD_1 dst_unused:UNUSED_PRESERVE src0_sel:WORD_1
    v_pk_fma_f16 v18, v19, s50, s50
    v_pk_fma_f16 v21, v22, s50, s50
    v_rcp_f16 v19, v18
    s_waitcnt lgkmcnt(0)
    v_mfma_f32_32x32x16_bf16 v[80:95], v[72:75], v[144:147], v[80:95]
    s_lshl_b32 s71, s39, 5
    s_add_u32 s71, s71, s64
    s_sub_u32 s71, s71, 2
    s_nop 0
    s_mul_i32 s85, s71, 98304
    s_mul_i32 s72, s38, 6144
    s_add_u32 s85, s85, s72
    s_nop 0
    s_cmp_lt_u32 s71, 512
    s_cselect_b32 s85, s85, 0x80000000
    s_cmp_ge_u32 s64, 24
    s_cselect_b32 s72, 24, 0
    s_sub_u32 s71, s64, s72
    s_cmp_ge_u32 s71, 12
    s_cselect_b32 s72, 12, 0
    s_sub_u32 s71, s71, s72
    s_and_b32 s72, s64, 4
    s_lshl_b32 s72, s72, 1
    s_mul_i32 s71, s71, 7104
    s_add_u32 s71, s71, s72
    s_nop 0
    s_add_u32 s86, s71, 78272
    s_mov_b64 exec, s[80:81]
    s_mov_b32 m0, s86
    s_sub_u32 s71, s85, s70
    s_nop 0
    buffer_load_dwordx4 v12, s[16:19], s71 offen nt lds
    s_add_u32 m0, s86, 784
    s_add_u32 s71, s85, 384
    buffer_load_dwordx4 v14, s[16:19], s71 offen nt lds
    s_add_u32 m0, s86, 1568
    s_add_u32 s71, s85, 1152
    buffer_load_dwordx4 v14, s[16:19], s71 offen nt lds
    s_mov_b64 exec, -1
    v_rcp_f16 v22, v21
    v_rcp_f16_sdwa v19, v18 dst_sel:WORD_1 dst_unused:UNUSED_PRESERVE src0_sel:WORD_1
    v_rcp_f16_sdwa v22, v21 dst_sel:WORD_1 dst_unused:UNUSED_PRESERVE src0_sel:WORD_1
    v_pk_mul_f16 v28, v20, v19
    v_pk_mul_f16 v29, v23, v22
    v_cvt_pk_f16_f32 v20, v108, v109
    v_mfma_f32_32x32x16_f16 v[224:239], v[36:39], v[24:27], v[224:239]
    v_cvt_pk_f16_f32 v23, v110, v111
    v_pk_fma_f16 v19, v20, v20, s49
    v_pk_fma_f16 v22, v23, v23, s49
    v_pk_mul_f16 v18, v20, v19
    v_pk_mul_f16 v21, v23, v22
    v_exp_f16 v19, v18
    v_exp_f16 v22, v21
    v_mfma_f32_32x32x16_bf16 v[80:95], v[76:79], v[152:155], v[80:95]
    v_exp_f16_sdwa v19, v18 dst_sel:WORD_1 dst_unused:UNUSED_PRESERVE src0_sel:WORD_1
    v_exp_f16_sdwa v22, v21 dst_sel:WORD_1 dst_unused:UNUSED_PRESERVE src0_sel:WORD_1
    v_pk_fma_f16 v18, v19, s50, s50
    v_pk_fma_f16 v21, v22, s50, s50
    v_rcp_f16_e64 v19, v18
    v_mfma_f32_32x32x16_f16 v[240:255], v[40:43], v[24:27], v[240:255]
    s_mov_b64 exec, s[80:81]
    s_nop 0
    s_add_u32 m0, s86, 2352
    s_add_u32 s71, s85, 1920
    buffer_load_dwordx4 v14, s[16:19], s71 offen nt lds
    s_add_u32 m0, s86, 3136
    s_add_u32 s71, s85, 2688
    buffer_load_dwordx4 v14, s[16:19], s71 offen nt lds
    s_add_u32 m0, s86, 3920
    s_add_u32 s71, s85, 3456
    buffer_load_dwordx4 v14, s[16:19], s71 offen nt lds
    s_mov_b64 exec, -1
    v_rcp_f16 v22, v21
    v_rcp_f16_sdwa v19, v18 dst_sel:WORD_1 dst_unused:UNUSED_PRESERVE src0_sel:WORD_1
    v_rcp_f16_sdwa v22, v21 dst_sel:WORD_1 dst_unused:UNUSED_PRESERVE src0_sel:WORD_1
    v_pk_mul_f16 v30, v20, v19
    v_pk_mul_f16 v31, v23, v22
    s_cmp_lg_u32 s56, 0
    s_cbranch_scc1 Ldry_ret
Lhalf1:
    s_setprio 1
    s_nop 0
    v_cvt_pk_f16_f32 v20, v80, v81
    v_cvt_pk_f16_f32 v23, v82, v83
    v_mfma_f32_32x32x16_f16 v[208:223], v[44:47], v[28:31], v[208:223]
    ds_read_b128 v[44:47], v9 offset:21504
    v_pk_fma_f16 v19, v20, v20, s49
    v_pk_fma_f16 v22, v23, v23, s49
    v_pk_mul_f16 v18, v20, v19
    v_pk_mul_f16 v21, v23, v22
    v_exp_f16 v19, v18
    v_exp_f16 v22, v21
    v_exp_f16_sdwa v19, v18 dst_sel:WORD_1 dst_unused:UNUSED_PRESERVE src0_sel:WORD_1
    v_mfma_f32_32x32x16_bf16 v[96:111], v[56:59], v[116:119], 0
    ds_read_b128 v[32:35], v9 offset:18432
    ds_read_b128 v[56:59], v10 offset:12288
    v_exp_f16_sdwa v22, v21 dst_sel:WORD_1 dst_unused:UNUSED_PRESERVE src0_sel:WORD_1
    v_pk_fma_f16 v18, v19, s50, s50
    v_pk_fma_f16 v21, v22, s50, s50
    v_rcp_f16 v19, v18
    v_rcp_f16 v22, v21
    v_mfma_f32_32x32x16_f16 v[224:239], v[48:51], v[28:31], v[224:239]
    ds_read_b128 v[36:39], v9 offset:19456
    ds_read_b128 v[48:51], v9 offset:22528
    v_rcp_f16_sdwa v19, v18 dst_sel:WORD_1 dst_unused:UNUSED_PRESERVE src0_sel:WORD_1
    v_rcp_f16_sdwa v22, v21 dst_sel:WORD_1 dst_unused:UNUSED_PRESERVE src0_sel:WORD_1
    v_pk_mul_f16 v24, v20, v19
    v_pk_mul_f16 v25, v23, v22
    v_cvt_pk_f16_f32 v20, v84, v85
    v_cvt_pk_f16_f32 v23, v86, v87
    v_mfma_f32_32x32x16_bf16 v[96:111], v[60:63], v[124:127], v[96:111]
    ds_read_b128 v[40:43], v9 offset:20480
    ds_read_b128 v[60:63], v10 offset:13312
    v_pk_fma_f16 v19, v20, v20, s49
    v_pk_fma_f16 v22, v23, v23, s49
    v_pk_mul_f16 v18, v20, v19
    v_pk_mul_f16 v21, v23, v22
    v_exp_f16 v19, v18
    v_exp_f16 v22, v21
    v_mfma_f32_32x32x16_f16 v[240:255], v[52:55], v[28:31], v[240:255]
    ds_read_b128 v[52:55], v9 offset:23552
    v_exp_f16_sdwa v19, v18 dst_sel:WORD_1 dst_unused:UNUSED_PRESERVE src0_sel:WORD_1
    v_exp_f16_sdwa v22, v21 dst_sel:WORD_1 dst_unused:UNUSED_PRESERVE src0_sel:WORD_1
    v_pk_fma_f16 v18, v19, s50, s50
    v_pk_fma_f16 v21, v22, s50, s50
    v_rcp_f16 v19, v18
    v_rcp_f16 v22, v21
    v_mfma_f32_32x32x16_bf16 v[96:111], v[64:67], v[132:135], v[96:111]
    ds_read_b128 v[64:67], v10 offset:14336
    v_rcp_f16_sdwa v19, v18 dst_sel:WORD_1 dst_unused:UNUSED_PRESERVE src0_sel:WORD_1
    v_rcp_f16_sdwa v22, v21 dst_sel:WORD_1 dst_unused:UNUSED_PRESERVE src0_sel:WORD_1
    v_pk_mul_f16 v26, v20, v19
    v_pk_mul_f16 v27, v23, v22
    v_cvt_pk_f16_f32 v20, v88, v89
    v_mfma_f32_32x32x16_bf16 v[96:111], v[68:71], v[140:143], v[96:111]
    ds_read_b128 v[68:71], v10 offset:15360
    v_cvt_pk_f16_f32 v23, v90, v91
    v_pk_fma_f16 v19, v20, v20, s49
    v_pk_fma_f16 v22, v23, v23, s49
    v_pk_mul_f16 v18, v20, v19
    v_pk_mul_f16 v21, v23, v22
    v_exp_f16_e64 v19, v18
    v_exp_f16 v22, v21
    s_waitcnt lgkmcnt(5)
    v_mfma_f32_32x32x16_f16 v[160:175], v[32:35], v[24:27], v[160:175]
    s_mov_b64 exec, s[80:81]
    s_nop 0
    s_add_u32 m0, s86, 4704
    s_add_u32 s71, s85, 4224
    buffer_load_dwordx4 v14, s[16:19], s71 offen nt lds
    s_add_u32 m0, s86, 5488
    s_add_u32 s71, s85, 4992
    buffer_load_dwordx4 v14, s[16:19], s71 offen nt lds
    s_add_u32 m0, s86, 6272
    s_add_u32 s71, s85, 5760
    buffer_load_dwordx4 v13, s[16:19], s71 offen nt lds
    s_mov_b64 exec, -1
    s_add_u32 s64, s64, 1
    v_exp_f16_sdwa v19, v18 dst_sel:WORD_1 dst_unused:UNUSED_PRESERVE src0_sel:WORD_1
    v_exp_f16_sdwa v22, v21 dst_sel:WORD_1 dst_unused:UNUSED_PRESERVE src0_sel:WORD_1
    v_pk_fma_f16 v18, v19, s50, s50
    v_pk_fma_f16 v21, v22, s50, s50
    v_rcp_f16_e64 v19, v18
    v_mfma_f32_32x32x16_bf16 v[96:111], v[72:75], v[148:151], v[96:111]
    ds_read_b128 v[72:75], v10 offset:16384
    v_rcp_f16_e64 v22, v21
    v_rcp_f16_sdwa v19, v18 dst_sel:WORD_1 dst_unused:UNUSED_PRESERVE src0_sel:WORD_1
    v_rcp_f16_sdwa v22, v21 dst_sel:WORD_1 dst_unused:UNUSED_PRESERVE src0_sel:WORD_1
    v_pk_mul_f16 v28, v20, v19
    v_pk_mul_f16 v29, v23, v22
    v_cvt_pk_f16_f32 v20, v92, v93
    v_mfma_f32_32x32x16_f16 v[176:191], v[36:39], v[24:27], v[176:191]
    v_cvt_pk_f16_f32 v23, v94, v95
    v_pk_fma_f16 v19, v20, v20, s49
    v_pk_fma_f16 v22, v23, v23, s49
    v_pk_mul_f16 v18, v20, v19
    v_pk_mul_f16 v21, v23, v22
    v_exp_f16 v19, v18
    v_exp_f16 v22, v21
    v_mfma_f32_32x32x16_bf16 v[96:111], v[76:79], v[156:159], v[96:111]
    ds_read_b128 v[76:79], v10 offset:17408
    v_exp_f16_sdwa v19, v18 dst_sel:WORD_1 dst_unused:UNUSED_PRESERVE src0_sel:WORD_1
    v_exp_f16_sdwa v22, v21 dst_sel:WORD_1 dst_unused:UNUSED_PRESERVE src0_sel:WORD_1
    v_pk_fma_f16 v18, v19, s50, s50
    v_pk_fma_f16 v21, v22, s50, s50
    v_rcp_f16 v19, v18
    s_waitcnt lgkmcnt(2)
    v_mfma_f32_32x32x16_f16 v[192:207], v[40:43], v[24:27], v[192:207]
    s_lshl_b32 s71, s39, 5
    s_add_u32 s71, s71, s64
    s_sub_u32 s71, s71, 2
    s_nop 0
    s_mul_i32 s85, s71, 98304
    s_mul_i32 s72, s38, 6144
    s_add_u32 s85, s85, s72
    s_nop 0
    s_cmp_lt_u32 s71, 512
    s_cselect_b32 s85, s85, 0x80000000
    s_cmp_ge_u32 s64, 24
    s_cselect_b32 s72, 24, 0
    s_sub_u32 s71, s64, s72
    s_cmp_ge_u32 s71, 12
    s_cselect_b32 s72, 12, 0
    s_sub_u32 s71, s71, s72
    s_and_b32 s72, s64, 4
    s_lshl_b32 s72, s72, 1
    s_mul_i32 s71, s71, 7104
    s_add_u32 s71, s71, s72
    s_nop 0
    s_add_u32 s86, s71, 78272
    s_mov_b64 exec, s[80:81]
    s_mov_b32 m0, s86
    s_sub_u32 s71, s85, s70
    s_nop 0
    buffer_load_dwordx4 v12, s[16:19], s71 offen nt lds
    s_add_u32 m0, s86, 784
    s_add_u32 s71, s85, 384
    buffer_load_dwordx4 v14, s[16:19], s71 offen nt lds
    s_add_u32 m0, s86, 1568
    s_add_u32 s71, s85, 1152
    buffer_load_dwordx4 v14, s[16:19], s71 offen nt lds
    s_mov_b64 exec, -1
    v_rcp_f16 v22, v21
    v_rcp_f16_sdwa v19, v18 dst_sel:WORD_1 dst_unused:UNUSED_PRESERVE src0_sel:WORD_1
    v_rcp_f16_sdwa v22, v21 dst_sel:WORD_1 dst_unused:UNUSED_PRESERVE src0_sel:WORD_1
    v_pk_mul_f16 v30, v20, v19
    v_pk_mul_f16 v31, v23, v22
    s_cmp_lg_u32 s56, 0
    s_cbranch_scc1 Ldry_ret
Lq31:
    s_setprio 0
    s_nop 0
    v_cvt_pk_f16_f32 v20, v96, v97
    v_cvt_pk_f16_f32 v23, v98, v99
    v_mfma_f32_32x32x16_f16 v[160:175], v[44:47], v[28:31], v[160:175]
    v_pk_fma_f16 v19, v20, v20, s49
    v_pk_fma_f16 v22, v23, v23, s49
    v_pk_mul_f16 v18, v20, v19
    v_pk_mul_f16 v21, v23, v22
    v_exp_f16 v19, v18
    v_exp_f16 v22, v21
    v_exp_f16_sdwa v19, v18 dst_sel:WORD_1 dst_unused:UNUSED_PRESERVE src0_sel:WORD_1
    v_mfma_f32_32x32x16_bf16 v[80:95], v[56:59], v[112:115], 0
    v_exp_f16_sdwa v22, v21 dst_sel:WORD_1 dst_unused:UNUSED_PRESERVE src0_sel:WORD_1
    v_pk_fma_f16 v18, v19, s50, s50
    v_pk_fma_f16 v21, v22, s50, s50
    v_rcp_f16 v19, v18
    v_rcp_f16 v22, v21
    v_mfma_f32_32x32x16_f16 v[176:191], v[48:51], v[28:31], v[176:191]
    v_rcp_f16_sdwa v19, v18 dst_sel:WORD_1 dst_unused:UNUSED_PRESERVE src0_sel:WORD_1
    v_rcp_f16_sdwa v22, v21 dst_sel:WORD_1 dst_unused:UNUSED_PRESERVE src0_sel:WORD_1
    v_pk_mul_f16 v24, v20, v19
    v_pk_mul_f16 v25, v23, v22
    v_cvt_pk_f16_f32 v20, v100, v101
    v_cvt_pk_f16_f32 v23, v102, v103
    v_mfma_f32_32x32x16_bf16 v[80:95], v[60:63], v[120:123], v[80:95]
    s_mov_b64 exec, s[80:81]
    s_nop 0
    s_add_u32 m0, s86, 2352
    s_add_u32 s71, s85, 1920
    buffer_load_dwordx4 v14, s[16:19], s71 offen nt lds
    s_add_u32 m0, s86, 3136
    s_add_u32 s71, s85, 2688
    buffer_load_dwordx4 v14, s[16:19], s71 offen nt lds
    s_add_u32 m0, s86, 3920
    s_add_u32 s71, s85, 3456
    buffer_load_dwordx4 v14, s[16:19], s71 offen nt lds
    s_mov_b64 exec, -1
    s_nop 0
    v_pk_fma_f16 v19, v20, v20, s49
    v_pk_fma_f16 v22, v23, v23, s49
    v_pk_mul_f16 v18, v20, v19
    v_pk_mul_f16 v21, v23, v22
    v_exp_f16 v19, v18
    v_exp_f16 v22, v21
    v_mfma_f32_32x32x16_f16 v[192:207], v[52:55], v[28:31], v[192:207]
    v_exp_f16_sdwa v19, v18 dst_sel:WORD_1 dst_unused:UNUSED_PRESERVE src0_sel:WORD_1
    v_exp_f16_sdwa v22, v21 dst_sel:WORD_1 dst_unused:UNUSED_PRESERVE src0_sel:WORD_1
    v_pk_fma_f16 v18, v19, s50, s50
    v_pk_fma_f16 v21, v22, s50, s50
    v_rcp_f16 v19, v18
    v_rcp_f16 v22, v21
    v_mfma_f32_32x32x16_bf16 v[80:95], v[64:67], v[128:131], v[80:95]
    v_rcp_f16_sdwa v19, v18 dst_sel:WORD_1 dst_unused:UNUSED_PRESERVE src0_sel:WORD_1
    v_rcp_f16_sdwa v22, v21 dst_sel:WORD_1 dst_unused:UNUSED_PRESERVE src0_sel:WORD_1
    v_pk_mul_f16 v26, v20, v19
    v_pk_mul_f16 v27, v23, v22
    v_cvt_pk_f16_f32 v20, v104, v105
    v_mfma_f32_32x32x16_bf16 v[80:95], v[68:71], v[136:139], v[80:95]
    v_cvt_pk_f16_f32 v23, v106, v107
    v_pk_fma_f16 v19, v20, v20, s49
    v_pk_fma_f16 v22, v23, v23, s49
    v_pk_mul_f16 v18, v20, v19
    v_pk_mul_f16 v21, v23, v22
    v_exp_f16 v19, v18
    v_exp_f16 v22, v21
    v_mfma_f32_32x32x16_f16 v[208:223], v[32:35], v[24:27], v[208:223]
    s_mov_b64 exec, s[80:81]
    s_nop 0
    s_add_u32 m0, s86, 4704
    s_add_u32 s71, s85, 4224
    buffer_load_dwordx4 v14, s[16:19], s71 offen nt lds
    s_add_u32 m0, s86, 5488
    s_add_u32 s71, s85, 4992
    buffer_load_dwordx4 v14, s[16:19], s71 offen nt lds
    s_add_u32 m0, s86, 6272
    s_add_u32 s71, s85, 5760
    buffer_load_dwordx4 v13, s[16:19], s71 offen nt lds
    s_mov_b64 exec, -1
    s_add_u32 s64, s64, 7
    v_exp_f16_sdwa v19, v18 dst_sel:WORD_1 dst_unused:UNUSED_PRESERVE src0_sel:WORD_1
    v_exp_f16_sdwa v22, v21 dst_sel:WORD_1 dst_unused:UNUSED_PRESERVE src0_sel:WORD_1
    v_pk_fma_f16 v18, v19, s50, s50
    v_pk_fma_f16 v21, v22, s50, s50
    v_rcp_f16 v19, v18
    s_waitcnt lgkmcnt(0)
    v_mfma_f32_32x32x16_bf16 v[80:95], v[72:75], v[144:147], v[80:95]
    v_rcp_f16_e64 v22, v21
    v_rcp_f16_sdwa v19, v18 dst_sel:WORD_1 dst_unused:UNUSED_PRESERVE src0_sel:WORD_1
    v_rcp_f16_sdwa v22, v21 dst_sel:WORD_1 dst_unused:UNUSED_PRESERVE src0_sel:WORD_1
    v_pk_mul_f16 v28, v20, v19
    v_pk_mul_f16 v29, v23, v22
    v_cvt_pk_f16_f32 v20, v108, v109
    v_mfma_f32_32x32x16_f16 v[224:239], v[36:39], v[24:27], v[224:239]
    v_cvt_pk_f16_f32 v23, v110, v111
    v_pk_fma_f16 v19, v20, v20, s49
    v_pk_fma_f16 v22, v23, v23, s49
    v_pk_mul_f16 v18, v20, v19
    v_pk_mul_f16 v21, v23, v22
    v_exp_f16 v19, v18
    v_exp_f16 v22, v21
    v_mfma_f32_32x32x16_bf16 v[80:95], v[76:79], v[152:155], v[80:95]
    v_exp_f16_sdwa v19, v18 dst_sel:WORD_1 dst_unused:UNUSED_PRESERVE src0_sel:WORD_1
    v_exp_f16_sdwa v22, v21 dst_sel:WORD_1 dst_unused:UNUSED_PRESERVE src0_sel:WORD_1
    v_pk_fma_f16 v18, v19, s50, s50
    v_pk_fma_f16 v21, v22, s50, s50
    v_rcp_f16_e64 v19, v18
    v_mfma_f32_32x32x16_f16 v[240:255], v[40:43], v[24:27], v[240:255]
    v_rcp_f16_e64 v22, v21
    v_rcp_f16_sdwa v19, v18 dst_sel:WORD_1 dst_unused:UNUSED_PRESERVE src0_sel:WORD_1
    v_rcp_f16_sdwa v22, v21 dst_sel:WORD_1 dst_unused:UNUSED_PRESERVE src0_sel:WORD_1
    v_pk_mul_f16 v30, v20, v19
    v_pk_mul_f16 v31, v23, v22
    s_cmp_lg_u32 s56, 0
    s_cbranch_scc1 Ldry_ret
    s_mov_b32 s66, 1
    s_mov_b32 s67, 1
    s_cmp_eq_u32 s47, 0
    s_cselect_b32 s48, 1, 5
    s_waitcnt vmcnt(18)
    s_branch Lnowait0P
.p2align 6
LloopAP:
    s_waitcnt vmcnt(0)
Lnowait0P:
    s_barrier
    s_sub_u32 s41, 82816, s41
Lbody0P:
    v_add_u32 v9, s41, v14
    s_cmp_eq_u32 s48, s67
    s_cselect_b32 s71, 0x30000, s41
    v_add_u32 v10, s71, v14
    s_setprio 3
    v_cvt_pk_f16_f32 v20, v80, v81
    v_cvt_pk_f16_f32 v23, v82, v83
    v_mfma_f32_32x32x16_f16 v[208:223], v[44:47], v[28:31], v[208:223]
    ds_read_b128 v[44:47], v9 offset:9216
    v_pk_fma_f16 v19, v20, v20, s49
    v_pk_fma_f16 v22, v23, v23, s49
    v_pk_mul_f16 v18, v20, v19
    v_pk_mul_f16 v21, v23, v22
    v_exp_f16 v19, v18
    v_exp_f16 v22, v21
    v_exp_f16_sdwa v19, v18 dst_sel:WORD_1 dst_unused:UNUSED_PRESERVE src0_sel:WORD_1
    v_mfma_f32_32x32x16_bf16 v[96:111], v[56:59], v[116:119], 0
    ds_read_b128 v[32:35], v9 offset:6144
    ds_read_b128 v[56:59], v9 offset:0
    v_exp_f16_sdwa v22, v21 dst_sel:WORD_1 dst_unused:UNUSED_PRESERVE src0_sel:WORD_1
    v_pk_fma_f16 v18, v19, s50, s50
    v_pk_fma_f16 v21, v22, s50, s50
    v_rcp_f16 v19, v18
    v_rcp_f16 v22, v21
    v_mfma_f32_32x32x16_f16 v[224:239], v[48:51], v[28:31], v[224:239]
    ds_read_b128 v[36:39], v9 offset:7168
    ds_read_b128 v[48:51], v9 offset:10240
    v_rcp_f16_sdwa v19, v18 dst_sel:WORD_1 dst_unused:UNUSED_PRESERVE src0_sel:WORD_1
    v_rcp_f16_sdwa v22, v21 dst_sel:WORD_1 dst_unused:UNUSED_PRESERVE src0_sel:WORD_1
    v_pk_mul_f16 v24, v20, v19
    v_pk_mul_f16 v25, v23, v22
    v_cvt_pk_f16_f32 v20, v84, v85
    v_cvt_pk_f16_f32 v23, v86, v87
    v_mfma_f32_32x32x16_bf16 v[96:111], v[60:63], v[124:127], v[96:111]
    ds_read_b128 v[40:43], v9 offset:8192
    ds_read_b128 v[60:63], v9 offset:1024
    v_pk_fma_f16 v19, v20, v20, s49
    v_pk_fma_f16 v22, v23, v23, s49
    v_pk_mul_f16 v18, v20, v19
    v_pk_mul_f16 v21, v23, v22
    v_exp_f16 v19, v18
    v_exp_f16 v22, v21
    v_mfma_f32_32x32x16_f16 v[240:255], v[52:55], v[28:31], v[240:255]
    ds_read_b128 v[52:55], v9 offset:11264
    v_exp_f16_sdwa v19, v18 dst_sel:WORD_1 dst_unused:UNUSED_PRESERVE src0_sel:WORD_1
    v_exp_f16_sdwa v22, v21 dst_sel:WORD_1 dst_unused:UNUSED_PRESERVE src0_sel:WORD_1
    v_pk_fma_f16 v18, v19, s50, s50
    v_pk_fma_f16 v21, v22, s50, s50
    v_rcp_f16 v19, v18
    v_rcp_f16 v22, v21
    v_mfma_f32_32x32x16_bf16 v[96:111], v[64:67], v[132:135], v[96:111]
    ds_read_b128 v[64:67], v9 offset:2048
    v_rcp_f16_sdwa v19, v18 dst_sel:WORD_1 dst_unused:UNUSED_PRESERVE src0_sel:WORD_1
    v_rcp_f16_sdwa v22, v21 dst_sel:WORD_1 dst_unused:UNUSED_PRESERVE src0_sel:WORD_1
    v_pk_mul_f16 v26, v20, v19
    v_pk_mul_f16 v27, v23, v22
    v_cvt_pk_f16_f32 v20, v88, v89
    v_mfma_f32_32x32x16_bf16 v[96:111], v[68:71], v[140:143], v[96:111]
    ds_read_b128 v[68:71], v9 offset:3072
    v_cvt_pk_f16_f32 v23, v90, v91
    v_pk_fma_f16 v19, v20, v20, s49
    v_pk_fma_f16 v22, v23, v23, s49
    v_pk_mul_f16 v18, v20, v19
    v_pk_mul_f16 v21, v23, v22
    v_exp_f16_e64 v19, v18
    v_exp_f16 v22, v21
    s_waitcnt lgkmcnt(5)
    v_mfma_f32_32x32x16_f16 v[160:175], v[32:35], v[24:27], v[160:175]
    s_sub_u32 s78, 82816, s41
    s_add_u32 m0, s78, s88
    s_add_u32 s79, s42, s46
    buffer_load_dwordx4 v11, s[24:27], s79 offen sc1 lds
    v_exp_f16_sdwa v19, v18 dst_sel:WORD_1 dst_unused:UNUSED_PRESERVE src0_sel:WORD_1
    v_exp_f16_sdwa v22, v21 dst_sel:WORD_1 dst_unused:UNUSED_PRESERVE src0_sel:WORD_1
    v_pk_fma_f16 v18, v19, s50, s50
    v_pk_fma_f16 v21, v22, s50, s50
    v_rcp_f16_e64 v19, v18
    v_mfma_f32_32x32x16_bf16 v[96:111], v[72:75], v[148:151], v[96:111]
    ds_read_b128 v[72:75], v9 offset:4096
    v_rcp_f16_e64 v22, v21
    v_rcp_f16_sdwa v19, v18 dst_sel:WORD_1 dst_unused:UNUSED_PRESERVE src0_sel:WORD_1
    v_rcp_f16_sdwa v22, v21 dst_sel:WORD_1 dst_unused:UNUSED_PRESERVE src0_sel:WORD_1
    v_pk_mul_f16 v28, v20, v19
    v_pk_mul_f16 v29, v23, v22
    v_cvt_pk_f16_f32 v20, v92, v93
    v_mfma_f32_32x32x16_f16 v[176:191], v[36:39], v[24:27], v[176:191]
    s_add_u32 m0, m0, s89
    s_add_u32 s79, s79, s45
    buffer_load_dwordx4 v11, s[24:27], s79 offen sc1 lds
    v_cvt_pk_f16_f32 v23, v94, v95
    v_pk_fma_f16 v19, v20, v20, s49
    v_pk_fma_f16 v22, v23, v23, s49
    v_pk_mul_f16 v18, v20, v19
    v_pk_mul_f16 v21, v23, v22
    v_exp_f16 v19, v18
    v_exp_f16 v22, v21
    v_mfma_f32_32x32x16_bf16 v[96:111], v[76:79], v[156:159], v[96:111]
    ds_read_b128 v[76:79], v9 offset:5120
    v_exp_f16_sdwa v19, v18 dst_sel:WORD_1 dst_unused:UNUSED_PRESERVE src0_sel:WORD_1
    v_exp_f16_sdwa v22, v21 dst_sel:WORD_1 dst_unused:UNUSED_PRESERVE src0_sel:WORD_1
    v_pk_fma_f16 v18, v19, s50, s50
    v_pk_fma_f16 v21, v22, s50, s50
    v_rcp_f16 v19, v18
    s_waitcnt lgkmcnt(2)
    v_mfma_f32_32x32x16_f16 v[192:207], v[40:43], v[24:27], v[192:207]
    s_add_u32 m0, m0, s89
    s_add_u32 s79, s79, s45
    buffer_load_dwordx4 v11, s[24:27], s79 offen sc1 lds
    s_add_u32 s42, s42, s43
    s_cmp_eq_u32 s42, s44
    s_cselect_b32 s42, 0, s42
    v_rcp_f16 v22, v21
    v_rcp_f16_sdwa v19, v18 dst_sel:WORD_1 dst_unused:UNUSED_PRESERVE src0_sel:WORD_1
    v_rcp_f16_sdwa v22, v21 dst_sel:WORD_1 dst_unused:UNUSED_PRESERVE src0_sel:WORD_1
    v_pk_mul_f16 v30, v20, v19
    v_pk_mul_f16 v31, v23, v22
    s_setprio 2
    s_nop 0
    v_cvt_pk_f16_f32 v20, v96, v97
    v_cvt_pk_f16_f32 v23, v98, v99
    v_mfma_f32_32x32x16_f16 v[160:175], v[44:47], v[28:31], v[160:175]
    v_pk_fma_f16 v19, v20, v20, s49
    v_pk_fma_f16 v22, v23, v23, s49
    v_pk_mul_f16 v18, v20, v19
    v_pk_mul_f16 v21, v23, v22
    v_exp_f16 v19, v18
    v_exp_f16 v22, v21
    v_exp_f16_sdwa v19, v18 dst_sel:WORD_1 dst_unused:UNUSED_PRESERVE src0_sel:WORD_1
    v_mfma_f32_32x32x16_bf16 v[80:95], v[56:59], v[112:115], 0
    s_add_u32 s78, s78, 12288
    s_add_u32 m0, s78, s88
    s_add_u32 s79, s42, s46
    buffer_load_dwordx4 v11, s[24:27], s79 offen sc1 lds
    v_exp_f16_sdwa v22, v21 dst_sel:WORD_1 dst_unused:UNUSED_PRESERVE src0_sel:WORD_1
    v_pk_fma_f16 v18, v19, s50, s50
    v_pk_fma_f16 v21, v22, s50, s50
    v_rcp_f16 v19, v18
    v_rcp_f16 v22, v21
    v_mfma_f32_32x32x16_f16 v[176:191], v[48:51], v[28:31], v[176:191]
    v_rcp_f16_sdwa v19, v18 dst_sel:WORD_1 dst_unused:UNUSED_PRESERVE src0_sel:WORD_1
    v_rcp_f16_sdwa v22, v21 dst_sel:WORD_1 dst_unused:UNUSED_PRESERVE src0_sel:WORD_1
    v_pk_mul_f16 v24, v20, v19
    v_pk_mul_f16 v25, v23, v22
    v_cvt_pk_f16_f32 v20, v100, v101
    v_cvt_pk_f16_f32 v23, v102, v103
    v_mfma_f32_32x32x16_bf16 v[80:95], v[60:63], v[120:123], v[80:95]
    s_add_u32 m0, m0, s89
    s_add_u32 s79, s79, s45
    buffer_load_dwordx4 v11, s[24:27], s79 offen sc1 lds
    v_pk_fma_f16 v19, v20, v20, s49
    v_pk_fma_f16 v22, v23, v23, s49
    v_pk_mul_f16 v18, v20, v19
    v_pk_mul_f16 v21, v23, v22
    v_exp_f16 v19, v18
    v_exp_f16 v22, v21
    v_mfma_f32_32x32x16_f16 v[192:207], v[52:55], v[28:31], v[192:207]
    v_exp_f16_sdwa v19, v18 dst_sel:WORD_1 dst_unused:UNUSED_PRESERVE src0_sel:WORD_1
    v_exp_f16_sdwa v22, v21 dst_sel:WORD_1 dst_unused:UNUSED_PRESERVE src0_sel:WORD_1
    v_pk_fma_f16 v18, v19, s50, s50
    v_pk_fma_f16 v21, v22, s50, s50
    v_rcp_f16 v19, v18
    v_rcp_f16 v22, v21
    v_mfma_f32_32x32x16_bf16 v[80:95], v[64:67], v[128:131], v[80:95]
    s_add_u32 m0, m0, s89
    s_add_u32 s79, s79, s45
    buffer_load_dwordx4 v11, s[24:27], s79 offen sc1 lds
    s_add_u32 s42, s42, s43
    s_cmp_eq_u32 s42, s44
    s_cselect_b32 s42, 0, s42
    s_nop 0
    v_rcp_f16_sdwa v19, v18 dst_sel:WORD_1 dst_unused:UNUSED_PRESERVE src0_sel:WORD_1
    v_rcp_f16_sdwa v22, v21 dst_sel:WORD_1 dst_unused:UNUSED_PRESERVE src0_sel:WORD_1
    v_pk_mul_f16 v26, v20, v19
    v_pk_mul_f16 v27, v23, v22
    v_cvt_pk_f16_f32 v20, v104, v105
    v_mfma_f32_32x32x16_bf16 v[80:95], v[68:71], v[136:139], v[80:95]
    v_cvt_pk_f16_f32 v23, v106, v107
    v_pk_fma_f16 v19, v20, v20, s49
    v_pk_fma_f16 v22, v23, v23, s49
    v_pk_mul_f16 v18, v20, v19
    v_pk_mul_f16 v21, v23, v22
    v_exp_f16 v19, v18
    v_exp_f16 v22, v21
    v_mfma_f32_32x32x16_f16 v[208:223], v[32:35], v[24:27], v[208:223]
    v_exp_f16_sdwa v19, v18 dst_sel:WORD_1 dst_unused:UNUSED_PRESERVE src0_sel:WORD_1
    v_exp_f16_sdwa v22, v21 dst_sel:WORD_1 dst_unused:UNUSED_PRESERVE src0_sel:WORD_1
    v_pk_fma_f16 v18, v19, s50, s50
    v_pk_fma_f16 v21, v22, s50, s50
    v_rcp_f16 v19, v18
    s_waitcnt lgkmcnt(0)
    v_mfma_f32_32x32x16_bf16 v[80:95], v[72:75], v[144:147], v[80:95]
    v_rcp_f16_e64 v22, v21
    v_rcp_f16_sdwa v19, v18 dst_sel:WORD_1 dst_unused:UNUSED_PRESERVE src0_sel:WORD_1
    v_rcp_f16_sdwa v22, v21 dst_sel:WORD_1 dst_unused:UNUSED_PRESERVE src0_sel:WORD_1
    v_pk_mul_f16 v28, v20, v19
    v_pk_mul_f16 v29, v23, v22
    v_cvt_pk_f16_f32 v20, v108, v109
    v_mfma_f32_32x32x16_f16 v[224:239], v[36:39], v[24:27], v[224:239]
    v_cvt_pk_f16_f32 v23, v110, v111
    v_pk_fma_f16 v19, v20, v20, s49
    v_pk_fma_f16 v22, v23, v23, s49
    v_pk_mul_f16 v18, v20, v19
    v_pk_mul_f16 v21, v23, v22
    v_exp_f16 v19, v18
    v_exp_f16 v22, v21
    v_mfma_f32_32x32x16_bf16 v[80:95], v[76:79], v[152:155], v[80:95]
    v_exp_f16_sdwa v19, v18 dst_sel:WORD_1 dst_unused:UNUSED_PRESERVE src0_sel:WORD_1
    v_exp_f16_sdwa v22, v21 dst_sel:WORD_1 dst_unused:UNUSED_PRESERVE src0_sel:WORD_1
    v_pk_fma_f16 v18, v19, s50, s50
    v_pk_fma_f16 v21, v22, s50, s50
    v_rcp_f16_e64 v19, v18
    v_mfma_f32_32x32x16_f16 v[240:255], v[40:43], v[24:27], v[240:255]
    v_rcp_f16_e64 v22, v21
    v_rcp_f16_sdwa v19, v18 dst_sel:WORD_1 dst_unused:UNUSED_PRESERVE src0_sel:WORD_1
    v_rcp_f16_sdwa v22, v21 dst_sel:WORD_1 dst_unused:UNUSED_PRESERVE src0_sel:WORD_1
    v_pk_mul_f16 v30, v20, v19
    v_pk_mul_f16 v31, v23, v22
    s_cmp_lg_u32 s56, 0
    s_cbranch_scc1 Ldry_ret
Lhalf0:
    s_setprio 1
    s_nop 0
    v_cvt_pk_f16_f32 v20, v80, v81
    v_cvt_pk_f16_f32 v23, v82, v83
    v_mfma_f32_32x32x16_f16 v[208:223], v[44:47], v[28:31], v[208:223]
    ds_read_b128 v[44:47], v9 offset:21504
    v_pk_fma_f16 v19, v20, v20, s49
    v_pk_fma_f16 v22, v23, v23, s49
    v_pk_mul_f16 v18, v20, v19
    v_pk_mul_f16 v21, v23, v22
    v_exp_f16 v19, v18
    v_exp_f16 v22, v21
    v_exp_f16_sdwa v19, v18 dst_sel:WORD_1 dst_unused:UNUSED_PRESERVE src0_sel:WORD_1
    v_mfma_f32_32x32x16_bf16 v[96:111], v[56:59], v[116:119], 0
    ds_read_b128 v[32:35], v9 offset:18432
    ds_read_b128 v[56:59], v10 offset:12288
    v_exp_f16_sdwa v22, v21 dst_sel:WORD_1 dst_unused:UNUSED_PRESERVE src0_sel:WORD_1
    v_pk_fma_f16 v18, v19, s50, s50
    v_pk_fma_f16 v21, v22, s50, s50
    v_rcp_f16 v19, v18
    v_rcp_f16 v22, v21
    v_mfma_f32_32x32x16_f16 v[224:239], v[48:51], v[28:31], v[224:239]
    ds_read_b128 v[36:39], v9 offset:19456
    ds_read_b128 v[48:51], v9 offset:22528
    v_rcp_f16_sdwa v19, v18 dst_sel:WORD_1 dst_unused:UNUSED_PRESERVE src0_sel:WORD_1
    v_rcp_f16_sdwa v22, v21 dst_sel:WORD_1 dst_unused:UNUSED_PRESERVE src0_sel:WORD_1
    v_pk_mul_f16 v24, v20, v19
    v_pk_mul_f16 v25, v23, v22
    v_cvt_pk_f16_f32 v20, v84, v85
    v_cvt_pk_f16_f32 v23, v86, v87
    v_mfma_f32_32x32x16_bf16 v[96:111], v[60:63], v[124:127], v[96:111]
    ds_read_b128 v[40:43], v9 offset:20480
    ds_read_b128 v[60:63], v10 offset:13312
    v_pk_fma_f16 v19, v20, v20, s49
    v_pk_fma_f16 v22, v23, v23, s49
    v_pk_mul_f16 v18, v20, v19
    v_pk_mul_f16 v21, v23, v22
    v_exp_f16 v19, v18
    v_exp_f16 v22, v21
    v_mfma_f32_32x32x16_f16 v[240:255], v[52:55], v[28:31], v[240:255]
    ds_read_b128 v[52:55], v9 offset:23552
    v_exp_f16_sdwa v19, v18 dst_sel:WORD_1 dst_unused:UNUSED_PRESERVE src0_sel:WORD_1
    v_exp_f16_sdwa v22, v21 dst_sel:WORD_1 dst_unused:UNUSED_PRESERVE src0_sel:WORD_1
    v_pk_fma_f16 v18, v19, s50, s50
    v_pk_fma_f16 v21, v22, s50, s50
    v_rcp_f16 v19, v18
    v_rcp_f16 v22, v21
    v_mfma_f32_32x32x16_bf16 v[96:111], v[64:67], v[132:135], v[96:111]
    ds_read_b128 v[64:67], v10 offset:14336
    v_rcp_f16_sdwa v19, v18 dst_sel:WORD_1 dst_unused:UNUSED_PRESERVE src0_sel:WORD_1
    v_rcp_f16_sdwa v22, v21 dst_sel:WORD_1 dst_unused:UNUSED_PRESERVE src0_sel:WORD_1
    v_pk_mul_f16 v26, v20, v19
    v_pk_mul_f16 v27, v23, v22
    v_cvt_pk_f16_f32 v20, v88, v89
    v_mfma_f32_32x32x16_bf16 v[96:111], v[68:71], v[140:143], v[96:111]
    ds_read_b128 v[68:71], v10 offset:15360
    v_cvt_pk_f16_f32 v23, v90, v91
    v_pk_fma_f16 v19, v20, v20, s49
    v_pk_fma_f16 v22, v23, v23, s49
    v_pk_mul_f16 v18, v20, v19
    v_pk_mul_f16 v21, v23, v22
    v_exp_f16_e64 v19, v18
    v_exp_f16 v22, v21
    s_waitcnt lgkmcnt(5)
    v_mfma_f32_32x32x16_f16 v[160:175], v[32:35], v[24:27], v[160:175]
    v_exp_f16_sdwa v19, v18 dst_sel:WORD_1 dst_unused:UNUSED_PRESERVE src0_sel:WORD_1
    v_exp_f16_sdwa v22, v21 dst_sel:WORD_1 dst_unused:UNUSED_PRESERVE src0_sel:WORD_1
    v_pk_fma_f16 v18, v19, s50, s50
    v_pk_fma_f16 v21, v22, s50, s50
    v_rcp_f16_e64 v19, v18
    v_mfma_f32_32x32x16_bf16 v[96:111], v[72:75], v[148:151], v[96:111]
    ds_read_b128 v[72:75], v10 offset:16384
    v_rcp_f16_e64 v22, v21
    v_rcp_f16_sdwa v19, v18 dst_sel:WORD_1 dst_unused:UNUSED_PRESERVE src0_sel:WORD_1
    v_rcp_f16_sdwa v22, v21 dst_sel:WORD_1 dst_unused:UNUSED_PRESERVE src0_sel:WORD_1
    v_pk_mul_f16 v28, v20, v19
    v_pk_mul_f16 v29, v23, v22
    v_cvt_pk_f16_f32 v20, v92, v93
    v_mfma_f32_32x32x16_f16 v[176:191], v[36:39], v[24:27], v[176:191]
    v_cvt_pk_f16_f32 v23, v94, v95
    v_pk_fma_f16 v19, v20, v20, s49
    v_pk_fma_f16 v22, v23, v23, s49
    v_pk_mul_f16 v18, v20, v19
    v_pk_mul_f16 v21, v23, v22
    v_exp_f16 v19, v18
    v_exp_f16 v22, v21
    v_mfma_f32_32x32x16_bf16 v[96:111], v[76:79], v[156:159], v[96:111]
    ds_read_b128 v[76:79], v10 offset:17408
    v_exp_f16_sdwa v19, v18 dst_sel:WORD_1 dst_unused:UNUSED_PRESERVE src0_sel:WORD_1
    v_exp_f16_sdwa v22, v21 dst_sel:WORD_1 dst_unused:UNUSED_PRESERVE src0_sel:WORD_1
    v_pk_fma_f16 v18, v19, s50, s50
    v_pk_fma_f16 v21, v22, s50, s50
    v_rcp_f16 v19, v18
    s_waitcnt lgkmcnt(2)
    v_mfma_f32_32x32x16_f16 v[192:207], v[40:43], v[24:27], v[192:207]
    v_rcp_f16_e64 v22, v21
    v_rcp_f16_sdwa v19, v18 dst_sel:WORD_1 dst_unused:UNUSED_PRESERVE src0_sel:WORD_1
    v_rcp_f16_sdwa v22, v21 dst_sel:WORD_1 dst_unused:UNUSED_PRESERVE src0_sel:WORD_1
    v_pk_mul_f16 v30, v20, v19
    v_pk_mul_f16 v31, v23, v22
    s_setprio 0
    s_nop 0
    v_cvt_pk_f16_f32 v20, v96, v97
    v_cvt_pk_f16_f32 v23, v98, v99
    v_mfma_f32_32x32x16_f16 v[160:175], v[44:47], v[28:31], v[160:175]
    v_pk_fma_f16 v19, v20, v20, s49
    v_pk_fma_f16 v22, v23, v23, s49
    v_pk_mul_f16 v18, v20, v19
    v_pk_mul_f16 v21, v23, v22
    v_exp_f16 v19, v18
    v_exp_f16 v22, v21
    v_exp_f16_sdwa v19, v18 dst_sel:WORD_1 dst_unused:UNUSED_PRESERVE src0_sel:WORD_1
    v_mfma_f32_32x32x16_bf16 v[80:95], v[56:59], v[112:115], 0
    v_exp_f16_sdwa v22, v21 dst_sel:WORD_1 dst_unused:UNUSED_PRESERVE src0_sel:WORD_1
    v_pk_fma_f16 v18, v19, s50, s50
    v_pk_fma_f16 v21, v22, s50, s50
    v_rcp_f16 v19, v18
    v_rcp_f16 v22, v21
    v_mfma_f32_32x32x16_f16 v[176:191], v[48:51], v[28:31], v[176:191]
    v_rcp_f16_sdwa v19, v18 dst_sel:WORD_1 dst_unused:UNUSED_PRESERVE src0_sel:WORD_1
    v_rcp_f16_sdwa v22, v21 dst_sel:WORD_1 dst_unused:UNUSED_PRESERVE src0_sel:WORD_1
    v_pk_mul_f16 v24, v20, v19
    v_pk_mul_f16 v25, v23, v22
    v_cvt_pk_f16_f32 v20, v100, v101
    v_cvt_pk_f16_f32 v23, v102, v103
    v_mfma_f32_32x32x16_bf16 v[80:95], v[60:63], v[120:123], v[80:95]
    v_pk_fma_f16 v19, v20, v20, s49
    v_pk_fma_f16 v22, v23, v23, s49
    v_pk_mul_f16 v18, v20, v19
    v_pk_mul_f16 v21, v23, v22
    v_exp_f16 v19, v18
    v_exp_f16 v22, v21
    v_mfma_f32_32x32x16_f16 v[192:207], v[52:55], v[28:31], v[192:207]
    v_exp_f16_sdwa v19, v18 dst_sel:WORD_1 dst_unused:UNUSED_PRESERVE src0_sel:WORD_1
    v_exp_f16_sdwa v22, v21 dst_sel:WORD_1 dst_unused:UNUSED_PRESERVE src0_sel:WORD_1
    v_pk_fma_f16 v18, v19, s50, s50
    v_pk_fma_f16 v21, v22, s50, s50
    v_rcp_f16 v19, v18
    v_rcp_f16 v22, v21
    v_mfma_f32_32x32x16_bf16 v[80:95], v[64:67], v[128:131], v[80:95]
    v_rcp_f16_sdwa v19, v18 dst_sel:WORD_1 dst_unused:UNUSED_PRESERVE src0_sel:WORD_1
    v_rcp_f16_sdwa v22, v21 dst_sel:WORD_1 dst_unused:UNUSED_PRESERVE src0_sel:WORD_1
    v_pk_mul_f16 v26, v20, v19
    v_pk_mul_f16 v27, v23, v22
    v_cvt_pk_f16_f32 v20, v104, v105
    v_mfma_f32_32x32x16_bf16 v[80:95], v[68:71], v[136:139], v[80:95]
    v_cvt_pk_f16_f32 v23, v106, v107
    v_pk_fma_f16 v19, v20, v20, s49
    v_pk_fma_f16 v22, v23, v23, s49
    v_pk_mul_f16 v18, v20, v19
    v_pk_mul_f16 v21, v23, v22
    v_exp_f16 v19, v18
    v_exp_f16 v22, v21
    v_mfma_f32_32x32x16_f16 v[208:223], v[32:35], v[24:27], v[208:223]
    v_exp_f16_sdwa v19, v18 dst_sel:WORD_1 dst_unused:UNUSED_PRESERVE src0_sel:WORD_1
    v_exp_f16_sdwa v22, v21 dst_sel:WORD_1 dst_unused:UNUSED_PRESERVE src0_sel:WORD_1
    v_pk_fma_f16 v18, v19, s50, s50
    v_pk_fma_f16 v21, v22, s50, s50
    v_rcp_f16 v19, v18
    s_waitcnt lgkmcnt(0)
    v_mfma_f32_32x32x16_bf16 v[80:95], v[72:75], v[144:147], v[80:95]
    v_rcp_f16_e64 v22, v21
    v_rcp_f16_sdwa v19, v18 dst_sel:WORD_1 dst_unused:UNUSED_PRESERVE src0_sel:WORD_1
    v_rcp_f16_sdwa v22, v21 dst_sel:WORD_1 dst_unused:UNUSED_PRESERVE src0_sel:WORD_1
    v_pk_mul_f16 v28, v20, v19
    v_pk_mul_f16 v29, v23, v22
    v_cvt_pk_f16_f32 v20, v108, v109
    v_mfma_f32_32x32x16_f16 v[224:239], v[36:39], v[24:27], v[224:239]
    v_cvt_pk_f16_f32 v23, v110, v111
    v_pk_fma_f16 v19, v20, v20, s49
    v_pk_fma_f16 v22, v23, v23, s49
    v_pk_mul_f16 v18, v20, v19
    v_pk_mul_f16 v21, v23, v22
    v_exp_f16 v19, v18
    v_exp_f16 v22, v21
    v_mfma_f32_32x32x16_bf16 v[80:95], v[76:79], v[152:155], v[80:95]
    v_exp_f16_sdwa v19, v18 dst_sel:WORD_1 dst_unused:UNUSED_PRESERVE src0_sel:WORD_1
    v_exp_f16_sdwa v22, v21 dst_sel:WORD_1 dst_unused:UNUSED_PRESERVE src0_sel:WORD_1
    v_pk_fma_f16 v18, v19, s50, s50
    v_pk_fma_f16 v21, v22, s50, s50
    v_rcp_f16_e64 v19, v18
    v_mfma_f32_32x32x16_f16 v[240:255], v[40:43], v[24:27], v[240:255]
    v_rcp_f16_e64 v22, v21
    v_rcp_f16_sdwa v19, v18 dst_sel:WORD_1 dst_unused:UNUSED_PRESERVE src0_sel:WORD_1
    v_rcp_f16_sdwa v22, v21 dst_sel:WORD_1 dst_unused:UNUSED_PRESERVE src0_sel:WORD_1
    v_pk_mul_f16 v30, v20, v19
    v_pk_mul_f16 v31, v23, v22
    s_sub_u32 s48, s48, 1
    s_cmp_lg_u32 s48, 0
    s_cbranch_scc1 LloopAP
    s_cmp_lg_u32 s56, 0
    s_cbranch_scc1 Ldry_ret
    s_mov_b32 s48, 9
    s_cmp_eq_u32 s66, 0
    s_cbranch_scc1 LloopXP
    s_add_u32 s63, s63, 4
    s_cmp_ge_u32 s63, 12
    s_cselect_b32 s63, 0, s63
    s_add_u32 s47, s47, 1
    s_cmp_eq_u32 s47, 1
    s_cbranch_scc1 LouterP
    s_waitcnt vmcnt(0)
    s_barrier
    s_sub_u32 s41, 82816, s41
    s_sub_u32 s78, 82816, s41
    s_add_u32 m0, s78, s88
    s_add_u32 s79, s42, s46
    buffer_load_dwordx4 v11, s[24:27], s79 offen sc1 lds
    s_add_u32 m0, m0, s89
    s_add_u32 s79, s79, s45
    buffer_load_dwordx4 v11, s[24:27], s79 offen sc1 lds
    s_add_u32 m0, m0, s89
    s_add_u32 s79, s79, s45
    buffer_load_dwordx4 v11, s[24:27], s79 offen sc1 lds
    s_add_u32 s42, s42, s43
    s_cmp_eq_u32 s42, s44
    s_cselect_b32 s42, 0, s42
    s_nop 0
    s_add_u32 s78, s78, 12288
    s_add_u32 m0, s78, s88
    s_add_u32 s79, s42, s46
    buffer_load_dwordx4 v11, s[24:27], s79 offen sc1 lds
    s_add_u32 m0, m0, s89
    s_add_u32 s79, s79, s45
    buffer_load_dwordx4 v11, s[24:27], s79 offen sc1 lds
    s_add_u32 m0, m0, s89
    s_add_u32 s79, s79, s45
    buffer_load_dwordx4 v11, s[24:27], s79 offen sc1 lds
    s_add_u32 s42, s42, s43
    s_cmp_eq_u32 s42, s44
    s_cselect_b32 s42, 0, s42
    s_getpc_b64 s[60:61]
Lpc3:
    s_add_u32 s60, s60, Lbody3P-Lpc3
    s_addc_u32 s61, s61, 0
    s_lshl_b32 s71, s37, 11
    v_lshl_add_u32 v18, v14, 1, s71
    global_load_dword v19, v18, s[60:61]
    v_cvt_pk_bf16_f32 v112, v160, v161
    v_cvt_pk_bf16_f32 v113, v162, v163
    v_mfma_f32_32x32x16_f16 v[208:223], v[44:47], v[28:31], v[208:223]
    v_cvt_pk_bf16_f32 v114, v164, v165
    v_cvt_pk_bf16_f32 v115, v166, v167
    v_cvt_pk_bf16_f32 v116, v168, v169
    v_cvt_pk_bf16_f32 v117, v170, v171
    v_cvt_pk_bf16_f32 v118, v172, v173
    v_cvt_pk_bf16_f32 v119, v174, v175
    v_cvt_pk_bf16_f32 v120, v176, v177
    v_mfma_f32_32x32x16_f16 v[224:239], v[48:51], v[28:31], v[224:239]
    v_cvt_pk_bf16_f32 v121, v178, v179
    v_cvt_pk_bf16_f32 v122, v180, v181
    v_cvt_pk_bf16_f32 v123, v182, v183
    v_cvt_pk_bf16_f32 v124, v184, v185
    v_cvt_pk_bf16_f32 v125, v186, v187
    v_cvt_pk_bf16_f32 v126, v188, v189
    v_cvt_pk_bf16_f32 v127, v190, v191
    v_mfma_f32_32x32x16_f16 v[240:255], v[52:55], v[28:31], v[240:255]
    v_permlane16_swap_b32 v112, v116
    v_permlane16_swap_b32 v113, v117
    v_permlane16_swap_b32 v114, v118
    v_permlane16_swap_b32 v115, v119
    buffer_store_dwordx4 v[112:115], v6, s[20:23], s51 offen offset:0 sc0 sc1
    buffer_store_dwordx4 v[116:119], v6, s[20:23], s51 offen offset:3072 sc0 sc1
    v_cvt_pk_bf16_f32 v128, v192, v193
    v_cvt_pk_bf16_f32 v129, v194, v195
    v_cvt_pk_bf16_f32 v130, v196, v197
    v_cvt_pk_bf16_f32 v131, v198, v199
    v_cvt_pk_bf16_f32 v132, v200, v201
    v_cvt_pk_bf16_f32 v133, v202, v203
    v_cvt_pk_bf16_f32 v134, v204, v205
    v_cvt_pk_bf16_f32 v135, v206, v207
    v_permlane16_swap_b32 v120, v124
    v_permlane16_swap_b32 v121, v125
    v_permlane16_swap_b32 v122, v126
    v_permlane16_swap_b32 v123, v127
    buffer_store_dwordx4 v[120:123], v6, s[20:23], s51 offen offset:64 sc0 sc1
    buffer_store_dwordx4 v[124:127], v6, s[20:23], s51 offen offset:3136 sc0 sc1
    v_cvt_pk_bf16_f32 v136, v208, v209
    v_cvt_pk_bf16_f32 v137, v210, v211
    v_cvt_pk_bf16_f32 v138, v212, v213
    v_cvt_pk_bf16_f32 v139, v214, v215
    v_cvt_pk_bf16_f32 v140, v216, v217
    v_cvt_pk_bf16_f32 v141, v218, v219
    v_cvt_pk_bf16_f32 v142, v220, v221
    v_cvt_pk_bf16_f32 v143, v222, v223
    v_permlane16_swap_b32 v128, v132
    v_permlane16_swap_b32 v129, v133
    v_permlane16_swap_b32 v130, v134
    v_permlane16_swap_b32 v131, v135
    buffer_store_dwordx4 v[128:131], v6, s[20:23], s51 offen offset:128 sc0 sc1
    buffer_store_dwordx4 v[132:135], v6, s[20:23], s51 offen offset:3200 sc0 sc1
    s_waitcnt vmcnt(6)
    s_barrier
    s_sub_u32 s41, 82816, s41
    s_sub_u32 s78, 82816, s41
    s_add_u32 m0, s78, s88
    s_add_u32 s79, s42, s46
    buffer_load_dwordx4 v11, s[24:27], s79 offen sc1 lds
    s_add_u32 m0, m0, s89
    s_add_u32 s79, s79, s45
    buffer_load_dwordx4 v11, s[24:27], s79 offen sc1 lds
    s_add_u32 m0, m0, s89
    s_add_u32 s79, s79, s45
    buffer_load_dwordx4 v11, s[24:27], s79 offen sc1 lds
    s_add_u32 s42, s42, s43
    s_cmp_eq_u32 s42, s44
    s_cselect_b32 s42, 0, s42
    s_nop 0
    s_add_u32 s78, s78, 12288
    s_add_u32 m0, s78, s88
    s_add_u32 s79, s42, s46
    buffer_load_dwordx4 v11, s[24:27], s79 offen sc1 lds
    s_add_u32 m0, m0, s89
    s_add_u32 s79, s79, s45
    buffer_load_dwordx4 v11, s[24:27], s79 offen sc1 lds
    s_add_u32 m0, m0, s89
    s_add_u32 s79, s79, s45
    buffer_load_dwordx4 v11, s[24:27], s79 offen sc1 lds
    s_add_u32 s42, s42, s43
    s_cmp_eq_u32 s42, s44
    s_cselect_b32 s42, 0, s42
    s_nop 0
    v_cvt_pk_bf16_f32 v144, v224, v225
    v_cvt_pk_bf16_f32 v145, v226, v227
    v_cvt_pk_bf16_f32 v146, v228, v229
    v_cvt_pk_bf16_f32 v147, v230, v231
    v_cvt_pk_bf16_f32 v148, v232, v233
    v_cvt_pk_bf16_f32 v149, v234, v235
    v_cvt_pk_bf16_f32 v150, v236, v237
    v_cvt_pk_bf16_f32 v151, v238, v239
    v_permlane16_swap_b32 v136, v140
    v_permlane16_swap_b32 v137, v141
    v_permlane16_swap_b32 v138, v142
    v_permlane16_swap_b32 v139, v143
    buffer_store_dwordx4 v[136:139], v6, s[20:23], s52 offen offset:0 sc0 sc1
    buffer_store_dwordx4 v[140:143], v6, s[20:23], s52 offen offset:3072 sc0 sc1
    v_cvt_pk_bf16_f32 v152, v240, v241
    v_cvt_pk_bf16_f32 v153, v242, v243
    v_cvt_pk_bf16_f32 v154, v244, v245
    v_cvt_pk_bf16_f32 v155, v246, v247
    v_cvt_pk_bf16_f32 v156, v248, v249
    v_cvt_pk_bf16_f32 v157, v250, v251
    v_cvt_pk_bf16_f32 v158, v252, v253
    v_cvt_pk_bf16_f32 v159, v254, v255
    v_permlane16_swap_b32 v144, v148
    v_permlane16_swap_b32 v145, v149
    v_permlane16_swap_b32 v146, v150
    v_permlane16_swap_b32 v147, v151
    buffer_store_dwordx4 v[144:147], v6, s[20:23], s52 offen offset:64 sc0 sc1
    buffer_store_dwordx4 v[148:151], v6, s[20:23], s52 offen offset:3136 sc0 sc1
    v_permlane16_swap_b32 v152, v156
    v_permlane16_swap_b32 v153, v157
    v_permlane16_swap_b32 v154, v158
    v_permlane16_swap_b32 v155, v159
    buffer_store_dwordx4 v[152:155], v6, s[20:23], s52 offen offset:128 sc0 sc1
    buffer_store_dwordx4 v[156:159], v6, s[20:23], s52 offen offset:3200 sc0 sc1
    s_waitcnt vmcnt(6)
    s_barrier
    s_sub_u32 s41, 82816, s41
    s_sub_u32 s78, 82816, s41
    s_add_u32 m0, s78, s88
    s_add_u32 s79, s42, s46
    buffer_load_dwordx4 v11, s[24:27], s79 offen sc1 lds
    s_add_u32 m0, m0, s89
    s_add_u32 s79, s79, s45
    buffer_load_dwordx4 v11, s[24:27], s79 offen sc1 lds
    s_add_u32 m0, m0, s89
    s_add_u32 s79, s79, s45
    buffer_load_dwordx4 v11, s[24:27], s79 offen sc1 lds
    s_add_u32 s42, s42, s43
    s_cmp_eq_u32 s42, s44
    s_cselect_b32 s42, 0, s42
    s_nop 0
    s_add_u32 s78, s78, 12288
    s_add_u32 m0, s78, s88
    s_add_u32 s79, s42, s46
    buffer_load_dwordx4 v11, s[24:27], s79 offen sc1 lds
    s_add_u32 m0, m0, s89
    s_add_u32 s79, s79, s45
    buffer_load_dwordx4 v11, s[24:27], s79 offen sc1 lds
    s_add_u32 m0, m0, s89
    s_add_u32 s79, s79, s45
    buffer_load_dwordx4 v11, s[24:27], s79 offen sc1 lds
    s_add_u32 s42, s42, s43
    s_cmp_eq_u32 s42, s44
    s_cselect_b32 s42, 0, s42
    s_mov_b32 s59, 4
    s_mov_b32 s56, 1
    s_setvskip -1, 0
    s_cmp_eq_u32 s37, 0
    s_cbranch_scc1 Lbody3P
    s_cmp_eq_u32 s37, 1
    s_cbranch_scc1 Lq13
    s_cmp_eq_u32 s37, 2
    s_cbranch_scc1 Lhalf3
    s_branch Lq33
Ldry_A4:
    s_waitcnt vmcnt(0)
    s_barrier
    s_nop 0
    s_sub_u32 s41, 82816, s41
    s_branch Lfin
.p2align 6
LloopNP:
    s_waitcnt vmcnt(0)
Lnowait2P:
    s_barrier
    s_sub_u32 s41, 82816, s41
Lbody2P:
    v_add_u32 v9, s41, v14
    s_cmp_eq_u32 s48, s67
    s_cselect_b32 s71, 0x30000, s41
    v_add_u32 v10, s71, v14
    s_setprio 3
    v_cvt_pk_f16_f32 v20, v80, v81
    v_cvt_pk_f16_f32 v23, v82, v83
    v_mfma_f32_32x32x16_f16 v[208:223], v[44:47], v[28:31], v[208:223]
    ds_read_b128 v[44:47], v9 offset:9216
    v_pk_fma_f16 v19, v20, v20, s49
    v_pk_fma_f16 v22, v23, v23, s49
    v_pk_mul_f16 v18, v20, v19
    v_pk_mul_f16 v21, v23, v22
    v_exp_f16 v19, v18
    v_exp_f16 v22, v21
    v_exp_f16_sdwa v19, v18 dst_sel:WORD_1 dst_unused:UNUSED_PRESERVE src0_sel:WORD_1
    v_mfma_f32_32x32x16_bf16 v[96:111], v[56:59], v[116:119], 0
    ds_read_b128 v[32:35], v9 offset:6144
    ds_read_b128 v[56:59], v9 offset:0
    v_exp_f16_sdwa v22, v21 dst_sel:WORD_1 dst_unused:UNUSED_PRESERVE src0_sel:WORD_1
    v_pk_fma_f16 v18, v19, s50, s50
    v_pk_fma_f16 v21, v22, s50, s50
    v_rcp_f16 v19, v18
    v_rcp_f16 v22, v21
    v_mfma_f32_32x32x16_f16 v[224:239], v[48:51], v[28:31], v[224:239]
    ds_read_b128 v[36:39], v9 offset:7168
    ds_read_b128 v[48:51], v9 offset:10240
    v_rcp_f16_sdwa v19, v18 dst_sel:WORD_1 dst_unused:UNUSED_PRESERVE src0_sel:WORD_1
    v_rcp_f16_sdwa v22, v21 dst_sel:WORD_1 dst_unused:UNUSED_PRESERVE src0_sel:WORD_1
    v_pk_mul_f16 v24, v20, v19
    v_pk_mul_f16 v25, v23, v22
    v_cvt_pk_f16_f32 v20, v84, v85
    v_cvt_pk_f16_f32 v23, v86, v87
    v_mfma_f32_32x32x16_bf16 v[96:111], v[60:63], v[124:127], v[96:111]
    ds_read_b128 v[40:43], v9 offset:8192
    ds_read_b128 v[60:63], v9 offset:1024
    v_pk_fma_f16 v19, v20, v20, s49
    v_pk_fma_f16 v22, v23, v23, s49
    v_pk_mul_f16 v18, v20, v19
    v_pk_mul_f16 v21, v23, v22
    v_exp_f16 v19, v18
    v_exp_f16 v22, v21
    v_mfma_f32_32x32x16_f16 v[240:255], v[52:55], v[28:31], v[240:255]
    ds_read_b128 v[52:55], v9 offset:11264
    v_exp_f16_sdwa v19, v18 dst_sel:WORD_1 dst_unused:UNUSED_PRESERVE src0_sel:WORD_1
    v_exp_f16_sdwa v22, v21 dst_sel:WORD_1 dst_unused:UNUSED_PRESERVE src0_sel:WORD_1
    v_pk_fma_f16 v18, v19, s50, s50
    v_pk_fma_f16 v21, v22, s50, s50
    v_rcp_f16 v19, v18
    v_rcp_f16 v22, v21
    v_mfma_f32_32x32x16_bf16 v[96:111], v[64:67], v[132:135], v[96:111]
    ds_read_b128 v[64:67], v9 offset:2048
    v_rcp_f16_sdwa v19, v18 dst_sel:WORD_1 dst_unused:UNUSED_PRESERVE src0_sel:WORD_1
    v_rcp_f16_sdwa v22, v21 dst_sel:WORD_1 dst_unused:UNUSED_PRESERVE src0_sel:WORD_1
    v_pk_mul_f16 v26, v20, v19
    v_pk_mul_f16 v27, v23, v22
    v_cvt_pk_f16_f32 v20, v88, v89
    v_mfma_f32_32x32x16_bf16 v[96:111], v[68:71], v[140:143], v[96:111]
    ds_read_b128 v[68:71], v9 offset:3072
    v_cvt_pk_f16_f32 v23, v90, v91
    v_pk_fma_f16 v19, v20, v20, s49
    v_pk_fma_f16 v22, v23, v23, s49
    v_pk_mul_f16 v18, v20, v19
    v_pk_mul_f16 v21, v23, v22
    v_exp_f16_e64 v19, v18
    v_exp_f16 v22, v21
    s_waitcnt lgkmcnt(5)
    v_mfma_f32_32x32x16_f16 v[160:175], v[32:35], v[24:27], v[160:175]
    v_exp_f16_sdwa v19, v18 dst_sel:WORD_1 dst_unused:UNUSED_PRESERVE src0_sel:WORD_1
    v_exp_f16_sdwa v22, v21 dst_sel:WORD_1 dst_unused:UNUSED_PRESERVE src0_sel:WORD_1
    v_pk_fma_f16 v18, v19, s50, s50
    v_pk_fma_f16 v21, v22, s50, s50
    v_rcp_f16_e64 v19, v18
    v_mfma_f32_32x32x16_bf16 v[96:111], v[72:75], v[148:151], v[96:111]
    ds_read_b128 v[72:75], v9 offset:4096
    v_rcp_f16_e64 v22, v21
    v_rcp_f16_sdwa v19, v18 dst_sel:WORD_1 dst_unused:UNUSED_PRESERVE src0_sel:WORD_1
    v_rcp_f16_sdwa v22, v21 dst_sel:WORD_1 dst_unused:UNUSED_PRESERVE src0_sel:WORD_1
    v_pk_mul_f16 v28, v20, v19
    v_pk_mul_f16 v29, v23, v22
    v_cvt_pk_f16_f32 v20, v92, v93
    v_mfma_f32_32x32x16_f16 v[176:191], v[36:39], v[24:27], v[176:191]
    v_cvt_pk_f16_f32 v23, v94, v95
    v_pk_fma_f16 v19, v20, v20, s49
    v_pk_fma_f16 v22, v23, v23, s49
    v_pk_mul_f16 v18, v20, v19
    v_pk_mul_f16 v21, v23, v22
    v_exp_f16 v19, v18
    v_exp_f16 v22, v21
    v_mfma_f32_32x32x16_bf16 v[96:111], v[76:79], v[156:159], v[96:111]
    ds_read_b128 v[76:79], v9 offset:5120
    v_exp_f16_sdwa v19, v18 dst_sel:WORD_1 dst_unused:UNUSED_PRESERVE src0_sel:WORD_1
    v_exp_f16_sdwa v22, v21 dst_sel:WORD_1 dst_unused:UNUSED_PRESERVE src0_sel:WORD_1
    v_pk_fma_f16 v18, v19, s50, s50
    v_pk_fma_f16 v21, v22, s50, s50
    v_rcp_f16 v19, v18
    s_waitcnt lgkmcnt(2)
    v_mfma_f32_32x32x16_f16 v[192:207], v[40:43], v[24:27], v[192:207]
    v_rcp_f16_e64 v22, v21
    v_rcp_f16_sdwa v19, v18 dst_sel:WORD_1 dst_unused:UNUSED_PRESERVE src0_sel:WORD_1
    v_rcp_f16_sdwa v22, v21 dst_sel:WORD_1 dst_unused:UNUSED_PRESERVE src0_sel:WORD_1
    v_pk_mul_f16 v30, v20, v19
    v_pk_mul_f16 v31, v23, v22
    s_cmp_lg_u32 s56, 0
    s_cbranch_scc1 Ldry_ret
Lq12:
    s_setprio 2
    s_nop 0
    v_cvt_pk_f16_f32 v20, v96, v97
    v_cvt_pk_f16_f32 v23, v98, v99
    v_mfma_f32_32x32x16_f16 v[160:175], v[44:47], v[28:31], v[160:175]
    v_pk_fma_f16 v19, v20, v20, s49
    v_pk_fma_f16 v22, v23, v23, s49
    v_pk_mul_f16 v18, v20, v19
    v_pk_mul_f16 v21, v23, v22
    v_exp_f16 v19, v18
    v_exp_f16 v22, v21
    v_exp_f16_sdwa v19, v18 dst_sel:WORD_1 dst_unused:UNUSED_PRESERVE src0_sel:WORD_1
    v_mfma_f32_32x32x16_bf16 v[80:95], v[56:59], v[112:115], 0
    v_exp_f16_sdwa v22, v21 dst_sel:WORD_1 dst_unused:UNUSED_PRESERVE src0_sel:WORD_1
    v_pk_fma_f16 v18, v19, s50, s50
    v_pk_fma_f16 v21, v22, s50, s50
    v_rcp_f16 v19, v18
    v_rcp_f16 v22, v21
    v_mfma_f32_32x32x16_f16 v[176:191], v[48:51], v[28:31], v[176:191]
    v_rcp_f16_sdwa v19, v18 dst_sel:WORD_1 dst_unused:UNUSED_PRESERVE src0_sel:WORD_1
    v_rcp_f16_sdwa v22, v21 dst_sel:WORD_1 dst_unused:UNUSED_PRESERVE src0_sel:WORD_1
    v_pk_mul_f16 v24, v20, v19
    v_pk_mul_f16 v25, v23, v22
    v_cvt_pk_f16_f32 v20, v100, v101
    v_cvt_pk_f16_f32 v23, v102, v103
    v_mfma_f32_32x32x16_bf16 v[80:95], v[60:63], v[120:123], v[80:95]
    v_pk_fma_f16 v19, v20, v20, s49
    v_pk_fma_f16 v22, v23, v23, s49
    v_pk_mul_f16 v18, v20, v19
    v_pk_mul_f16 v21, v23, v22
    v_exp_f16 v19, v18
    v_exp_f16 v22, v21
    v_mfma_f32_32x32x16_f16 v[192:207], v[52:55], v[28:31], v[192:207]
    v_exp_f16_sdwa v19, v18 dst_sel:WORD_1 dst_unused:UNUSED_PRESERVE src0_sel:WORD_1
    v_exp_f16_sdwa v22, v21 dst_sel:WORD_1 dst_unused:UNUSED_PRESERVE src0_sel:WORD_1
    v_pk_fma_f16 v18, v19, s50, s50
    v_pk_fma_f16 v21, v22, s50, s50
    v_rcp_f16 v19, v18
    v_rcp_f16 v22, v21
    v_mfma_f32_32x32x16_bf16 v[80:95], v[64:67], v[128:131], v[80:95]
    v_rcp_f16_sdwa v19, v18 dst_sel:WORD_1 dst_unused:UNUSED_PRESERVE src0_sel:WORD_1
    v_rcp_f16_sdwa v22, v21 dst_sel:WORD_1 dst_unused:UNUSED_PRESERVE src0_sel:WORD_1
    v_pk_mul_f16 v26, v20, v19
    v_pk_mul_f16 v27, v23, v22
    v_cvt_pk_f16_f32 v20, v104, v105
    v_mfma_f32_32x32x16_bf16 v[80:95], v[68:71], v[136:139], v[80:95]
    v_cvt_pk_f16_f32 v23, v106, v107
    v_pk_fma_f16 v19, v20, v20, s49
    v_pk_fma_f16 v22, v23, v23, s49
    v_pk_mul_f16 v18, v20, v19
    v_pk_mul_f16 v21, v23, v22
    v_exp_f16 v19, v18
    v_exp_f16 v22, v21
    v_mfma_f32_32x32x16_f16 v[208:223], v[32:35], v[24:27], v[208:223]
    v_exp_f16_sdwa v19, v18 dst_sel:WORD_1 dst_unused:UNUSED_PRESERVE src0_sel:WORD_1
    v_exp_f16_sdwa v22, v21 dst_sel:WORD_1 dst_unused:UNUSED_PRESERVE src0_sel:WORD_1
    v_pk_fma_f16 v18, v19, s50, s50
    v_pk_fma_f16 v21, v22, s50, s50
    v_rcp_f16 v19, v18
    s_waitcnt lgkmcnt(0)
    v_mfma_f32_32x32x16_bf16 v[80:95], v[72:75], v[144:147], v[80:95]
    v_rcp_f16_e64 v22, v21
    v_rcp_f16_sdwa v19, v18 dst_sel:WORD_1 dst_unused:UNUSED_PRESERVE src0_sel:WORD_1
    v_rcp_f16_sdwa v22, v21 dst_sel:WORD_1 dst_unused:UNUSED_PRESERVE src0_sel:WORD_1
    v_pk_mul_f16 v28, v20, v19
    v_pk_mul_f16 v29, v23, v22
    v_cvt_pk_f16_f32 v20, v108, v109
    v_mfma_f32_32x32x16_f16 v[224:239], v[36:39], v[24:27], v[224:239]
    v_cvt_pk_f16_f32 v23, v110, v111
    v_pk_fma_f16 v19, v20, v20, s49
    v_pk_fma_f16 v22, v23, v23, s49
    v_pk_mul_f16 v18, v20, v19
    v_pk_mul_f16 v21, v23, v22
    v_exp_f16 v19, v18
    v_exp_f16 v22, v21
    v_mfma_f32_32x32x16_bf16 v[80:95], v[76:79], v[152:155], v[80:95]
    v_exp_f16_sdwa v19, v18 dst_sel:WORD_1 dst_unused:UNUSED_PRESERVE src0_sel:WORD_1
    v_exp_f16_sdwa v22, v21 dst_sel:WORD_1 dst_unused:UNUSED_PRESERVE src0_sel:WORD_1
    v_pk_fma_f16 v18, v19, s50, s50
    v_pk_fma_f16 v21, v22, s50, s50
    v_rcp_f16_e64 v19, v18
    v_mfma_f32_32x32x16_f16 v[240:255], v[40:43], v[24:27], v[240:255]
    v_rcp_f16_e64 v22, v21
    v_rcp_f16_sdwa v19, v18 dst_sel:WORD_1 dst_unused:UNUSED_PRESERVE src0_sel:WORD_1
    v_rcp_f16_sdwa v22, v21 dst_sel:WORD_1 dst_unused:UNUSED_PRESERVE src0_sel:WORD_1
    v_pk_mul_f16 v30, v20, v19
    v_pk_mul_f16 v31, v23, v22
    s_cmp_lg_u32 s56, 0
    s_cbranch_scc1 Ldry_ret
Lhalf2:
    s_setprio 1
    s_nop 0
    v_cvt_pk_f16_f32 v20, v80, v81
    v_cvt_pk_f16_f32 v23, v82, v83
    v_mfma_f32_32x32x16_f16 v[208:223], v[44:47], v[28:31], v[208:223]
    ds_read_b128 v[44:47], v9 offset:21504
    v_pk_fma_f16 v19, v20, v20, s49
    v_pk_fma_f16 v22, v23, v23, s49
    v_pk_mul_f16 v18, v20, v19
    v_pk_mul_f16 v21, v23, v22
    v_exp_f16 v19, v18
    v_exp_f16 v22, v21
    v_exp_f16_sdwa v19, v18 dst_sel:WORD_1 dst_unused:UNUSED_PRESERVE src0_sel:WORD_1
    v_mfma_f32_32x32x16_bf16 v[96:111], v[56:59], v[116:119], 0
    ds_read_b128 v[32:35], v9 offset:18432
    ds_read_b128 v[56:59], v10 offset:12288
    v_exp_f16_sdwa v22, v21 dst_sel:WORD_1 dst_unused:UNUSED_PRESERVE src0_sel:WORD_1
    v_pk_fma_f16 v18, v19, s50, s50
    v_pk_fma_f16 v21, v22, s50, s50
    v_rcp_f16 v19, v18
    v_rcp_f16 v22, v21
    v_mfma_f32_32x32x16_f16 v[224:239], v[48:51], v[28:31], v[224:239]
    ds_read_b128 v[36:39], v9 offset:19456
    ds_read_b128 v[48:51], v9 offset:22528
    v_rcp_f16_sdwa v19, v18 dst_sel:WORD_1 dst_unused:UNUSED_PRESERVE src0_sel:WORD_1
    v_rcp_f16_sdwa v22, v21 dst_sel:WORD_1 dst_unused:UNUSED_PRESERVE src0_sel:WORD_1
    v_pk_mul_f16 v24, v20, v19
    v_pk_mul_f16 v25, v23, v22
    v_cvt_pk_f16_f32 v20, v84, v85
    v_cvt_pk_f16_f32 v23, v86, v87
    v_mfma_f32_32x32x16_bf16 v[96:111], v[60:63], v[124:127], v[96:111]
    ds_read_b128 v[40:43], v9 offset:20480
    ds_read_b128 v[60:63], v10 offset:13312
    v_pk_fma_f16 v19, v20, v20, s49
    v_pk_fma_f16 v22, v23, v23, s49
    v_pk_mul_f16 v18, v20, v19
    v_pk_mul_f16 v21, v23, v22
    v_exp_f16 v19, v18
    v_exp_f16 v22, v21
    v_mfma_f32_32x32x16_f16 v[240:255], v[52:55], v[28:31], v[240:255]
    ds_read_b128 v[52:55], v9 offset:23552
    v_exp_f16_sdwa v19, v18 dst_sel:WORD_1 dst_unused:UNUSED_PRESERVE src0_sel:WORD_1
    v_exp_f16_sdwa v22, v21 dst_sel:WORD_1 dst_unused:UNUSED_PRESERVE src0_sel:WORD_1
    v_pk_fma_f16 v18, v19, s50, s50
    v_pk_fma_f16 v21, v22, s50, s50
    v_rcp_f16 v19, v18
    v_rcp_f16 v22, v21
    v_mfma_f32_32x32x16_bf16 v[96:111], v[64:67], v[132:135], v[96:111]
    ds_read_b128 v[64:67], v10 offset:14336
    v_rcp_f16_sdwa v19, v18 dst_sel:WORD_1 dst_unused:UNUSED_PRESERVE src0_sel:WORD_1
    v_rcp_f16_sdwa v22, v21 dst_sel:WORD_1 dst_unused:UNUSED_PRESERVE src0_sel:WORD_1
    v_pk_mul_f16 v26, v20, v19
    v_pk_mul_f16 v27, v23, v22
    v_cvt_pk_f16_f32 v20, v88, v89
    v_mfma_f32_32x32x16_bf16 v[96:111], v[68:71], v[140:143], v[96:111]
    ds_read_b128 v[68:71], v10 offset:15360
    v_cvt_pk_f16_f32 v23, v90, v91
    v_pk_fma_f16 v19, v20, v20, s49
    v_pk_fma_f16 v22, v23, v23, s49
    v_pk_mul_f16 v18, v20, v19
    v_pk_mul_f16 v21, v23, v22
    v_exp_f16_e64 v19, v18
    v_exp_f16 v22, v21
    s_waitcnt lgkmcnt(5)
    v_mfma_f32_32x32x16_f16 v[160:175], v[32:35], v[24:27], v[160:175]
    v_exp_f16_sdwa v19, v18 dst_sel:WORD_1 dst_unused:UNUSED_PRESERVE src0_sel:WORD_1
    v_exp_f16_sdwa v22, v21 dst_sel:WORD_1 dst_unused:UNUSED_PRESERVE src0_sel:WORD_1
    v_pk_fma_f16 v18, v19, s50, s50
    v_pk_fma_f16 v21, v22, s50, s50
    v_rcp_f16_e64 v19, v18
    v_mfma_f32_32x32x16_bf16 v[96:111], v[72:75], v[148:151], v[96:111]
    ds_read_b128 v[72:75], v10 offset:16384
    v_rcp_f16_e64 v22, v21
    v_rcp_f16_sdwa v19, v18 dst_sel:WORD_1 dst_unused:UNUSED_PRESERVE src0_sel:WORD_1
    v_rcp_f16_sdwa v22, v21 dst_sel:WORD_1 dst_unused:UNUSED_PRESERVE src0_sel:WORD_1
    v_pk_mul_f16 v28, v20, v19
    v_pk_mul_f16 v29, v23, v22
    v_cvt_pk_f16_f32 v20, v92, v93
    v_mfma_f32_32x32x16_f16 v[176:191], v[36:39], v[24:27], v[176:191]
    v_cvt_pk_f16_f32 v23, v94, v95
    v_pk_fma_f16 v19, v20, v20, s49
    v_pk_fma_f16 v22, v23, v23, s49
    v_pk_mul_f16 v18, v20, v19
    v_pk_mul_f16 v21, v23, v22
    v_exp_f16 v19, v18
    v_exp_f16 v22, v21
    v_mfma_f32_32x32x16_bf16 v[96:111], v[76:79], v[156:159], v[96:111]
    ds_read_b128 v[76:79], v10 offset:17408
    v_exp_f16_sdwa v19, v18 dst_sel:WORD_1 dst_unused:UNUSED_PRESERVE src0_sel:WORD_1
    v_exp_f16_sdwa v22, v21 dst_sel:WORD_1 dst_unused:UNUSED_PRESERVE src0_sel:WORD_1
    v_pk_fma_f16 v18, v19, s50, s50
    v_pk_fma_f16 v21, v22, s50, s50
    v_rcp_f16 v19, v18
    s_waitcnt lgkmcnt(2)
    v_mfma_f32_32x32x16_f16 v[192:207], v[40:43], v[24:27], v[192:207]
    v_rcp_f16_e64 v22, v21
    v_rcp_f16_sdwa v19, v18 dst_sel:WORD_1 dst_unused:UNUSED_PRESERVE src0_sel:WORD_1
    v_rcp_f16_sdwa v22, v21 dst_sel:WORD_1 dst_unused:UNUSED_PRESERVE src0_sel:WORD_1
    v_pk_mul_f16 v30, v20, v19
    v_pk_mul_f16 v31, v23, v22
    s_cmp_lg_u32 s56, 0
    s_cbranch_scc1 Ldry_ret
Lq32:
    s_setprio 0
    s_nop 0
    v_cvt_pk_f16_f32 v20, v96, v97
    v_cvt_pk_f16_f32 v23, v98, v99
    v_mfma_f32_32x32x16_f16 v[160:175], v[44:47], v[28:31], v[160:175]
    v_pk_fma_f16 v19, v20, v20, s49
    v_pk_fma_f16 v22, v23, v23, s49
    v_pk_mul_f16 v18, v20, v19
    v_pk_mul_f16 v21, v23, v22
    v_exp_f16 v19, v18
    v_exp_f16 v22, v21
    v_exp_f16_sdwa v19, v18 dst_sel:WORD_1 dst_unused:UNUSED_PRESERVE src0_sel:WORD_1
    v_mfma_f32_32x32x16_bf16 v[80:95], v[56:59], v[112:115], 0
    v_exp_f16_sdwa v22, v21 dst_sel:WORD_1 dst_unused:UNUSED_PRESERVE src0_sel:WORD_1
    v_pk_fma_f16 v18, v19, s50, s50
    v_pk_fma_f16 v21, v22, s50, s50
    v_rcp_f16 v19, v18
    v_rcp_f16 v22, v21
    v_mfma_f32_32x32x16_f16 v[176:191], v[48:51], v[28:31], v[176:191]
    v_rcp_f16_sdwa v19, v18 dst_sel:WORD_1 dst_unused:UNUSED_PRESERVE src0_sel:WORD_1
    v_rcp_f16_sdwa v22, v21 dst_sel:WORD_1 dst_unused:UNUSED_PRESERVE src0_sel:WORD_1
    v_pk_mul_f16 v24, v20, v19
    v_pk_mul_f16 v25, v23, v22
    v_cvt_pk_f16_f32 v20, v100, v101
    v_cvt_pk_f16_f32 v23, v102, v103
    v_mfma_f32_32x32x16_bf16 v[80:95], v[60:63], v[120:123], v[80:95]
    v_pk_fma_f16 v19, v20, v20, s49
    v_pk_fma_f16 v22, v23, v23, s49
    v_pk_mul_f16 v18, v20, v19
    v_pk_mul_f16 v21, v23, v22
    v_exp_f16 v19, v18
    v_exp_f16 v22, v21
    v_mfma_f32_32x32x16_f16 v[192:207], v[52:55], v[28:31], v[192:207]
    v_exp_f16_sdwa v19, v18 dst_sel:WORD_1 dst_unused:UNUSED_PRESERVE src0_sel:WORD_1
    v_exp_f16_sdwa v22, v21 dst_sel:WORD_1 dst_unused:UNUSED_PRESERVE src0_sel:WORD_1
    v_pk_fma_f16 v18, v19, s50, s50
    v_pk_fma_f16 v21, v22, s50, s50
    v_rcp_f16 v19, v18
    v_rcp_f16 v22, v21
    v_mfma_f32_32x32x16_bf16 v[80:95], v[64:67], v[128:131], v[80:95]
    v_rcp_f16_sdwa v19, v18 dst_sel:WORD_1 dst_unused:UNUSED_PRESERVE src0_sel:WORD_1
    v_rcp_f16_sdwa v22, v21 dst_sel:WORD_1 dst_unused:UNUSED_PRESERVE src0_sel:WORD_1
    v_pk_mul_f16 v26, v20, v19
    v_pk_mul_f16 v27, v23, v22
    v_cvt_pk_f16_f32 v20, v104, v105
    v_mfma_f32_32x32x16_bf16 v[80:95], v[68:71], v[136:139], v[80:95]
    v_cvt_pk_f16_f32 v23, v106, v107
    v_pk_fma_f16 v19, v20, v20, s49
    v_pk_fma_f16 v22, v23, v23, s49
    v_pk_mul_f16 v18, v20, v19
    v_pk_mul_f16 v21, v23, v22
    v_exp_f16 v19, v18
    v_exp_f16 v22, v21
    v_mfma_f32_32x32x16_f16 v[208:223], v[32:35], v[24:27], v[208:223]
    v_exp_f16_sdwa v19, v18 dst_sel:WORD_1 dst_unused:UNUSED_PRESERVE src0_sel:WORD_1
    v_exp_f16_sdwa v22, v21 dst_sel:WORD_1 dst_unused:UNUSED_PRESERVE src0_sel:WORD_1
    v_pk_fma_f16 v18, v19, s50, s50
    v_pk_fma_f16 v21, v22, s50, s50
    v_rcp_f16 v19, v18
    s_waitcnt lgkmcnt(0)
    v_mfma_f32_32x32x16_bf16 v[80:95], v[72:75], v[144:147], v[80:95]
    v_rcp_f16_e64 v22, v21
    v_rcp_f16_sdwa v19, v18 dst_sel:WORD_1 dst_unused:UNUSED_PRESERVE src0_sel:WORD_1
    v_rcp_f16_sdwa v22, v21 dst_sel:WORD_1 dst_unused:UNUSED_PRESERVE src0_sel:WORD_1
    v_pk_mul_f16 v28, v20, v19
    v_pk_mul_f16 v29, v23, v22
    v_cvt_pk_f16_f32 v20, v108, v109
    v_mfma_f32_32x32x16_f16 v[224:239], v[36:39], v[24:27], v[224:239]
    v_cvt_pk_f16_f32 v23, v110, v111
    v_pk_fma_f16 v19, v20, v20, s49
    v_pk_fma_f16 v22, v23, v23, s49
    v_pk_mul_f16 v18, v20, v19
    v_pk_mul_f16 v21, v23, v22
    v_exp_f16 v19, v18
    v_exp_f16 v22, v21
    v_mfma_f32_32x32x16_bf16 v[80:95], v[76:79], v[152:155], v[80:95]
    v_exp_f16_sdwa v19, v18 dst_sel:WORD_1 dst_unused:UNUSED_PRESERVE src0_sel:WORD_1
    v_exp_f16_sdwa v22, v21 dst_sel:WORD_1 dst_unused:UNUSED_PRESERVE src0_sel:WORD_1
    v_pk_fma_f16 v18, v19, s50, s50
    v_pk_fma_f16 v21, v22, s50, s50
    v_rcp_f16_e64 v19, v18
    v_mfma_f32_32x32x16_f16 v[240:255], v[40:43], v[24:27], v[240:255]
    v_rcp_f16_e64 v22, v21
    v_rcp_f16_sdwa v19, v18 dst_sel:WORD_1 dst_unused:UNUSED_PRESERVE src0_sel:WORD_1
    v_rcp_f16_sdwa v22, v21 dst_sel:WORD_1 dst_unused:UNUSED_PRESERVE src0_sel:WORD_1
    v_pk_mul_f16 v30, v20, v19
    v_pk_mul_f16 v31, v23, v22
    s_sub_u32 s48, s48, 1
    s_cmp_lg_u32 s48, 0
    s_cbranch_scc1 LloopNP
    s_cmp_lg_u32 s56, 0
    s_cbranch_scc1 Ldry_ret
    s_cmp_lg_u32 s65, 0
    s_mov_b32 s65, 0
    s_mov_b32 s48, 2
    s_cbranch_scc1 LloopAP
    s_add_u32 s63, s63, 4
    s_cmp_ge_u32 s63, 12
    s_cselect_b32 s63, 0, s63
    s_add_u32 s47, s47, 1
    s_cmp_eq_u32 s47, 1
    s_cbranch_scc1 LouterP
    s_waitcnt vmcnt(0)
    s_barrier
    s_nop 0
    s_sub_u32 s41, 82816, s41
Lbody3P:
    v_add_u32_e64 v9, s41, v14
    s_sub_u32 s71, 82816, s41
    v_add_u32_e64 v15, s71, v14
    ds_read_b128 v[56:59], v9 offset:0
    ds_read_b128 v[60:63], v9 offset:1024
    ds_read_b128 v[64:67], v9 offset:2048
    v_cvt_pk_f16_f32 v20, v80, v81
    v_cvt_pk_f16_f32 v23, v82, v83
    v_mfma_f32_32x32x16_f16 v[208:223], v[44:47], v[28:31], v[208:223]
    ds_read_b128 v[44:47], v9 offset:9216
    ds_read_b128 v[68:71], v9 offset:3072
    v_pk_fma_f16 v19, v20, v20, s49
    v_pk_fma_f16 v22, v23, v23, s49
    v_pk_mul_f16 v18, v20, v19
    v_pk_mul_f16 v21, v23, v22
    v_exp_f16 v19, v18
    v_exp_f16 v22, v21
    v_exp_f16_sdwa v19, v18 dst_sel:WORD_1 dst_unused:UNUSED_PRESERVE src0_sel:WORD_1
    v_mfma_f32_32x32x16_f16 v[224:239], v[48:51], v[28:31], v[224:239]
    ds_read_b128 v[48:51], v9 offset:10240
    ds_read_b128 v[72:75], v9 offset:4096
    ds_read_b128 v[32:35], v9 offset:6144
    v_exp_f16_sdwa v22, v21 dst_sel:WORD_1 dst_unused:UNUSED_PRESERVE src0_sel:WORD_1
    v_pk_fma_f16 v18, v19, s50, s50
    v_pk_fma_f16 v21, v22, s50, s50
    v_rcp_f16 v19, v18
    v_rcp_f16 v22, v21
    v_mfma_f32_32x32x16_f16 v[240:255], v[52:55], v[28:31], v[240:255]
    ds_read_b128 v[52:55], v9 offset:11264
    ds_read_b128 v[76:79], v9 offset:5120
    ds_read_b128 v[36:39], v9 offset:7168
    v_rcp_f16_sdwa v19, v18 dst_sel:WORD_1 dst_unused:UNUSED_PRESERVE src0_sel:WORD_1
    v_rcp_f16_sdwa v22, v21 dst_sel:WORD_1 dst_unused:UNUSED_PRESERVE src0_sel:WORD_1
    v_pk_mul_f16 v24, v20, v19
    v_pk_mul_f16 v25, v23, v22
    v_cvt_pk_f16_f32 v20, v84, v85
    v_cvt_pk_f16_f32 v23, v86, v87
    s_waitcnt lgkmcnt(10)
    s_nop 0
    v_mfma_f32_32x32x16_bf16 v[96:111], v[56:59], v[112:115], 0
    ds_read_b128 v[56:59], v15 offset:12288
    ds_read_b128 v[40:43], v9 offset:8192
    v_pk_fma_f16 v19, v20, v20, s49
    v_pk_fma_f16 v22, v23, v23, s49
    v_pk_mul_f16 v18, v20, v19
    v_pk_mul_f16 v21, v23, v22
    v_exp_f16_e64 v19, v18
    v_exp_f16 v22, v21
    s_waitcnt lgkmcnt(10)
    v_mfma_f32_32x32x16_bf16 v[96:111], v[60:63], v[120:123], v[96:111]
    ds_read_b128 v[60:63], v15 offset:13312
    v_exp_f16_sdwa v19, v18 dst_sel:WORD_1 dst_unused:UNUSED_PRESERVE src0_sel:WORD_1
    v_exp_f16_sdwa v22, v21 dst_sel:WORD_1 dst_unused:UNUSED_PRESERVE src0_sel:WORD_1
    v_pk_fma_f16 v18, v19, s50, s50
    v_pk_fma_f16 v21, v22, s50, s50
    v_rcp_f16 v19, v18
    v_rcp_f16 v22, v21
    v_mfma_f32_32x32x16_bf16 v[96:111], v[64:67], v[128:131], v[96:111]
    ds_read_b128 v[64:67], v15 offset:14336
    v_rcp_f16_sdwa v19, v18 dst_sel:WORD_1 dst_unused:UNUSED_PRESERVE src0_sel:WORD_1
    v_rcp_f16_sdwa v22, v21 dst_sel:WORD_1 dst_unused:UNUSED_PRESERVE src0_sel:WORD_1
    v_pk_mul_f16 v26, v20, v19
    v_pk_mul_f16 v27, v23, v22
    v_cvt_pk_f16_f32 v20, v88, v89
    s_waitcnt lgkmcnt(7)
    s_nop 0
    v_mfma_f32_32x32x16_bf16 v[96:111], v[68:71], v[136:139], v[96:111]
    ds_read_b128 v[68:71], v15 offset:15360
    v_cvt_pk_f16_f32 v23, v90, v91
    v_pk_fma_f16 v19, v20, v20, s49
    v_pk_fma_f16 v22, v23, v23, s49
    v_pk_mul_f16 v18, v20, v19
    v_pk_mul_f16 v21, v23, v22
    v_exp_f16 v19, v18
    v_exp_f16 v22, v21
    v_mfma_f32_32x32x16_f16 v[160:175], v[32:35], v[24:27], v[160:175]
    ds_read_b128 v[32:35], v9 offset:18432
    v_exp_f16_sdwa v19, v18 dst_sel:WORD_1 dst_unused:UNUSED_PRESERVE src0_sel:WORD_1
    v_exp_f16_sdwa v22, v21 dst_sel:WORD_1 dst_unused:UNUSED_PRESERVE src0_sel:WORD_1
    v_pk_fma_f16 v18, v19, s50, s50
    v_pk_fma_f16 v21, v22, s50, s50
    v_rcp_f16_e64 v19, v18
    v_mfma_f32_32x32x16_bf16 v[96:111], v[72:75], v[144:147], v[96:111]
    ds_read_b128 v[72:75], v15 offset:16384
    v_rcp_f16_e64 v22, v21
    v_rcp_f16_sdwa v19, v18 dst_sel:WORD_1 dst_unused:UNUSED_PRESERVE src0_sel:WORD_1
    v_rcp_f16_sdwa v22, v21 dst_sel:WORD_1 dst_unused:UNUSED_PRESERVE src0_sel:WORD_1
    v_pk_mul_f16 v28, v20, v19
    v_pk_mul_f16 v29, v23, v22
    v_cvt_pk_f16_f32 v20, v92, v93
    s_waitcnt lgkmcnt(4)
    s_nop 0
    v_mfma_f32_32x32x16_f16 v[176:191], v[36:39], v[24:27], v[176:191]
    ds_read_b128 v[36:39], v9 offset:19456
    v_cvt_pk_f16_f32 v23, v94, v95
    v_pk_fma_f16 v19, v20, v20, s49
    v_pk_fma_f16 v22, v23, v23, s49
    v_pk_mul_f16 v18, v20, v19
    v_pk_mul_f16 v21, v23, v22
    v_exp_f16 v19, v18
    v_exp_f16 v22, v21
    v_mfma_f32_32x32x16_bf16 v[96:111], v[76:79], v[152:155], v[96:111]
    ds_read_b128 v[76:79], v15 offset:17408
    v_exp_f16_sdwa v19, v18 dst_sel:WORD_1 dst_unused:UNUSED_PRESERVE src0_sel:WORD_1
    v_exp_f16_sdwa v22, v21 dst_sel:WORD_1 dst_unused:UNUSED_PRESERVE src0_sel:WORD_1
    v_pk_fma_f16 v18, v19, s50, s50
    v_pk_fma_f16 v21, v22, s50, s50
    v_rcp_f16_e64 v19, v18
    v_mfma_f32_32x32x16_f16 v[192:207], v[40:43], v[24:27], v[192:207]
    ds_read_b128 v[40:43], v9 offset:20480
    v_rcp_f16_e64 v22, v21
    v_rcp_f16_sdwa v19, v18 dst_sel:WORD_1 dst_unused:UNUSED_PRESERVE src0_sel:WORD_1
    v_rcp_f16_sdwa v22, v21 dst_sel:WORD_1 dst_unused:UNUSED_PRESERVE src0_sel:WORD_1
    v_pk_mul_f16 v30, v20, v19
    v_pk_mul_f16 v31, v23, v22
    s_cmp_lg_u32 s56, 0
    s_cbranch_scc1 Ldry_ret
Lq13:
    v_cvt_pk_f16_f32 v20, v96, v97
    v_cvt_pk_f16_f32 v23, v98, v99
    v_mfma_f32_32x32x16_f16 v[160:175], v[44:47], v[28:31], v[160:175]
    ds_read_b128 v[44:47], v9 offset:21504
    v_pk_fma_f16 v19, v20, v20, s49
    v_pk_fma_f16 v22, v23, v23, s49
    v_pk_mul_f16 v18, v20, v19
    v_pk_mul_f16 v21, v23, v22
    v_exp_f16 v19, v18
    v_exp_f16 v22, v21
    v_exp_f16_sdwa v19, v18 dst_sel:WORD_1 dst_unused:UNUSED_PRESERVE src0_sel:WORD_1
    v_mfma_f32_32x32x16_bf16 v[80:95], v[56:59], v[116:119], 0
    ds_read_b128 v[56:59], v9 offset:0
    v_exp_f16_sdwa v22, v21 dst_sel:WORD_1 dst_unused:UNUSED_PRESERVE src0_sel:WORD_1
    v_pk_fma_f16 v18, v19, s50, s50
    v_pk_fma_f16 v21, v22, s50, s50
    v_rcp_f16 v19, v18
    v_rcp_f16 v22, v21
    v_mfma_f32_32x32x16_f16 v[176:191], v[48:51], v[28:31], v[176:191]
    ds_read_b128 v[48:51], v9 offset:22528
    v_rcp_f16_sdwa v19, v18 dst_sel:WORD_1 dst_unused:UNUSED_PRESERVE src0_sel:WORD_1
    v_rcp_f16_sdwa v22, v21 dst_sel:WORD_1 dst_unused:UNUSED_PRESERVE src0_sel:WORD_1
    v_pk_mul_f16 v24, v20, v19
    v_pk_mul_f16 v25, v23, v22
    v_cvt_pk_f16_f32 v20, v100, v101
    v_cvt_pk_f16_f32 v23, v102, v103
    v_mfma_f32_32x32x16_bf16 v[80:95], v[60:63], v[124:127], v[80:95]
    ds_read_b128 v[60:63], v9 offset:1024
    v_pk_fma_f16 v19, v20, v20, s49
    v_pk_fma_f16 v22, v23, v23, s49
    v_pk_mul_f16 v18, v20, v19
    v_pk_mul_f16 v21, v23, v22
    v_exp_f16 v19, v18
    v_exp_f16 v22, v21
    v_mfma_f32_32x32x16_f16 v[192:207], v[52:55], v[28:31], v[192:207]
    ds_read_b128 v[52:55], v9 offset:23552
    v_exp_f16_sdwa v19, v18 dst_sel:WORD_1 dst_unused:UNUSED_PRESERVE src0_sel:WORD_1
    v_exp_f16_sdwa v22, v21 dst_sel:WORD_1 dst_unused:UNUSED_PRESERVE src0_sel:WORD_1
    v_pk_fma_f16 v18, v19, s50, s50
    v_pk_fma_f16 v21, v22, s50, s50
    v_rcp_f16_e64 v19, v18
    v_rcp_f16 v22, v21
    s_waitcnt lgkmcnt(4)
    v_mfma_f32_32x32x16_bf16 v[80:95], v[64:67], v[132:135], v[80:95]
    ds_read_b128 v[64:67], v9 offset:2048
    v_rcp_f16_sdwa v19, v18 dst_sel:WORD_1 dst_unused:UNUSED_PRESERVE src0_sel:WORD_1
    v_rcp_f16_sdwa v22, v21 dst_sel:WORD_1 dst_unused:UNUSED_PRESERVE src0_sel:WORD_1
    v_pk_mul_f16 v26, v20, v19
    v_pk_mul_f16 v27, v23, v22
    v_cvt_pk_f16_f32 v20, v104, v105
    v_mfma_f32_32x32x16_bf16 v[80:95], v[68:71], v[140:143], v[80:95]
    ds_read_b128 v[68:71], v9 offset:3072
    v_cvt_pk_f16_f32 v23, v106, v107
    v_pk_fma_f16 v19, v20, v20, s49
    v_pk_fma_f16 v22, v23, v23, s49
    v_pk_mul_f16 v18, v20, v19
    v_pk_mul_f16 v21, v23, v22
    v_exp_f16 v19, v18
    v_exp_f16 v22, v21
    v_mfma_f32_32x32x16_f16 v[160:175], v[32:35], v[24:27], v[160:175]
    ds_read_b128 v[32:35], v9 offset:6144
    v_exp_f16_sdwa v19, v18 dst_sel:WORD_1 dst_unused:UNUSED_PRESERVE src0_sel:WORD_1
    v_exp_f16_sdwa v22, v21 dst_sel:WORD_1 dst_unused:UNUSED_PRESERVE src0_sel:WORD_1
    v_pk_fma_f16 v18, v19, s50, s50
    v_pk_fma_f16 v21, v22, s50, s50
    v_rcp_f16_e64 v19, v18
    v_mfma_f32_32x32x16_bf16 v[80:95], v[72:75], v[148:151], v[80:95]
    ds_read_b128 v[72:75], v9 offset:4096
    v_rcp_f16_e64 v22, v21
    v_rcp_f16_sdwa v19, v18 dst_sel:WORD_1 dst_unused:UNUSED_PRESERVE src0_sel:WORD_1
    v_rcp_f16_sdwa v22, v21 dst_sel:WORD_1 dst_unused:UNUSED_PRESERVE src0_sel:WORD_1
    v_pk_mul_f16 v28, v20, v19
    v_pk_mul_f16 v29, v23, v22
    v_cvt_pk_f16_f32 v20, v108, v109
    v_mfma_f32_32x32x16_f16 v[176:191], v[36:39], v[24:27], v[176:191]
    ds_read_b128 v[36:39], v9 offset:7168
    v_cvt_pk_f16_f32 v23, v110, v111
    v_pk_fma_f16 v19, v20, v20, s49
    v_pk_fma_f16 v22, v23, v23, s49
    v_pk_mul_f16 v18, v20, v19
    v_pk_mul_f16 v21, v23, v22
    v_exp_f16 v19, v18
    v_exp_f16 v22, v21
    v_mfma_f32_32x32x16_bf16 v[80:95], v[76:79], v[156:159], v[80:95]
    ds_read_b128 v[76:79], v9 offset:5120
    v_exp_f16_sdwa v19, v18 dst_sel:WORD_1 dst_unused:UNUSED_PRESERVE src0_sel:WORD_1
    v_exp_f16_sdwa v22, v21 dst_sel:WORD_1 dst_unused:UNUSED_PRESERVE src0_sel:WORD_1
    v_pk_fma_f16 v18, v19, s50, s50
    v_pk_fma_f16 v21, v22, s50, s50
    v_rcp_f16_e64 v19, v18
    v_mfma_f32_32x32x16_f16 v[192:207], v[40:43], v[24:27], v[192:207]
    ds_read_b128 v[40:43], v9 offset:8192
    v_rcp_f16_e64 v22, v21
    v_rcp_f16_sdwa v19, v18 dst_sel:WORD_1 dst_unused:UNUSED_PRESERVE src0_sel:WORD_1
    v_rcp_f16_sdwa v22, v21 dst_sel:WORD_1 dst_unused:UNUSED_PRESERVE src0_sel:WORD_1
    v_pk_mul_f16 v30, v20, v19
    v_pk_mul_f16 v31, v23, v22
    s_cmp_lg_u32 s56, 0
    s_cbranch_scc1 Ldry_ret
Lhalf3:
    v_cvt_pk_f16_f32 v20, v80, v81
    v_cvt_pk_f16_f32 v23, v82, v83
    v_mfma_f32_32x32x16_f16 v[160:175], v[44:47], v[28:31], v[160:175]
    ds_read_b128 v[44:47], v9 offset:9216
    v_pk_fma_f16 v19, v20, v20, s49
    v_pk_fma_f16 v22, v23, v23, s49
    v_pk_mul_f16 v18, v20, v19
    v_pk_mul_f16 v21, v23, v22
    v_exp_f16 v19, v18
    v_exp_f16 v22, v21
    v_exp_f16_sdwa v19, v18 dst_sel:WORD_1 dst_unused:UNUSED_PRESERVE src0_sel:WORD_1
    v_exp_f16_sdwa v22, v21 dst_sel:WORD_1 dst_unused:UNUSED_PRESERVE src0_sel:WORD_1
    v_pk_fma_f16 v18, v19, s50, s50
    v_pk_fma_f16 v21, v22, s50, s50
    s_waitcnt lgkmcnt(3)
    s_nop 0
    v_mfma_f32_32x32x16_f16 v[176:191], v[48:51], v[28:31], v[176:191]
    ds_read_b128 v[48:51], v9 offset:10240
    v_rcp_f16 v19, v18
    v_rcp_f16 v22, v21
    v_rcp_f16_sdwa v19, v18 dst_sel:WORD_1 dst_unused:UNUSED_PRESERVE src0_sel:WORD_1
    v_rcp_f16_sdwa v22, v21 dst_sel:WORD_1 dst_unused:UNUSED_PRESERVE src0_sel:WORD_1
    v_pk_mul_f16 v24, v20, v19
    v_pk_mul_f16 v25, v23, v22
    v_cvt_pk_f16_f32 v20, v84, v85
    v_cvt_pk_f16_f32 v23, v86, v87
    v_pk_fma_f16 v19, v20, v20, s49
    v_mfma_f32_32x32x16_f16 v[192:207], v[52:55], v[28:31], v[192:207]
    ds_read_b128 v[52:55], v9 offset:11264
    v_pk_fma_f16 v22, v23, v23, s49
    v_pk_mul_f16 v18, v20, v19
    v_pk_mul_f16 v21, v23, v22
    v_exp_f16_e64 v19, v18
    v_cvt_pk_bf16_f32 v112, v160, v161
    v_exp_f16_e64 v22, v21
    v_cvt_pk_bf16_f32 v113, v162, v163
    v_cvt_pk_bf16_f32 v114, v164, v165
    v_exp_f16_sdwa v19, v18 dst_sel:WORD_1 dst_unused:UNUSED_PRESERVE src0_sel:WORD_1
    v_cvt_pk_bf16_f32 v115, v166, v167
    v_mfma_f32_32x32x16_bf16 v[96:111], v[56:59], v[116:119], 0
    v_exp_f16_sdwa v22, v21 dst_sel:WORD_1 dst_unused:UNUSED_PRESERVE src0_sel:WORD_1
    v_cvt_pk_bf16_f32 v120, v168, v169
    v_pk_fma_f16 v18, v19, s50, s50
    v_cvt_pk_bf16_f32 v121, v170, v171
    v_pk_fma_f16 v21, v22, s50, s50
    v_rcp_f16_e64 v19, v18
    v_cvt_pk_bf16_f32 v122, v172, v173
    v_cvt_pk_bf16_f32 v123, v174, v175
    v_rcp_f16_e64 v22, v21
    v_cvt_pk_bf16_f32 v128, v176, v177
    v_mfma_f32_32x32x16_bf16 v[96:111], v[60:63], v[124:127], v[96:111]
    v_rcp_f16_sdwa v19, v18 dst_sel:WORD_1 dst_unused:UNUSED_PRESERVE src0_sel:WORD_1
    v_cvt_pk_bf16_f32 v129, v178, v179
    v_rcp_f16_sdwa v22, v21 dst_sel:WORD_1 dst_unused:UNUSED_PRESERVE src0_sel:WORD_1
    v_permlane16_swap_b32 v112, v120
    s_nop 0
    v_pk_mul_f16 v26, v20, v19
    v_permlane16_swap_b32 v113, v121
    s_nop 0
    v_pk_mul_f16 v27, v23, v22
    v_cvt_pk_f16_f32 v20, v88, v89
    v_permlane16_swap_b32 v114, v122
    s_nop 0
    v_mfma_f32_32x32x16_bf16 v[96:111], v[64:67], v[132:135], v[96:111]
    v_cvt_pk_f16_f32 v23, v90, v91
    v_permlane16_swap_b32 v115, v123
    s_nop 0
    v_pk_fma_f16 v19, v20, v20, s49
    v_pk_fma_f16 v22, v23, v23, s49
    buffer_store_dwordx4 v[112:115], v6, s[20:23], s51 offen offset:0 sc0 sc1
    v_pk_mul_f16 v18, v20, v19
    buffer_store_dwordx4 v[120:123], v6, s[20:23], s51 offen offset:3072 sc0 sc1
    v_pk_mul_f16 v21, v23, v22
    v_exp_f16_e64 v19, v18
    v_cvt_pk_bf16_f32 v130, v180, v181
    v_mfma_f32_32x32x16_bf16 v[96:111], v[68:71], v[140:143], v[96:111]
    v_exp_f16_e64 v22, v21
    v_cvt_pk_bf16_f32 v131, v182, v183
    v_cvt_pk_bf16_f32 v136, v184, v185
    v_exp_f16_sdwa v19, v18 dst_sel:WORD_1 dst_unused:UNUSED_PRESERVE src0_sel:WORD_1
    v_cvt_pk_bf16_f32 v137, v186, v187
    v_exp_f16_sdwa v22, v21 dst_sel:WORD_1 dst_unused:UNUSED_PRESERVE src0_sel:WORD_1
    v_cvt_pk_bf16_f32 v138, v188, v189
    v_pk_fma_f16 v18, v19, s50, s50
    v_cvt_pk_bf16_f32 v139, v190, v191
    v_pk_fma_f16 v21, v22, s50, s50
    v_rcp_f16_e64 v19, v18
    v_mfma_f32_32x32x16_f16 v[208:223], v[32:35], v[24:27], v[208:223]
    ds_read_b128 v[32:35], v9 offset:18432
    v_cvt_pk_bf16_f32 v144, v192, v193
    v_cvt_pk_bf16_f32 v145, v194, v195
    v_rcp_f16 v22, v21
    v_permlane16_swap_b32 v128, v136
    v_rcp_f16_sdwa v19, v18 dst_sel:WORD_1 dst_unused:UNUSED_PRESERVE src0_sel:WORD_1
    v_permlane16_swap_b32 v129, v137
    s_nop 0
    v_rcp_f16_sdwa v22, v21 dst_sel:WORD_1 dst_unused:UNUSED_PRESERVE src0_sel:WORD_1
    v_mfma_f32_32x32x16_bf16 v[96:111], v[72:75], v[148:151], v[96:111]
    v_permlane16_swap_b32 v130, v138
    s_nop 0
    v_pk_mul_f16 v28, v20, v19
    v_permlane16_swap_b32 v131, v139
    s_nop 0
    v_pk_mul_f16 v29, v23, v22
    v_cvt_pk_f16_f32 v20, v92, v93
    buffer_store_dwordx4 v[128:131], v6, s[20:23], s51 offen offset:64 sc0 sc1
    v_cvt_pk_f16_f32 v23, v94, v95
    buffer_store_dwordx4 v[136:139], v6, s[20:23], s51 offen offset:3136 sc0 sc1
    v_pk_fma_f16 v19, v20, v20, s49
    v_pk_fma_f16 v22, v23, v23, s49
    v_cvt_pk_bf16_f32 v146, v196, v197
    v_mfma_f32_32x32x16_f16 v[224:239], v[36:39], v[24:27], v[224:239]
    ds_read_b128 v[36:39], v9 offset:19456
    v_pk_mul_f16 v18, v20, v19
    v_cvt_pk_bf16_f32 v147, v198, v199
    v_pk_mul_f16 v21, v23, v22
    v_exp_f16_e64 v19, v18
    v_cvt_pk_bf16_f32 v152, v200, v201
    v_exp_f16_e64 v22, v21
    v_cvt_pk_bf16_f32 v153, v202, v203
    v_cvt_pk_bf16_f32 v154, v204, v205
    v_exp_f16_sdwa v19, v18 dst_sel:WORD_1 dst_unused:UNUSED_PRESERVE src0_sel:WORD_1
    v_cvt_pk_bf16_f32 v155, v206, v207
    s_waitcnt lgkmcnt(2)
    s_nop 0
    v_mfma_f32_32x32x16_bf16 v[96:111], v[76:79], v[156:159], v[96:111]
    v_exp_f16_sdwa v22, v21 dst_sel:WORD_1 dst_unused:UNUSED_PRESERVE src0_sel:WORD_1
    v_mov_b32_e64 v15, 0
    v_pk_fma_f16 v18, v19, s50, s50
    v_mov_b32_e64 v15, 0
    v_pk_fma_f16 v21, v22, s50, s50
    v_rcp_f16 v19, v18
    v_permlane16_swap_b32 v144, v152
    v_permlane16_swap_b32 v145, v153
    v_rcp_f16 v22, v21
    v_mfma_f32_32x32x16_f16 v[240:255], v[40:43], v[24:27], v[240:255]
    ds_read_b128 v[40:43], v9 offset:20480
    v_permlane16_swap_b32 v146, v154
    s_nop 0
    v_rcp_f16_sdwa v19, v18 dst_sel:WORD_1 dst_unused:UNUSED_PRESERVE src0_sel:WORD_1
    v_permlane16_swap_b32 v147, v155
    s_nop 0
    v_rcp_f16_sdwa v22, v21 dst_sel:WORD_1 dst_unused:UNUSED_PRESERVE src0_sel:WORD_1
    buffer_store_dwordx4 v[144:147], v6, s[20:23], s51 offen offset:128 sc0 sc1
    v_pk_mul_f16 v30, v20, v19
    buffer_store_dwordx4 v[152:155], v6, s[20:23], s51 offen offset:3200 sc0 sc1
    v_pk_mul_f16 v31, v23, v22
    s_cmp_lg_u32 s56, 0
    s_cbranch_scc1 Ldry_ret
Lq33:
    v_cvt_pk_f16_f32 v20, v96, v97
    v_cvt_pk_f16_f32 v23, v98, v99
    v_mfma_f32_32x32x16_f16 v[208:223], v[44:47], v[28:31], v[208:223]
    ds_read_b128 v[44:47], v9 offset:21504
    v_pk_fma_f16 v19, v20, v20, s49
    v_pk_fma_f16 v22, v23, v23, s49
    v_pk_mul_f16 v18, v20, v19
    v_pk_mul_f16 v21, v23, v22
    v_exp_f16 v19, v18
    v_exp_f16 v22, v21
    v_exp_f16_sdwa v19, v18 dst_sel:WORD_1 dst_unused:UNUSED_PRESERVE src0_sel:WORD_1
    v_mfma_f32_32x32x16_f16 v[224:239], v[48:51], v[28:31], v[224:239]
    ds_read_b128 v[48:51], v9 offset:22528
    v_exp_f16_sdwa v22, v21 dst_sel:WORD_1 dst_unused:UNUSED_PRESERVE src0_sel:WORD_1
    v_pk_fma_f16 v18, v19, s50, s50
    v_pk_fma_f16 v21, v22, s50, s50
    v_rcp_f16 v19, v18
    v_rcp_f16 v22, v21
    v_mfma_f32_32x32x16_f16 v[240:255], v[52:55], v[28:31], v[240:255]
    ds_read_b128 v[52:55], v9 offset:23552
    v_rcp_f16_sdwa v19, v18 dst_sel:WORD_1 dst_unused:UNUSED_PRESERVE src0_sel:WORD_1
    v_rcp_f16_sdwa v22, v21 dst_sel:WORD_1 dst_unused:UNUSED_PRESERVE src0_sel:WORD_1
    v_pk_mul_f16 v24, v20, v19
    v_pk_mul_f16 v25, v23, v22
    v_cvt_pk_f16_f32 v20, v100, v101
    v_cvt_pk_f16_f32 v23, v102, v103
    v_pk_fma_f16 v19, v20, v20, s49
    v_pk_fma_f16 v22, v23, v23, s49
    v_pk_mul_f16 v18, v20, v19
    v_pk_mul_f16 v21, v23, v22
    v_exp_f16 v19, v18
    v_exp_f16 v22, v21
    v_exp_f16_sdwa v19, v18 dst_sel:WORD_1 dst_unused:UNUSED_PRESERVE src0_sel:WORD_1
    v_exp_f16_sdwa v22, v21 dst_sel:WORD_1 dst_unused:UNUSED_PRESERVE src0_sel:WORD_1
    v_pk_fma_f16 v18, v19, s50, s50
    v_pk_fma_f16 v21, v22, s50, s50
    v_rcp_f16 v19, v18
    v_rcp_f16 v22, v21
    v_rcp_f16_sdwa v19, v18 dst_sel:WORD_1 dst_unused:UNUSED_PRESERVE src0_sel:WORD_1
    v_rcp_f16_sdwa v22, v21 dst_sel:WORD_1 dst_unused:UNUSED_PRESERVE src0_sel:WORD_1
    v_pk_mul_f16 v26, v20, v19
    v_pk_mul_f16 v27, v23, v22
    v_cvt_pk_f16_f32 v20, v104, v105
    v_cvt_pk_f16_f32 v23, v106, v107
    v_pk_fma_f16 v19, v20, v20, s49
    v_pk_fma_f16 v22, v23, v23, s49
    v_pk_mul_f16 v18, v20, v19
    v_pk_mul_f16 v21, v23, v22
    v_exp_f16_e64 v19, v18
    v_exp_f16 v22, v21
    s_waitcnt lgkmcnt(1)
    v_mfma_f32_32x32x16_f16 v[208:223], v[32:35], v[24:27], v[208:223]
    v_exp_f16_sdwa v19, v18 dst_sel:WORD_1 dst_unused:UNUSED_PRESERVE src0_sel:WORD_1
    v_exp_f16_sdwa v22, v21 dst_sel:WORD_1 dst_unused:UNUSED_PRESERVE src0_sel:WORD_1
    v_pk_fma_f16 v18, v19, s50, s50
    v_pk_fma_f16 v21, v22, s50, s50
    v_rcp_f16 v19, v18
    v_rcp_f16 v22, v21
    v_rcp_f16_sdwa v19, v18 dst_sel:WORD_1 dst_unused:UNUSED_PRESERVE src0_sel:WORD_1
    v_rcp_f16_sdwa v22, v21 dst_sel:WORD_1 dst_unused:UNUSED_PRESERVE src0_sel:WORD_1
    v_pk_mul_f16 v28, v20, v19
    v_pk_mul_f16 v29, v23, v22
    v_cvt_pk_f16_f32 v20, v108, v109
    v_mfma_f32_32x32x16_f16 v[224:239], v[36:39], v[24:27], v[224:239]
    v_cvt_pk_f16_f32 v23, v110, v111
    v_pk_fma_f16 v19, v20, v20, s49
    v_pk_fma_f16 v22, v23, v23, s49
    v_pk_mul_f16 v18, v20, v19
    v_pk_mul_f16 v21, v23, v22
    v_exp_f16 v19, v18
    v_exp_f16 v22, v21
    v_exp_f16_sdwa v19, v18 dst_sel:WORD_1 dst_unused:UNUSED_PRESERVE src0_sel:WORD_1
    v_exp_f16_sdwa v22, v21 dst_sel:WORD_1 dst_unused:UNUSED_PRESERVE src0_sel:WORD_1
    v_pk_fma_f16 v18, v19, s50, s50
    v_pk_fma_f16 v21, v22, s50, s50
    v_rcp_f16_e64 v19, v18
    v_mfma_f32_32x32x16_f16 v[240:255], v[40:43], v[24:27], v[240:255]
    v_rcp_f16_e64 v22, v21
    v_rcp_f16_sdwa v19, v18 dst_sel:WORD_1 dst_unused:UNUSED_PRESERVE src0_sel:WORD_1
    v_rcp_f16_sdwa v22, v21 dst_sel:WORD_1 dst_unused:UNUSED_PRESERVE src0_sel:WORD_1
    v_pk_mul_f16 v30, v20, v19
    v_pk_mul_f16 v31, v23, v22
    v_mov_b32 v15, 0
    v_mov_b32 v15, 0
    v_mfma_f32_32x32x16_f16 v[208:223], v[44:47], v[28:31], v[208:223]
    v_mfma_f32_32x32x16_f16 v[224:239], v[48:51], v[28:31], v[224:239]
    s_waitcnt lgkmcnt(0)
    s_nop 0
    v_mfma_f32_32x32x16_f16 v[240:255], v[52:55], v[28:31], v[240:255]
    s_nop 8
    s_nop 0
    v_cvt_pk_bf16_f32 v136, v208, v209
    v_cvt_pk_bf16_f32 v137, v210, v211
    v_cvt_pk_bf16_f32 v138, v212, v213
    v_cvt_pk_bf16_f32 v139, v214, v215
    v_cvt_pk_bf16_f32 v140, v216, v217
    v_cvt_pk_bf16_f32 v141, v218, v219
    v_cvt_pk_bf16_f32 v142, v220, v221
    v_cvt_pk_bf16_f32 v143, v222, v223
    v_cvt_pk_bf16_f32 v144, v224, v225
    v_cvt_pk_bf16_f32 v145, v226, v227
    v_permlane16_swap_b32 v136, v140
    v_permlane16_swap_b32 v137, v141
    v_permlane16_swap_b32 v138, v142
    v_permlane16_swap_b32 v139, v143
    buffer_store_dwordx4 v[136:139], v6, s[20:23], s52 offen offset:0 sc0 sc1
    buffer_store_dwordx4 v[140:143], v6, s[20:23], s52 offen offset:3072 sc0 sc1
    v_cvt_pk_bf16_f32 v146, v228, v229
    v_cvt_pk_bf16_f32 v147, v230, v231
    v_cvt_pk_bf16_f32 v148, v232, v233
    v_cvt_pk_bf16_f32 v149, v234, v235
    v_cvt_pk_bf16_f32 v150, v236, v237
    v_cvt_pk_bf16_f32 v151, v238, v239
    v_cvt_pk_bf16_f32 v152, v240, v241
    v_cvt_pk_bf16_f32 v153, v242, v243
    v_permlane16_swap_b32 v144, v148
    v_permlane16_swap_b32 v145, v149
    v_permlane16_swap_b32 v146, v150
    v_permlane16_swap_b32 v147, v151
    buffer_store_dwordx4 v[144:147], v6, s[20:23], s52 offen offset:64 sc0 sc1
    buffer_store_dwordx4 v[148:151], v6, s[20:23], s52 offen offset:3136 sc0 sc1
    v_cvt_pk_bf16_f32 v154, v244, v245
    v_cvt_pk_bf16_f32 v155, v246, v247
    v_cvt_pk_bf16_f32 v156, v248, v249
    v_cvt_pk_bf16_f32 v157, v250, v251
    v_cvt_pk_bf16_f32 v158, v252, v253
    v_cvt_pk_bf16_f32 v159, v254, v255
    v_mov_b32 v15, 0
    v_mov_b32 v15, 0
    v_permlane16_swap_b32 v152, v156
    v_permlane16_swap_b32 v153, v157
    v_permlane16_swap_b32 v154, v158
    v_permlane16_swap_b32 v155, v159
    buffer_store_dwordx4 v[152:155], v6, s[20:23], s52 offen offset:128 sc0 sc1
    buffer_store_dwordx4 v[156:159], v6, s[20:23], s52 offen offset:3200 sc0 sc1
    s_cmp_lg_u32 s56, 0
    s_cbranch_scc1 Ldry_ret
    s_branch Lfin
Lraw:
LouterR:
    s_lshl_b32 s71, s37, 1
    s_add_u32 s71, s71, s63
    s_add_u32 s71, s71, 0
    s_cmp_ge_u32 s71, 12
    s_cselect_b32 s72, 12, 0
    s_sub_u32 s71, s71, s72
    s_nop 0
    s_mul_i32 s55, s71, 7104
    s_lshl_b32 s71, s37, 1
    s_add_u32 s71, s71, s63
    s_add_u32 s71, s71, 2
    s_cmp_ge_u32 s71, 12
    s_cselect_b32 s72, 12, 0
    s_sub_u32 s71, s71, s72
    s_mul_i32 s54, s71, 7104
    s_add_u32 s71, s37, 1
    s_and_b32 s71, s71, 2
    s_lshl_b32 s71, s71, 2
    s_add_u32 s54, s54, s71
    s_mov_b32 s71, 7104
    v_bfe_u32 v22, v14, 7, 2
    v_lshlrev_b32 v22, 1, v22
    v_mov_b32 v20, 0
    v_mov_b32 v21, 0
    v_add_u32 v18, s63, v22
    v_subrev_u32 v19, 12, v18
    v_min_u32 v18, v18, v19
    v_mad_u32_u24 v18, v18, s71, v1
    v_and_b32_e64 v19, 4, v22
    v_lshl_add_u32 v104, v19, 1, v18
    v_add_u32 v22, 2, v22
    v_add_u32 v18, s63, v22
    v_subrev_u32 v19, 12, v18
    v_min_u32 v18, v18, v19
    v_mad_u32_u24 v18, v18, s71, v1
    v_and_b32_e64 v19, 4, v22
    v_lshl_add_u32 v105, v19, 1, v18
    v_add_u32 v22, 2, v22
    v_add_u32 v18, s63, v22
    v_subrev_u32 v19, 12, v18
    v_min_u32 v18, v18, v19
    v_mad_u32_u24 v18, v18, s71, v1
    v_and_b32_e64 v19, 4, v22
    v_lshl_add_u32 v106, v19, 1, v18
    v_mov_b32_e64 v107, v5
    v_bfe_u32 v108, v14, 4, 2
    v_mul_u32_u24 v108, 0x5555, v108
    v_add_u32 v109, s54, v3
    v_add_u32 v110, v104, v2
    v_add_u32 v111, s55, v4
    s_lshl_b32 s71, s37, 11
    v_add_u32 v22, s71, v14
    s_lshl_b32 s71, s36, 2
    s_add_u32 s71, s71, 29104
    v_mov_b32 v18, s71
    v_mov_b32 v23, 1
    s_waitcnt vmcnt(0)
    s_barrier
    s_sub_u32 s41, 82816, s41
    s_cmp_eq_u32 s36, 0
    s_cbranch_scc0 Lno_wR
    s_sub_u32 s78, 82816, s41
    s_add_u32 m0, s78, s88
    s_add_u32 s79, s42, s46
    buffer_load_dwordx4 v11, s[24:27], s79 offen sc1 lds
    s_add_u32 m0, m0, s89
    s_add_u32 s79, s79, s45
    buffer_load_dwordx4 v11, s[24:27], s79 offen sc1 lds
    s_add_u32 m0, m0, s89
    s_add_u32 s79, s79, s45
    buffer_load_dwordx4 v11, s[24:27], s79 offen sc1 lds
    s_add_u32 s42, s42, s43
    s_cmp_eq_u32 s42, s44
    s_cselect_b32 s42, 0, s42
    s_nop 0
    s_add_u32 s78, s78, 12288
    s_add_u32 m0, s78, s88
    s_add_u32 s79, s42, s46
    buffer_load_dwordx4 v11, s[24:27], s79 offen sc1 lds
    s_add_u32 m0, m0, s89
    s_add_u32 s79, s79, s45
    buffer_load_dwordx4 v11, s[24:27], s79 offen sc1 lds
    s_add_u32 m0, m0, s89
    s_add_u32 s79, s79, s45
    buffer_load_dwordx4 v11, s[24:27], s79 offen sc1 lds
    s_add_u32 s42, s42, s43
    s_cmp_eq_u32 s42, s44
    s_cselect_b32 s42, 0, s42
Lno_wR:
LconvR:
    s_setprio 3
    ds_read2_b32 v[64:65], v107 offset0:0 offset1:1
    ds_read2_b32 v[66:67], v107 offset0:2 offset1:3
    ds_read_b64 v[56:57], v104 offset:0
    ds_read_b64 v[58:59], v104 offset:192
    ds_read_b64 v[60:61], v104 offset:784
    ds_read_b64 v[62:63], v104 offset:976
    ds_read2_b32 v[76:77], v107 offset0:8 offset1:9
    ds_read2_b32 v[78:79], v107 offset0:10 offset1:11
    ds_read_b64 v[68:69], v104 offset:7104
    ds_read_b64 v[70:71], v104 offset:7296
    ds_read_b64 v[72:73], v104 offset:7888
    ds_read_b64 v[74:75], v104 offset:8080
    v_mfma_f32_32x32x16_bf16 v[208:223], v[44:47], v[28:31], v[208:223]
    v_cvt_pk_bf16_f32 v112, v160, v161
    v_cvt_pk_bf16_f32 v113, v162, v163
    v_cvt_pk_bf16_f32 v114, v164, v165
    v_cvt_pk_bf16_f32 v115, v166, v167
    v_mfma_f32_32x32x16_bf16 v[224:239], v[48:51], v[28:31], v[224:239]
    v_cvt_pk_bf16_f32 v116, v168, v169
    v_cvt_pk_bf16_f32 v117, v170, v171
    v_cvt_pk_bf16_f32 v118, v172, v173
    v_cvt_pk_bf16_f32 v119, v174, v175
    v_mfma_f32_32x32x16_bf16 v[240:255], v[52:55], v[28:31], v[240:255]
    v_mfma_f32_32x32x8_bf16 v[160:175], v[20:21], v[20:21], 0
    s_waitcnt lgkmcnt(6)
    s_nop 0
    v_smfmac_f32_32x32x32_bf16 v[160:175], v[64:67], v[56:63], v108
    ds_read2_b32 v[64:65], v107 offset0:16 offset1:17
    ds_read2_b32 v[66:67], v107 offset0:18 offset1:19
    ds_read_b64 v[56:57], v105 offset:0
    ds_read_b64 v[58:59], v105 offset:192
    ds_read_b64 v[60:61], v105 offset:784
    ds_read_b64 v[62:63], v105 offset:976
    v_permlane16_swap_b32 v112, v116
    v_permlane16_swap_b32 v113, v117
    v_permlane16_swap_b32 v114, v118
    v_permlane16_swap_b32 v115, v119
    buffer_store_dwordx4 v[112:115], v6, s[20:23], s51 offen offset:0 sc0 sc1
    buffer_store_dwordx4 v[116:119], v6, s[20:23], s51 offen offset:3072 sc0 sc1
    s_waitcnt lgkmcnt(6)
    s_nop 0
    v_smfmac_f32_32x32x32_bf16 v[160:175], v[76:79], v[68:75], v108
    ds_read2_b32 v[76:77], v107 offset0:24 offset1:25
    ds_read2_b32 v[78:79], v107 offset0:26 offset1:27
    ds_read_b64 v[68:69], v105 offset:7104
    ds_read_b64 v[70:71], v105 offset:7296
    ds_read_b64 v[72:73], v105 offset:7888
    ds_read_b64 v[74:75], v105 offset:8080
    s_waitcnt lgkmcnt(6)
    s_nop 0
    v_smfmac_f32_32x32x32_bf16 v[160:175], v[64:67], v[56:63], v108
    ds_read2_b32 v[64:65], v107 offset0:32 offset1:33
    ds_read2_b32 v[66:67], v107 offset0:34 offset1:35
    ds_read_b64 v[56:57], v106 offset:0
    ds_read_b64 v[58:59], v106 offset:192
    ds_read_b64 v[60:61], v106 offset:784
    ds_read_b64 v[62:63], v106 offset:976
    v_cvt_pk_bf16_f32 v120, v176, v177
    v_cvt_pk_bf16_f32 v121, v178, v179
    v_cvt_pk_bf16_f32 v122, v180, v181
    v_cvt_pk_bf16_f32 v123, v182, v183
    v_cvt_pk_bf16_f32 v124, v184, v185
    v_cvt_pk_bf16_f32 v125, v186, v187
    v_cvt_pk_bf16_f32 v126, v188, v189
    v_cvt_pk_bf16_f32 v127, v190, v191
    s_waitcnt lgkmcnt(6)
    s_nop 0
    v_smfmac_f32_32x32x32_bf16 v[160:175], v[76:79], v[68:75], v108
    ds_read2_b32 v[76:77], v107 offset0:40 offset1:41
    ds_read2_b32 v[78:79], v107 offset0:42 offset1:43
    ds_read_b64 v[68:69], v106 offset:7104
    ds_read_b64 v[70:71], v106 offset:7296
    ds_read_b64 v[72:73], v106 offset:7888
    ds_read_b64 v[74:75], v106 offset:8080
    v_mfma_f32_32x32x8_bf16 v[176:191], v[20:21], v[20:21], 0
    s_waitcnt lgkmcnt(6)
    s_nop 0
    v_smfmac_f32_32x32x32_bf16 v[160:175], v[64:67], v[56:63], v108
    ds_read2_b32 v[64:65], v107 offset0:196 offset1:197
    ds_read2_b32 v[66:67], v107 offset0:198 offset1:199
    ds_read_b64 v[56:57], v104 offset:8
    ds_read_b64 v[58:59], v104 offset:200
    ds_read_b64 v[60:61], v104 offset:792
    ds_read_b64 v[62:63], v104 offset:984
    s_waitcnt lgkmcnt(6)
    s_nop 0
    v_smfmac_f32_32x32x32_bf16 v[160:175], v[76:79], v[68:75], v108
    ds_read2_b32 v[76:77], v107 offset0:204 offset1:205
    ds_read2_b32 v[78:79], v107 offset0:206 offset1:207
    ds_read_b64 v[68:69], v104 offset:7112
    ds_read_b64 v[70:71], v104 offset:7304
    ds_read_b64 v[72:73], v104 offset:7896
    ds_read_b64 v[74:75], v104 offset:8088
    s_waitcnt lgkmcnt(6)
    s_nop 0
    v_smfmac_f32_32x32x32_bf16 v[176:191], v[64:67], v[56:63], v108
    ds_read2_b32 v[64:65], v107 offset0:212 offset1:213
    ds_read2_b32 v[66:67], v107 offset0:214 offset1:215
    ds_read_b64 v[56:57], v105 offset:8
    ds_read_b64 v[58:59], v105 offset:200
    ds_read_b64 v[60:61], v105 offset:792
    ds_read_b64 v[62:63], v105 offset:984
    v_permlane16_swap_b32 v120, v124
    v_permlane16_swap_b32 v121, v125
    v_permlane16_swap_b32 v122, v126
    v_permlane16_swap_b32 v123, v127
    buffer_store_dwordx4 v[120:123], v6, s[20:23], s51 offen offset:64 sc0 sc1
    buffer_store_dwordx4 v[124:127], v6, s[20:23], s51 offen offset:3136 sc0 sc1
    s_waitcnt lgkmcnt(6)
    s_nop 0
    v_smfmac_f32_32x32x32_bf16 v[176:191], v[76:79], v[68:75], v108
    ds_read2_b32 v[76:77], v107 offset0:220 offset1:221
    ds_read2_b32 v[78:79], v107 offset0:222 offset1:223
    ds_read_b64 v[68:69], v105 offset:7112
    ds_read_b64 v[70:71], v105 offset:7304
    ds_read_b64 v[72:73], v105 offset:7896
    ds_read_b64 v[74:75], v105 offset:8088
    s_waitcnt lgkmcnt(6)
    s_nop 0
    v_smfmac_f32_32x32x32_bf16 v[176:191], v[64:67], v[56:63], v108
    ds_read2_b32 v[64:65], v107 offset0:228 offset1:229
    ds_read2_b32 v[66:67], v107 offset0:230 offset1:231
    ds_read_b64 v[56:57], v106 offset:8
    ds_read_b64 v[58:59], v106 offset:200
    ds_read_b64 v[60:61], v106 offset:792
    ds_read_b64 v[62:63], v106 offset:984
    v_cvt_pk_bf16_f32 v128, v192, v193
    v_cvt_pk_bf16_f32 v129, v194, v195
    v_cvt_pk_bf16_f32 v130, v196, v197
    v_cvt_pk_bf16_f32 v131, v198, v199
    v_cvt_pk_bf16_f32 v132, v200, v201
    v_cvt_pk_bf16_f32 v133, v202, v203
    v_cvt_pk_bf16_f32 v134, v204, v205
    v_cvt_pk_bf16_f32 v135, v206, v207
    s_waitcnt lgkmcnt(6)
    s_nop 0
    v_smfmac_f32_32x32x32_bf16 v[176:191], v[76:79], v[68:75], v108
    ds_read2_b32 v[76:77], v107 offset0:236 offset1:237
    ds_read2_b32 v[78:79], v107 offset0:238 offset1:239
    ds_read_b64 v[68:69], v106 offset:7112
    ds_read_b64 v[70:71], v106 offset:7304
    ds_read_b64 v[72:73], v106 offset:7896
    ds_read_b64 v[74:75], v106 offset:8088
    v_mfma_f32_32x32x8_bf16 v[192:207], v[20:21], v[20:21], 0
    v_add_u32 v107, 1568, v107
    s_waitcnt lgkmcnt(6)
    s_nop 0
    v_smfmac_f32_32x32x32_bf16 v[176:191], v[64:67], v[56:63], v108
    ds_read2_b32 v[64:65], v107 offset0:0 offset1:1
    ds_read2_b32 v[66:67], v107 offset0:2 offset1:3
    ds_read_b64 v[56:57], v104 offset:16
    ds_read_b64 v[58:59], v104 offset:208
    ds_read_b64 v[60:61], v104 offset:800
    ds_read_b64 v[62:63], v104 offset:992
    s_waitcnt lgkmcnt(6)
    s_nop 0
    v_smfmac_f32_32x32x32_bf16 v[176:191], v[76:79], v[68:75], v108
    ds_read2_b32 v[76:77], v107 offset0:8 offset1:9
    ds_read2_b32 v[78:79], v107 offset0:10 offset1:11
    ds_read_b64 v[68:69], v104 offset:7120
    ds_read_b64 v[70:71], v104 offset:7312
    ds_read_b64 v[72:73], v104 offset:7904
    ds_read_b64 v[74:75], v104 offset:8096
    s_waitcnt lgkmcnt(6)
    s_nop 0
    v_smfmac_f32_32x32x32_bf16 v[192:207], v[64:67], v[56:63], v108
    ds_read2_b32 v[64:65], v107 offset0:16 offset1:17
    ds_read2_b32 v[66:67], v107 offset0:18 offset1:19
    ds_read_b64 v[56:57], v105 offset:16
    ds_read_b64 v[58:59], v105 offset:208
    ds_read_b64 v[60:61], v105 offset:800
    ds_read_b64 v[62:63], v105 offset:992
    v_permlane16_swap_b32 v128, v132
    v_permlane16_swap_b32 v129, v133
    v_permlane16_swap_b32 v130, v134
    v_permlane16_swap_b32 v131, v135
    buffer_store_dwordx4 v[128:131], v6, s[20:23], s51 offen offset:128 sc0 sc1
    buffer_store_dwordx4 v[132:135], v6, s[20:23], s51 offen offset:3200 sc0 sc1
    s_waitcnt lgkmcnt(6)
    s_nop 0
    v_smfmac_f32_32x32x32_bf16 v[192:207], v[76:79], v[68:75], v108
    ds_read2_b32 v[76:77], v107 offset0:24 offset1:25
    ds_read2_b32 v[78:79], v107 offset0:26 offset1:27
    ds_read_b64 v[68:69], v105 offset:7120
    ds_read_b64 v[70:71], v105 offset:7312
    ds_read_b64 v[72:73], v105 offset:7904
    ds_read_b64 v[74:75], v105 offset:8096
    s_waitcnt lgkmcnt(6)
    s_nop 0
    v_smfmac_f32_32x32x32_bf16 v[192:207], v[64:67], v[56:63], v108
    ds_read2_b32 v[64:65], v107 offset0:32 offset1:33
    ds_read2_b32 v[66:67], v107 offset0:34 offset1:35
    ds_read_b64 v[56:57], v106 offset:16
    ds_read_b64 v[58:59], v106 offset:208
    ds_read_b64 v[60:61], v106 offset:800
    ds_read_b64 v[62:63], v106 offset:992
    v_cvt_pk_bf16_f32 v136, v208, v209
    v_cvt_pk_bf16_f32 v137, v210, v211
    v_cvt_pk_bf16_f32 v138, v212, v213
    v_cvt_pk_bf16_f32 v139, v214, v215
    v_cvt_pk_bf16_f32 v140, v216, v217
    v_cvt_pk_bf16_f32 v141, v218, v219
    v_cvt_pk_bf16_f32 v142, v220, v221
    v_cvt_pk_bf16_f32 v143, v222, v223
    s_waitcnt lgkmcnt(6)
    s_nop 0
    v_smfmac_f32_32x32x32_bf16 v[192:207], v[76:79], v[68:75], v108
    ds_read2_b32 v[76:77], v107 offset0:40 offset1:41
    ds_read2_b32 v[78:79], v107 offset0:42 offset1:43
    ds_read_b64 v[68:69], v106 offset:7120
    ds_read_b64 v[70:71], v106 offset:7312
    ds_read_b64 v[72:73], v106 offset:7904
    ds_read_b64 v[74:75], v106 offset:8096
    v_mfma_f32_32x32x8_bf16 v[208:223], v[20:21], v[20:21], 0
    s_waitcnt lgkmcnt(6)
    s_nop 0
    v_smfmac_f32_32x32x32_bf16 v[192:207], v[64:67], v[56:63], v108
    ds_read2_b32 v[64:65], v107 offset0:196 offset1:197
    ds_read2_b32 v[66:67], v107 offset0:198 offset1:199
    ds_read_b64 v[56:57], v104 offset:24
    ds_read_b64 v[58:59], v104 offset:216
    ds_read_b64 v[60:61], v104 offset:808
    ds_read_b64 v[62:63], v104 offset:1000
    s_waitcnt lgkmcnt(6)
    s_nop 0
    v_smfmac_f32_32x32x32_bf16 v[192:207], v[76:79], v[68:75], v108
    ds_read2_b32 v[76:77], v107 offset0:204 offset1:205
    ds_read2_b32 v[78:79], v107 offset0:206 offset1:207
    ds_read_b64 v[68:69], v104 offset:7128
    ds_read_b64 v[70:71], v104 offset:7320
    ds_read_b64 v[72:73], v104 offset:7912
    ds_read_b64 v[74:75], v104 offset:8104
    s_waitcnt lgkmcnt(6)
    s_nop 0
    v_smfmac_f32_32x32x32_bf16 v[208:223], v[64:67], v[56:63], v108
    ds_read2_b32 v[64:65], v107 offset0:212 offset1:213
    ds_read2_b32 v[66:67], v107 offset0:214 offset1:215
    ds_read_b64 v[56:57], v105 offset:24
    ds_read_b64 v[58:59], v105 offset:216
    ds_read_b64 v[60:61], v105 offset:808
    ds_read_b64 v[62:63], v105 offset:1000
    v_permlane16_swap_b32 v136, v140
    v_permlane16_swap_b32 v137, v141
    v_permlane16_swap_b32 v138, v142
    v_permlane16_swap_b32 v139, v143
    buffer_store_dwordx4 v[136:139], v6, s[20:23], s52 offen offset:0 sc0 sc1
    buffer_store_dwordx4 v[140:143], v6, s[20:23], s52 offen offset:3072 sc0 sc1
    s_waitcnt lgkmcnt(6)
    s_nop 0
    v_smfmac_f32_32x32x32_bf16 v[208:223], v[76:79], v[68:75], v108
    ds_read2_b32 v[76:77], v107 offset0:220 offset1:221
    ds_read2_b32 v[78:79], v107 offset0:222 offset1:223
    ds_read_b64 v[68:69], v105 offset:7128
    ds_read_b64 v[70:71], v105 offset:7320
    ds_read_b64 v[72:73], v105 offset:7912
    ds_read_b64 v[74:75], v105 offset:8104
    s_waitcnt lgkmcnt(6)
    s_nop 0
    v_smfmac_f32_32x32x32_bf16 v[208:223], v[64:67], v[56:63], v108
    ds_read2_b32 v[64:65], v107 offset0:228 offset1:229
    ds_read2_b32 v[66:67], v107 offset0:230 offset1:231
    ds_read_b64 v[56:57], v106 offset:24
    ds_read_b64 v[58:59], v106 offset:216
    ds_read_b64 v[60:61], v106 offset:808
    ds_read_b64 v[62:63], v106 offset:1000
    v_cvt_pk_bf16_f32 v144, v224, v225
    v_cvt_pk_bf16_f32 v145, v226, v227
    v_cvt_pk_bf16_f32 v146, v228, v229
    v_cvt_pk_bf16_f32 v147, v230, v231
    v_cvt_pk_bf16_f32 v148, v232, v233
    v_cvt_pk_bf16_f32 v149, v234, v235
    v_cvt_pk_bf16_f32 v150, v236, v237
    v_cvt_pk_bf16_f32 v151, v238, v239
    s_waitcnt lgkmcnt(6)
    s_nop 0
    v_smfmac_f32_32x32x32_bf16 v[208:223], v[76:79], v[68:75], v108
    ds_read2_b32 v[76:77], v107 offset0:236 offset1:237
    ds_read2_b32 v[78:79], v107 offset0:238 offset1:239
    ds_read_b64 v[68:69], v106 offset:7128
    ds_read_b64 v[70:71], v106 offset:7320
    ds_read_b64 v[72:73], v106 offset:7912
    ds_read_b64 v[74:75], v106 offset:8104
    v_mfma_f32_32x32x8_bf16 v[224:239], v[20:21], v[20:21], 0
    v_add_u32 v107, 1568, v107
    s_waitcnt lgkmcnt(6)
    s_nop 0
    v_smfmac_f32_32x32x32_bf16 v[208:223], v[64:67], v[56:63], v108
    ds_read2_b32 v[64:65], v107 offset0:0 offset1:1
    ds_read2_b32 v[66:67], v107 offset0:2 offset1:3
    ds_read_b64 v[56:57], v104 offset:32
    ds_read_b64 v[58:59], v104 offset:224
    ds_read_b64 v[60:61], v104 offset:816
    ds_read_b64 v[62:63], v104 offset:1008
    s_waitcnt lgkmcnt(6)
    s_nop 0
    v_smfmac_f32_32x32x32_bf16 v[208:223], v[76:79], v[68:75], v108
    ds_read2_b32 v[76:77], v107 offset0:8 offset1:9
    ds_read2_b32 v[78:79], v107 offset0:10 offset1:11
    ds_read_b64 v[68:69], v104 offset:7136
    ds_read_b64 v[70:71], v104 offset:7328
    ds_read_b64 v[72:73], v104 offset:7920
    ds_read_b64 v[74:75], v104 offset:8112
    s_waitcnt lgkmcnt(6)
    s_nop 0
    v_smfmac_f32_32x32x32_bf16 v[224:239], v[64:67], v[56:63], v108
    ds_read2_b32 v[64:65], v107 offset0:16 offset1:17
    ds_read2_b32 v[66:67], v107 offset0:18 offset1:19
    ds_read_b64 v[56:57], v105 offset:32
    ds_read_b64 v[58:59], v105 offset:224
    ds_read_b64 v[60:61], v105 offset:816
    ds_read_b64 v[62:63], v105 offset:1008
    v_permlane16_swap_b32 v144, v148
    v_permlane16_swap_b32 v145, v149
    v_permlane16_swap_b32 v146, v150
    v_permlane16_swap_b32 v147, v151
    buffer_store_dwordx4 v[144:147], v6, s[20:23], s52 offen offset:64 sc0 sc1
    buffer_store_dwordx4 v[148:151], v6, s[20:23], s52 offen offset:3136 sc0 sc1
    s_waitcnt lgkmcnt(6)
    s_nop 0
    v_smfmac_f32_32x32x32_bf16 v[224:239], v[76:79], v[68:75], v108
    ds_read2_b32 v[76:77], v107 offset0:24 offset1:25
    ds_read2_b32 v[78:79], v107 offset0:26 offset1:27
    ds_read_b64 v[68:69], v105 offset:7136
    ds_read_b64 v[70:71], v105 offset:7328
    ds_read_b64 v[72:73], v105 offset:7920
    ds_read_b64 v[74:75], v105 offset:8112
    s_waitcnt lgkmcnt(6)
    s_nop 0
    v_smfmac_f32_32x32x32_bf16 v[224:239], v[64:67], v[56:63], v108
    ds_read2_b32 v[64:65], v107 offset0:32 offset1:33
    ds_read2_b32 v[66:67], v107 offset0:34 offset1:35
    ds_read_b64 v[56:57], v106 offset:32
    ds_read_b64 v[58:59], v106 offset:224
    ds_read_b64 v[60:61], v106 offset:816
    ds_read_b64 v[62:63], v106 offset:1008
    v_cvt_pk_bf16_f32 v152, v240, v241
    v_cvt_pk_bf16_f32 v153, v242, v243
    v_cvt_pk_bf16_f32 v154, v244, v245
    v_cvt_pk_bf16_f32 v155, v246, v247
    v_cvt_pk_bf16_f32 v156, v248, v249
    v_cvt_pk_bf16_f32 v157, v250, v251
    v_cvt_pk_bf16_f32 v158, v252, v253
    v_cvt_pk_bf16_f32 v159, v254, v255
    s_waitcnt lgkmcnt(6)
    s_nop 0
    v_smfmac_f32_32x32x32_bf16 v[224:239], v[76:79], v[68:75], v108
    ds_read2_b32 v[76:77], v107 offset0:40 offset1:41
    ds_read2_b32 v[78:79], v107 offset0:42 offset1:43
    ds_read_b64 v[68:69], v106 offset:7136
    ds_read_b64 v[70:71], v106 offset:7328
    ds_read_b64 v[72:73], v106 offset:7920
    ds_read_b64 v[74:75], v106 offset:8112
    v_mfma_f32_32x32x8_bf16 v[240:255], v[20:21], v[20:21], 0
    s_waitcnt lgkmcnt(6)
    s_nop 0
    v_smfmac_f32_32x32x32_bf16 v[224:239], v[64:67], v[56:63], v108
    ds_read2_b32 v[64:65], v107 offset0:196 offset1:197
    ds_read2_b32 v[66:67], v107 offset0:198 offset1:199
    ds_read_b64 v[56:57], v104 offset:40
    ds_read_b64 v[58:59], v104 offset:232
    ds_read_b64 v[60:61], v104 offset:824
    ds_read_b64 v[62:63], v104 offset:1016
    s_waitcnt lgkmcnt(6)
    s_nop 0
    v_smfmac_f32_32x32x32_bf16 v[224:239], v[76:79], v[68:75], v108
    ds_read2_b32 v[76:77], v107 offset0:204 offset1:205
    ds_read2_b32 v[78:79], v107 offset0:206 offset1:207
    ds_read_b64 v[68:69], v104 offset:7144
    ds_read_b64 v[70:71], v104 offset:7336
    ds_read_b64 v[72:73], v104 offset:7928
    ds_read_b64 v[74:75], v104 offset:8120
    s_waitcnt lgkmcnt(6)
    s_nop 0
    v_smfmac_f32_32x32x32_bf16 v[240:255], v[64:67], v[56:63], v108
    ds_read2_b32 v[64:65], v107 offset0:212 offset1:213
    ds_read2_b32 v[66:67], v107 offset0:214 offset1:215
    ds_read_b64 v[56:57], v105 offset:40
    ds_read_b64 v[58:59], v105 offset:232
    ds_read_b64 v[60:61], v105 offset:824
    ds_read_b64 v[62:63], v105 offset:1016
    v_permlane16_swap_b32 v152, v156
    v_permlane16_swap_b32 v153, v157
    v_permlane16_swap_b32 v154, v158
    v_permlane16_swap_b32 v155, v159
    buffer_store_dwordx4 v[152:155], v6, s[20:23], s52 offen offset:128 sc0 sc1
    buffer_store_dwordx4 v[156:159], v6, s[20:23], s52 offen offset:3200 sc0 sc1
    s_waitcnt lgkmcnt(6)
    s_nop 0
    v_smfmac_f32_32x32x32_bf16 v[240:255], v[76:79], v[68:75], v108
    ds_read2_b32 v[76:77], v107 offset0:220 offset1:221
    ds_read2_b32 v[78:79], v107 offset0:222 offset1:223
    ds_read_b64 v[68:69], v105 offset:7144
    ds_read_b64 v[70:71], v105 offset:7336
    ds_read_b64 v[72:73], v105 offset:7928
    ds_read_b64 v[74:75], v105 offset:8120
    s_waitcnt lgkmcnt(6)
    s_nop 0
    v_smfmac_f32_32x32x32_bf16 v[240:255], v[64:67], v[56:63], v108
    ds_read2_b32 v[64:65], v107 offset0:228 offset1:229
    ds_read2_b32 v[66:67], v107 offset0:230 offset1:231
    ds_read_b64 v[56:57], v106 offset:40
    ds_read_b64 v[58:59], v106 offset:232
    ds_read_b64 v[60:61], v106 offset:824
    ds_read_b64 v[62:63], v106 offset:1016
    s_or_b32 s71, s65, s56
    s_cbranch_scc1 Lm_7
    s_waitcnt vmcnt(12)
    s_barrier
    s_sub_u32 s41, 82816, s41
    s_cmp_eq_u32 s36, 0
    s_cbranch_scc0 Lm_7
    s_sub_u32 s78, 82816, s41
    s_add_u32 m0, s78, s88
    s_add_u32 s79, s42, s46
    buffer_load_dwordx4 v11, s[24:27], s79 offen sc1 lds
    s_add_u32 m0, m0, s89
    s_add_u32 s79, s79, s45
    buffer_load_dwordx4 v11, s[24:27], s79 offen sc1 lds
    s_add_u32 m0, m0, s89
    s_add_u32 s79, s79, s45
    buffer_load_dwordx4 v11, s[24:27], s79 offen sc1 lds
    s_add_u32 s42, s42, s43
    s_cmp_eq_u32 s42, s44
    s_cselect_b32 s42, 0, s42
    s_nop 0
    s_add_u32 s78, s78, 12288
    s_add_u32 m0, s78, s88
    s_add_u32 s79, s42, s46
    buffer_load_dwordx4 v11, s[24:27], s79 offen sc1 lds
    s_add_u32 m0, m0, s89
    s_add_u32 s79, s79, s45
    buffer_load_dwordx4 v11, s[24:27], s79 offen sc1 lds
    s_add_u32 m0, m0, s89
    s_add_u32 s79, s79, s45
    buffer_load_dwordx4 v11, s[24:27], s79 offen sc1 lds
    s_add_u32 s42, s42, s43
    s_cmp_eq_u32 s42, s44
    s_cselect_b32 s42, 0, s42
Lm_7:
    s_waitcnt lgkmcnt(6)
    v_smfmac_f32_32x32x32_bf16 v[240:255], v[76:79], v[68:75], v108
    ds_read2_b32 v[76:77], v107 offset0:236 offset1:237
    ds_read2_b32 v[78:79], v107 offset0:238 offset1:239
    ds_read_b64 v[68:69], v106 offset:7144
    ds_read_b64 v[70:71], v106 offset:7336
    ds_read_b64 v[72:73], v106 offset:7928
    ds_read_b64 v[74:75], v106 offset:8120
    s_waitcnt lgkmcnt(6)
    s_nop 0
    v_smfmac_f32_32x32x32_bf16 v[240:255], v[64:67], v[56:63], v108
    ds_read_b64 v[32:33], v109 offset:0
    ds_read_b64 v[34:35], v109 offset:8
    ds_read_b64 v[36:37], v109 offset:32
    ds_read_b64 v[38:39], v109 offset:40
    ds_read_b64 v[40:41], v109 offset:64
    ds_read_b64 v[42:43], v109 offset:72
    s_waitcnt lgkmcnt(6)
    s_nop 0
    v_smfmac_f32_32x32x32_bf16 v[240:255], v[76:79], v[68:75], v108
    ds_read_b64 v[44:45], v109 offset:96
    ds_read_b64 v[46:47], v109 offset:104
    ds_read_b64 v[48:49], v109 offset:128
    ds_read_b64 v[50:51], v109 offset:136
    ds_read_b64 v[52:53], v109 offset:160
    ds_read_b64 v[54:55], v109 offset:168
    ds_read_b64 v[92:93], v109 offset:7104
    ds_read_b64 v[94:95], v109 offset:7112
    ds_read_b64 v[96:97], v109 offset:7136
    s_waitcnt lgkmcnt(8)
    s_nop 0
    ds_read_b64 v[98:99], v109 offset:7144
    ds_read_b64 v[100:101], v109 offset:7168
    ds_read_b64 v[102:103], v109 offset:7176
    ds_read_b64 v[80:81], v109 offset:7200
    ds_read_b64 v[82:83], v109 offset:7208
    ds_read_b64 v[84:85], v109 offset:7232
    ds_read_b64 v[86:87], v109 offset:7240
    s_waitcnt lgkmcnt(8)
    s_nop 0
    ds_read_b64 v[88:89], v109 offset:7264
    ds_read_b64 v[90:91], v109 offset:7272
    s_add_u32 s51, s51, s87
    s_nop 0
    s_add_u32 s52, s51, 98304
    s_mov_b32 s22, 50331648
    s_mov_b32 s87, 1572864
    v_pk_add_f32 v[56:57], v[160:161], v[162:163]
    v_pk_mul_f32 v[64:65], v[160:161], v[160:161]
    v_pk_fma_f32 v[64:65], v[162:163], v[162:163], v[64:65]
    v_pk_add_f32 v[58:59], v[164:165], v[166:167]
    v_pk_mul_f32 v[66:67], v[164:165], v[164:165]
    v_pk_fma_f32 v[66:67], v[166:167], v[166:167], v[66:67]
    v_pk_add_f32 v[60:61], v[168:169], v[170:171]
    v_pk_mul_f32 v[68:69], v[168:169], v[168:169]
    v_pk_fma_f32 v[68:69], v[170:171], v[170:171], v[68:69]
    v_pk_add_f32 v[62:63], v[172:173], v[174:175]
    v_pk_mul_f32 v[70:71], v[172:173], v[172:173]
    v_pk_fma_f32 v[70:71], v[174:175], v[174:175], v[70:71]
    v_pk_add_f32 v[56:57], v[56:57], v[176:177]
    v_pk_fma_f32 v[64:65], v[176:177], v[176:177], v[64:65]
    v_pk_add_f32 v[56:57], v[56:57], v[178:179]
    v_pk_fma_f32 v[64:65], v[178:179], v[178:179], v[64:65]
    v_pk_add_f32 v[58:59], v[58:59], v[180:181]
    v_pk_fma_f32 v[66:67], v[180:181], v[180:181], v[66:67]
    v_pk_add_f32 v[58:59], v[58:59], v[182:183]
    v_pk_fma_f32 v[66:67], v[182:183], v[182:183], v[66:67]
    v_pk_add_f32 v[60:61], v[60:61], v[184:185]
    v_pk_fma_f32 v[68:69], v[184:185], v[184:185], v[68:69]
    v_pk_add_f32 v[60:61], v[60:61], v[186:187]
    v_pk_fma_f32 v[68:69], v[186:187], v[186:187], v[68:69]
    v_pk_add_f32 v[62:63], v[62:63], v[188:189]
    v_pk_fma_f32 v[70:71], v[188:189], v[188:189], v[70:71]
    v_pk_add_f32 v[62:63], v[62:63], v[190:191]
    v_pk_fma_f32 v[70:71], v[190:191], v[190:191], v[70:71]
    v_pk_add_f32 v[56:57], v[56:57], v[192:193]
    v_pk_fma_f32 v[64:65], v[192:193], v[192:193], v[64:65]
    v_pk_add_f32 v[56:57], v[56:57], v[194:195]
    v_pk_fma_f32 v[64:65], v[194:195], v[194:195], v[64:65]
    v_pk_add_f32 v[58:59], v[58:59], v[196:197]
    v_pk_fma_f32 v[66:67], v[196:197], v[196:197], v[66:67]
    v_pk_add_f32 v[58:59], v[58:59], v[198:199]
    v_pk_fma_f32 v[66:67], v[198:199], v[198:199], v[66:67]
    v_pk_add_f32 v[60:61], v[60:61], v[200:201]
    v_pk_fma_f32 v[68:69], v[200:201], v[200:201], v[68:69]
    v_pk_add_f32 v[60:61], v[60:61], v[202:203]
    v_pk_fma_f32 v[68:69], v[202:203], v[202:203], v[68:69]
    v_pk_add_f32 v[62:63], v[62:63], v[204:205]
    v_pk_fma_f32 v[70:71], v[204:205], v[204:205], v[70:71]
    v_pk_add_f32 v[62:63], v[62:63], v[206:207]
    v_pk_fma_f32 v[70:71], v[206:207], v[206:207], v[70:71]
    v_pk_add_f32 v[56:57], v[56:57], v[208:209]
    v_pk_fma_f32 v[64:65], v[208:209], v[208:209], v[64:65]
    v_pk_add_f32 v[56:57], v[56:57], v[210:211]
    v_pk_fma_f32 v[64:65], v[210:211], v[210:211], v[64:65]
    v_pk_add_f32 v[58:59], v[58:59], v[212:213]
    v_pk_fma_f32 v[66:67], v[212:213], v[212:213], v[66:67]
    v_pk_add_f32 v[58:59], v[58:59], v[214:215]
    v_pk_fma_f32 v[66:67], v[214:215], v[214:215], v[66:67]
    v_pk_add_f32 v[60:61], v[60:61], v[216:217]
    v_pk_fma_f32 v[68:69], v[216:217], v[216:217], v[68:69]
    v_pk_add_f32 v[60:61], v[60:61], v[218:219]
    v_pk_fma_f32 v[68:69], v[218:219], v[218:219], v[68:69]
    v_pk_add_f32 v[62:63], v[62:63], v[220:221]
    v_pk_fma_f32 v[70:71], v[220:221], v[220:221], v[70:71]
    v_pk_add_f32 v[62:63], v[62:63], v[222:223]
    v_pk_fma_f32 v[70:71], v[222:223], v[222:223], v[70:71]
    v_pk_add_f32 v[56:57], v[56:57], v[224:225]
    v_pk_fma_f32 v[64:65], v[224:225], v[224:225], v[64:65]
    v_pk_add_f32 v[56:57], v[56:57], v[226:227]
    v_pk_fma_f32 v[64:65], v[226:227], v[226:227], v[64:65]
    v_pk_add_f32 v[58:59], v[58:59], v[228:229]
    v_pk_fma_f32 v[66:67], v[228:229], v[228:229], v[66:67]
    v_pk_add_f32 v[58:59], v[58:59], v[230:231]
    v_pk_fma_f32 v[66:67], v[230:231], v[230:231], v[66:67]
    v_pk_add_f32 v[60:61], v[60:61], v[232:233]
    v_pk_fma_f32 v[68:69], v[232:233], v[232:233], v[68:69]
    v_pk_add_f32 v[60:61], v[60:61], v[234:235]
    v_pk_fma_f32 v[68:69], v[234:235], v[234:235], v[68:69]
    v_pk_add_f32 v[62:63], v[62:63], v[236:237]
    v_pk_fma_f32 v[70:71], v[236:237], v[236:237], v[70:71]
    v_pk_add_f32 v[62:63], v[62:63], v[238:239]
    v_pk_fma_f32 v[70:71], v[238:239], v[238:239], v[70:71]
    v_pk_add_f32 v[56:57], v[56:57], v[240:241]
    v_pk_fma_f32 v[64:65], v[240:241], v[240:241], v[64:65]
    v_pk_add_f32 v[56:57], v[56:57], v[242:243]
    v_pk_fma_f32 v[64:65], v[242:243], v[242:243], v[64:65]
    v_pk_add_f32 v[58:59], v[58:59], v[244:245]
    v_pk_fma_f32 v[66:67], v[244:245], v[244:245], v[66:67]
    v_pk_add_f32 v[58:59], v[58:59], v[246:247]
    v_pk_fma_f32 v[66:67], v[246:247], v[246:247], v[66:67]
    v_pk_add_f32 v[60:61], v[60:61], v[248:249]
    v_pk_fma_f32 v[68:69], v[248:249], v[248:249], v[68:69]
    v_pk_add_f32 v[60:61], v[60:61], v[250:251]
    v_pk_fma_f32 v[68:69], v[250:251], v[250:251], v[68:69]
    v_pk_add_f32 v[62:63], v[62:63], v[252:253]
    v_pk_fma_f32 v[70:71], v[252:253], v[252:253], v[70:71]
    v_pk_add_f32 v[62:63], v[62:63], v[254:255]
    v_pk_fma_f32 v[70:71], v[254:255], v[254:255], v[70:71]
    v_add_f32 v24, v56, v57
    v_add_f32 v28, v64, v65
    v_add_f32 v25, v58, v59
    v_add_f32 v29, v66, v67
    v_add_f32 v26, v60, v61
    v_add_f32 v30, v68, v69
    v_add_f32 v27, v62, v63
    v_add_f32 v31, v70, v71
    ds_write_b64 v22, v[24:25] offset:20912
    ds_write_b64 v22, v[26:27] offset:20920
    ds_write_b64 v22, v[28:29] offset:21936
    ds_write_b64 v22, v[30:31] offset:21944
    s_waitcnt lgkmcnt(4)
    s_mov_b64 exec, 1
    ds_add_u32 v18, v23
    s_mov_b64 exec, -1
    s_add_u32 s53, s53, 4
Lp_8:
    ds_read_b32 v19, v18
    s_waitcnt lgkmcnt(0)
    v_readfirstlane_b32 s74, v19
    s_cmp_ge_u32 s74, s53
    s_cbranch_scc0 Lp_8
    ds_read_b128 v[24:27], v14 offset:20912
    ds_read_b128 v[28:31], v14 offset:21936
    ds_read_b128 v[56:59], v14 offset:22960
    ds_read_b128 v[60:63], v14 offset:23984
    ds_read_b128 v[64:67], v14 offset:25008
    ds_read_b128 v[68:71], v14 offset:26032
    ds_read_b128 v[72:75], v14 offset:27056
    ds_read_b128 v[76:79], v14 offset:28080
    s_waitcnt lgkmcnt(5)
    v_add_f32 v24, v24, v56
    v_add_f32_e64 v25, v25, v57
    v_add_f32 v26, v26, v58
    v_add_f32 v27, v27, v59
    s_waitcnt lgkmcnt(1)
    v_add_f32 v64, v64, v72
    v_add_f32 v65, v65, v73
    v_add_f32 v66, v66, v74
    v_add_f32 v67, v67, v75
    v_add_f32 v24, v24, v64
    v_add_f32 v25, v25, v65
    v_add_f32 v26, v26, v66
    v_add_f32 v27, v27, v67
    v_add_f32 v28, v28, v60
    v_add_f32 v29, v29, v61
    v_add_f32 v30, v30, v62
    v_add_f32 v31, v31, v63
    s_waitcnt lgkmcnt(0)
    v_add_f32 v68, v68, v76
    v_add_f32 v69, v69, v77
    v_add_f32 v70, v70, v78
    v_add_f32 v71, v71, v79
    v_add_f32 v28, v28, v68
    v_add_f32 v29, v29, v69
    v_add_f32 v30, v30, v70
    v_add_f32 v31, v31, v71
    v_mul_f32 v56, s82, v24
    v_mul_f32 v57, s82, v25
    v_mul_f32 v58, s82, v26
    v_mul_f32 v59, s82, v27
    v_mul_f32 v60, v56, v56
    v_mul_f32 v61, v57, v57
    v_mul_f32 v62, v58, v58
    v_mul_f32 v63, v59, v59
    v_fma_f32 v60, v28, s82, -v60
    v_fma_f32 v61, v29, s82, -v61
    v_fma_f32 v62, v30, s82, -v62
    v_fma_f32 v63, v31, s82, -v63
    ds_read_b128 v[24:27], v14 offset:18864
    ds_read_b128 v[28:31], v14 offset:19888
    v_max_f32 v60, 0, v60
    v_max_f32 v61, 0, v61
    v_max_f32 v62, 0, v62
    v_max_f32 v63, 0, v63
    v_add_f32 v60, s83, v60
    v_add_f32 v61, s83, v61
    v_add_f32 v62, s83, v62
    v_add_f32 v63, s83, v63
    v_rsq_f32 v60, v60
    v_rsq_f32 v61, v61
    v_rsq_f32 v62, v62
    v_rsq_f32 v63, v63
    v_mul_f32 v64, s84, v60
    v_mul_f32 v65, s84, v61
    v_mul_f32 v66, s84, v62
    v_mul_f32 v67, s84, v63
    v_mul_f32 v68, -v56, v64
    v_mul_f32 v69, -v57, v65
    v_mul_f32 v70, -v58, v66
    v_mul_f32 v71, -v59, v67
    v_pk_fma_f32 v[160:161], v[160:161], v[64:65], v[68:69] op_sel:[0,0,0] op_sel_hi:[1,0,0]
    v_pk_fma_f32 v[162:163], v[162:163], v[64:65], v[68:69] op_sel:[0,0,0] op_sel_hi:[1,0,0]
    v_pk_fma_f32 v[164:165], v[164:165], v[64:65], v[68:69] op_sel:[0,1,1] op_sel_hi:[1,1,1]
    v_pk_fma_f32 v[166:167], v[166:167], v[64:65], v[68:69] op_sel:[0,1,1] op_sel_hi:[1,1,1]
    v_pk_fma_f32 v[168:169], v[168:169], v[66:67], v[70:71] op_sel:[0,0,0] op_sel_hi:[1,0,0]
    v_pk_fma_f32 v[170:171], v[170:171], v[66:67], v[70:71] op_sel:[0,0,0] op_sel_hi:[1,0,0]
    v_pk_fma_f32 v[172:173], v[172:173], v[66:67], v[70:71] op_sel:[0,1,1] op_sel_hi:[1,1,1]
    v_pk_fma_f32 v[174:175], v[174:175], v[66:67], v[70:71] op_sel:[0,1,1] op_sel_hi:[1,1,1]
    v_pk_fma_f32 v[176:177], v[176:177], v[64:65], v[68:69] op_sel:[0,0,0] op_sel_hi:[1,0,0]
    v_pk_fma_f32 v[178:179], v[178:179], v[64:65], v[68:69] op_sel:[0,0,0] op_sel_hi:[1,0,0]
    v_pk_fma_f32 v[180:181], v[180:181], v[64:65], v[68:69] op_sel:[0,1,1] op_sel_hi:[1,1,1]
    v_pk_fma_f32 v[182:183], v[182:183], v[64:65], v[68:69] op_sel:[0,1,1] op_sel_hi:[1,1,1]
    v_pk_fma_f32 v[184:185], v[184:185], v[66:67], v[70:71] op_sel:[0,0,0] op_sel_hi:[1,0,0]
    v_pk_fma_f32 v[186:187], v[186:187], v[66:67], v[70:71] op_sel:[0,0,0] op_sel_hi:[1,0,0]
    v_pk_fma_f32 v[188:189], v[188:189], v[66:67], v[70:71] op_sel:[0,1,1] op_sel_hi:[1,1,1]
    v_pk_fma_f32 v[190:191], v[190:191], v[66:67], v[70:71] op_sel:[0,1,1] op_sel_hi:[1,1,1]
    v_pk_fma_f32 v[192:193], v[192:193], v[64:65], v[68:69] op_sel:[0,0,0] op_sel_hi:[1,0,0]
    v_pk_fma_f32 v[194:195], v[194:195], v[64:65], v[68:69] op_sel:[0,0,0] op_sel_hi:[1,0,0]
    v_pk_fma_f32 v[196:197], v[196:197], v[64:65], v[68:69] op_sel:[0,1,1] op_sel_hi:[1,1,1]
    v_pk_fma_f32 v[198:199], v[198:199], v[64:65], v[68:69] op_sel:[0,1,1] op_sel_hi:[1,1,1]
    v_pk_fma_f32 v[200:201], v[200:201], v[66:67], v[70:71] op_sel:[0,0,0] op_sel_hi:[1,0,0]
    v_pk_fma_f32 v[202:203], v[202:203], v[66:67], v[70:71] op_sel:[0,0,0] op_sel_hi:[1,0,0]
    v_pk_fma_f32 v[204:205], v[204:205], v[66:67], v[70:71] op_sel:[0,1,1] op_sel_hi:[1,1,1]
    v_pk_fma_f32 v[206:207], v[206:207], v[66:67], v[70:71] op_sel:[0,1,1] op_sel_hi:[1,1,1]
    v_pk_fma_f32 v[208:209], v[208:209], v[64:65], v[68:69] op_sel:[0,0,0] op_sel_hi:[1,0,0]
    v_pk_fma_f32 v[210:211], v[210:211], v[64:65], v[68:69] op_sel:[0,0,0] op_sel_hi:[1,0,0]
    v_pk_fma_f32 v[212:213], v[212:213], v[64:65], v[68:69] op_sel:[0,1,1] op_sel_hi:[1,1,1]
    v_pk_fma_f32 v[214:215], v[214:215], v[64:65], v[68:69] op_sel:[0,1,1] op_sel_hi:[1,1,1]
    v_pk_fma_f32 v[216:217], v[216:217], v[66:67], v[70:71] op_sel:[0,0,0] op_sel_hi:[1,0,0]
    v_pk_fma_f32 v[218:219], v[218:219], v[66:67], v[70:71] op_sel:[0,0,0] op_sel_hi:[1,0,0]
    v_pk_fma_f32 v[220:221], v[220:221], v[66:67], v[70:71] op_sel:[0,1,1] op_sel_hi:[1,1,1]
    v_pk_fma_f32 v[222:223], v[222:223], v[66:67], v[70:71] op_sel:[0,1,1] op_sel_hi:[1,1,1]
    v_pk_fma_f32 v[224:225], v[224:225], v[64:65], v[68:69] op_sel:[0,0,0] op_sel_hi:[1,0,0]
    v_pk_fma_f32 v[226:227], v[226:227], v[64:65], v[68:69] op_sel:[0,0,0] op_sel_hi:[1,0,0]
    v_pk_fma_f32 v[228:229], v[228:229], v[64:65], v[68:69] op_sel:[0,1,1] op_sel_hi:[1,1,1]
    v_pk_fma_f32 v[230:231], v[230:231], v[64:65], v[68:69] op_sel:[0,1,1] op_sel_hi:[1,1,1]
    v_pk_fma_f32 v[232:233], v[232:233], v[66:67], v[70:71] op_sel:[0,0,0] op_sel_hi:[1,0,0]
    v_pk_fma_f32 v[234:235], v[234:235], v[66:67], v[70:71] op_sel:[0,0,0] op_sel_hi:[1,0,0]
    v_pk_fma_f32 v[236:237], v[236:237], v[66:67], v[70:71] op_sel:[0,1,1] op_sel_hi:[1,1,1]
    v_pk_fma_f32 v[238:239], v[238:239], v[66:67], v[70:71] op_sel:[0,1,1] op_sel_hi:[1,1,1]
    v_pk_fma_f32 v[240:241], v[240:241], v[64:65], v[68:69] op_sel:[0,0,0] op_sel_hi:[1,0,0]
    v_pk_fma_f32 v[242:243], v[242:243], v[64:65], v[68:69] op_sel:[0,0,0] op_sel_hi:[1,0,0]
    v_pk_fma_f32 v[244:245], v[244:245], v[64:65], v[68:69] op_sel:[0,1,1] op_sel_hi:[1,1,1]
    v_pk_fma_f32 v[246:247], v[246:247], v[64:65], v[68:69] op_sel:[0,1,1] op_sel_hi:[1,1,1]
    v_pk_fma_f32 v[248:249], v[248:249], v[66:67], v[70:71] op_sel:[0,0,0] op_sel_hi:[1,0,0]
    v_pk_fma_f32 v[250:251], v[250:251], v[66:67], v[70:71] op_sel:[0,0,0] op_sel_hi:[1,0,0]
    v_pk_fma_f32 v[252:253], v[252:253], v[66:67], v[70:71] op_sel:[0,1,1] op_sel_hi:[1,1,1]
    v_pk_fma_f32 v[254:255], v[254:255], v[66:67], v[70:71] op_sel:[0,1,1] op_sel_hi:[1,1,1]
    v_cvt_pk_bf16_f32 v112, v160, v161
    v_cvt_pk_bf16_f32 v113, v162, v163
    ds_write_b64 v110, v[112:113] offset:0
    v_cvt_pk_bf16_f32 v124, v164, v165
    v_cvt_pk_bf16_f32 v125, v166, v167
    ds_write_b64 v110, v[124:125] offset:192
    v_cvt_pk_bf16_f32 v136, v168, v169
    v_cvt_pk_bf16_f32 v137, v170, v171
    ds_write_b64 v110, v[136:137] offset:384
    v_cvt_pk_bf16_f32 v148, v172, v173
    v_cvt_pk_bf16_f32 v149, v174, v175
    ds_write_b64 v110, v[148:149] offset:576
    v_cvt_pk_bf16_f32 v114, v176, v177
    s_waitcnt lgkmcnt(4)
    s_nop 0
    v_mfma_f32_32x32x16_bf16 v[160:175], v[24:27], v[32:35], 0
    v_cvt_pk_bf16_f32 v115, v178, v179
    ds_write_b64 v110, v[114:115] offset:8
    v_cvt_pk_bf16_f32 v126, v180, v181
    v_cvt_pk_bf16_f32 v127, v182, v183
    ds_write_b64 v110, v[126:127] offset:200
    v_mfma_f32_32x32x16_bf16 v[160:175], v[28:31], v[36:39], v[160:175]
    v_cvt_pk_bf16_f32 v138, v184, v185
    v_cvt_pk_bf16_f32 v139, v186, v187
    ds_write_b64 v110, v[138:139] offset:392
    v_cvt_pk_bf16_f32 v150, v188, v189
    v_cvt_pk_bf16_f32 v151, v190, v191
    ds_write_b64 v110, v[150:151] offset:584
    v_cvt_pk_bf16_f32 v116, v192, v193
    v_mfma_f32_32x32x16_bf16 v[176:191], v[24:27], v[40:43], 0
    v_cvt_pk_bf16_f32 v117, v194, v195
    ds_write_b64 v110, v[116:117] offset:16
    v_cvt_pk_bf16_f32 v128, v196, v197
    v_cvt_pk_bf16_f32 v129, v198, v199
    ds_write_b64 v110, v[128:129] offset:208
    v_mfma_f32_32x32x16_bf16 v[176:191], v[28:31], v[44:47], v[176:191]
    v_cvt_pk_bf16_f32 v140, v200, v201
    v_cvt_pk_bf16_f32 v141, v202, v203
    ds_write_b64 v110, v[140:141] offset:400
    v_cvt_pk_bf16_f32 v152, v204, v205
    v_cvt_pk_bf16_f32 v153, v206, v207
    ds_write_b64 v110, v[152:153] offset:592
    v_cvt_pk_bf16_f32 v118, v208, v209
    v_mfma_f32_32x32x16_bf16 v[192:207], v[24:27], v[48:51], 0
    v_cvt_pk_bf16_f32 v119, v210, v211
    ds_write_b64 v110, v[118:119] offset:24
    v_cvt_pk_bf16_f32 v130, v212, v213
    v_cvt_pk_bf16_f32 v131, v214, v215
    ds_write_b64 v110, v[130:131] offset:216
    v_mfma_f32_32x32x16_bf16 v[192:207], v[28:31], v[52:55], v[192:207]
    v_cvt_pk_bf16_f32 v142, v216, v217
    v_cvt_pk_bf16_f32 v143, v218, v219
    ds_write_b64 v110, v[142:143] offset:408
    v_cvt_pk_bf16_f32 v154, v220, v221
    v_cvt_pk_bf16_f32 v155, v222, v223
    s_waitcnt lgkmcnt(8)
    s_nop 0
    ds_write_b64 v110, v[154:155] offset:600
    v_cvt_pk_bf16_f32 v120, v224, v225
    v_mfma_f32_32x32x16_bf16 v[208:223], v[24:27], v[92:95], 0
    v_cvt_pk_bf16_f32 v121, v226, v227
    ds_write_b64 v110, v[120:121] offset:32
    v_cvt_pk_bf16_f32 v132, v228, v229
    v_cvt_pk_bf16_f32 v133, v230, v231
    ds_write_b64 v110, v[132:133] offset:224
    v_mfma_f32_32x32x16_bf16 v[208:223], v[28:31], v[96:99], v[208:223]
    v_cvt_pk_bf16_f32 v144, v232, v233
    v_cvt_pk_bf16_f32 v145, v234, v235
    ds_write_b64 v110, v[144:145] offset:416
    v_cvt_pk_bf16_f32 v156, v236, v237
    v_cvt_pk_bf16_f32 v157, v238, v239
    ds_write_b64 v110, v[156:157] offset:608
    v_cvt_pk_bf16_f32 v122, v240, v241
    v_mfma_f32_32x32x16_bf16 v[224:239], v[24:27], v[100:103], 0
    v_cvt_pk_bf16_f32 v123, v242, v243
    ds_write_b64 v110, v[122:123] offset:40
    v_cvt_pk_bf16_f32 v134, v244, v245
    v_cvt_pk_bf16_f32 v135, v246, v247
    ds_write_b64 v110, v[134:135] offset:232
    v_mfma_f32_32x32x16_bf16 v[224:239], v[28:31], v[80:83], v[224:239]
    v_cvt_pk_bf16_f32 v146, v248, v249
    v_cvt_pk_bf16_f32 v147, v250, v251
    s_waitcnt lgkmcnt(8)
    s_nop 0
    ds_write_b64 v110, v[146:147] offset:424
    v_cvt_pk_bf16_f32 v158, v252, v253
    v_cvt_pk_bf16_f32 v159, v254, v255
    ds_write_b64 v110, v[158:159] offset:616
    s_mov_b64 exec, 1
    s_nop 0
    ds_add_u32 v18, v23
    s_mov_b64 exec, -1
    s_add_u32 s53, s53, 4
    v_mfma_f32_32x32x16_bf16 v[240:255], v[24:27], v[84:87], 0
    v_mfma_f32_32x32x16_bf16 v[240:255], v[28:31], v[88:91], v[240:255]
    s_cmp_lg_u32 s65, 0
    s_cbranch_scc1 Lw1wait
Lw1wait_retR:
    v_add_u32_e64 v9, s41, v7
    ds_read_b64_tr_b16 v[56:57], v9 offset:12288
    ds_read_b64_tr_b16 v[58:59], v9 offset:12544
    ds_read_b64_tr_b16 v[60:61], v9 offset:13312
    ds_read_b64_tr_b16 v[62:63], v9 offset:13568
    s_waitcnt lgkmcnt(8)
    s_nop 0
    ds_read_b64_tr_b16 v[64:65], v9 offset:14336
    ds_read_b64_tr_b16 v[66:67], v9 offset:14592
    ds_read_b64_tr_b16 v[68:69], v9 offset:15360
    ds_read_b64_tr_b16 v[70:71], v9 offset:15616
    ds_read_b64_tr_b16 v[72:73], v9 offset:16384
    ds_read_b64_tr_b16 v[74:75], v9 offset:16640
    ds_read_b64_tr_b16 v[76:77], v9 offset:17408
    s_waitcnt lgkmcnt(8)
    s_nop 0
    ds_read_b64_tr_b16 v[78:79], v9 offset:17664
    v_mov_b32 v28, 0
    v_mov_b32 v29, 0
    v_mov_b32 v30, 0
    v_mov_b32 v31, 0
Lp_9:
    ds_read_b32 v19, v18
    s_waitcnt lgkmcnt(0)
    v_readfirstlane_b32 s74, v19
    s_cmp_ge_u32 s74, s53
    s_cbranch_scc0 Lp_9
    ds_read_b128 v[112:115], v111 offset:0
    ds_read_b128 v[120:123], v111 offset:32
    ds_read_b128 v[128:131], v111 offset:64
    ds_read_b128 v[136:139], v111 offset:96
    ds_read_b128 v[144:147], v111 offset:128
    ds_read_b128 v[152:155], v111 offset:160
    ds_read_b128 v[116:119], v111 offset:7104
    ds_read_b128 v[124:127], v111 offset:7136
    ds_read_b128 v[132:135], v111 offset:7168
    ds_read_b128 v[140:143], v111 offset:7200
    ds_read_b128 v[148:151], v111 offset:7232
    ds_read_b128 v[156:159], v111 offset:7264
    s_waitcnt lgkmcnt(11)
    s_nop 0
    v_mfma_f32_32x32x16_bf16 v[80:95], v[56:59], v[112:115], 0
    s_waitcnt lgkmcnt(10)
    s_nop 0
    v_mfma_f32_32x32x16_bf16 v[80:95], v[60:63], v[120:123], v[80:95]
    s_waitcnt lgkmcnt(9)
    s_nop 0
    v_mfma_f32_32x32x16_bf16 v[80:95], v[64:67], v[128:131], v[80:95]
    s_waitcnt lgkmcnt(8)
    s_nop 0
    v_mfma_f32_32x32x16_bf16 v[80:95], v[68:71], v[136:139], v[80:95]
    s_waitcnt lgkmcnt(7)
    s_nop 0
    v_mfma_f32_32x32x16_bf16 v[80:95], v[72:75], v[144:147], v[80:95]
    s_waitcnt lgkmcnt(6)
    s_nop 0
    v_mfma_f32_32x32x16_bf16 v[80:95], v[76:79], v[152:155], v[80:95]
    s_waitcnt lgkmcnt(0)
    s_setprio 0
    s_nop 6
    s_sub_u32 s67, s36, s47
    s_max_i32 s67, s67, 0
    s_mov_b32 s48, 9
    s_or_b32 s71, s36, s65
    s_cbranch_scc0 LloopXR
    s_sub_u32 s48, 6, s47
    s_cmp_lg_u32 s65, 0
    s_cselect_b32 s48, 2, s48
    s_branch LloopNR
.p2align 6
LloopXR:
    s_waitcnt vmcnt(0)
Lnowait1R:
    s_barrier
    s_sub_u32 s41, 82816, s41
Lbody1R:
    v_add_u32_e64 v9, s41, v7
    v_add_u32 v10, s41, v8
    s_setprio 3
    v_cvt_pk_f16_f32 v18, v80, v81
    v_cvt_pk_f16_f32 v21, v82, v83
    v_mfma_f32_32x32x16_bf16 v[208:223], v[44:47], v[28:31], v[208:223]
    ds_read_b64_tr_b16 v[44:45], v10 offset:9216
    ds_read_b64_tr_b16 v[46:47], v10 offset:10752
    v_pk_fma_f16 v19, v18, v18, s49
    v_pk_fma_f16 v22, v21, v21, s49
    v_pk_mul_f16 v18, v18, v19
    v_pk_mul_f16 v21, v21, v22
    v_exp_f16 v19, v18
    v_exp_f16 v22, v21
    v_exp_f16_sdwa v19, v18 dst_sel:WORD_1 dst_unused:UNUSED_PRESERVE src0_sel:WORD_1
    v_mfma_f32_32x32x16_bf16 v[96:111], v[56:59], v[116:119], 0
    ds_read_b64_tr_b16 v[32:33], v10 offset:6144
    ds_read_b64_tr_b16 v[34:35], v10 offset:7680
    ds_read_b64_tr_b16 v[56:57], v9 offset:0
    ds_read_b64_tr_b16 v[58:59], v9 offset:256
    v_exp_f16_sdwa v22, v21 dst_sel:WORD_1 dst_unused:UNUSED_PRESERVE src0_sel:WORD_1
    v_pk_fma_f16 v18, v19, s50, s50
    v_pk_fma_f16 v21, v22, s50, s50
    v_rcp_f16 v19, v18
    v_rcp_f16 v22, v21
    v_rcp_f16_sdwa v20, v18 dst_sel:DWORD dst_unused:UNUSED_PAD src0_sel:WORD_1
    v_mfma_f32_32x32x16_bf16 v[224:239], v[48:51], v[28:31], v[224:239]
    ds_read_b64_tr_b16 v[36:37], v10 offset:6208
    ds_read_b64_tr_b16 v[38:39], v10 offset:7744
    ds_read_b64_tr_b16 v[48:49], v10 offset:9280
    ds_read_b64_tr_b16 v[50:51], v10 offset:10816
    v_rcp_f16_sdwa v23, v21 dst_sel:DWORD dst_unused:UNUSED_PAD src0_sel:WORD_1
    v_fma_mix_f32 v19, v80, v19, 0 op_sel_hi:[0,1,0]
    v_fma_mix_f32 v22, v82, v22, 0 op_sel_hi:[0,1,0]
    v_fma_mix_f32 v20, v81, v20, 0 op_sel_hi:[0,1,0]
    v_fma_mix_f32 v23, v83, v23, 0 op_sel_hi:[0,1,0]
    v_cvt_pk_bf16_f32 v24, v19, v20
    v_cvt_pk_bf16_f32 v25, v22, v23
    v_cvt_pk_f16_f32 v18, v84, v85
    v_cvt_pk_f16_f32 v21, v86, v87
    v_mfma_f32_32x32x16_bf16 v[96:111], v[60:63], v[124:127], v[96:111]
    ds_read_b64_tr_b16 v[40:41], v10 offset:6272
    ds_read_b64_tr_b16 v[42:43], v10 offset:7808
    ds_read_b64_tr_b16 v[60:61], v9 offset:1024
    ds_read_b64_tr_b16 v[62:63], v9 offset:1280
    v_pk_fma_f16 v19, v18, v18, s49
    v_pk_fma_f16 v22, v21, v21, s49
    v_pk_mul_f16 v18, v18, v19
    v_pk_mul_f16 v21, v21, v22
    v_exp_f16 v19, v18
    v_exp_f16 v22, v21
    v_exp_f16_sdwa v19, v18 dst_sel:WORD_1 dst_unused:UNUSED_PRESERVE src0_sel:WORD_1
    v_mfma_f32_32x32x16_bf16 v[240:255], v[52:55], v[28:31], v[240:255]
    ds_read_b64_tr_b16 v[52:53], v10 offset:9344
    s_waitcnt lgkmcnt(8)
    s_nop 0
    ds_read_b64_tr_b16 v[54:55], v10 offset:10880
    v_exp_f16_sdwa v22, v21 dst_sel:WORD_1 dst_unused:UNUSED_PRESERVE src0_sel:WORD_1
    v_pk_fma_f16 v18, v19, s50, s50
    v_pk_fma_f16 v21, v22, s50, s50
    v_rcp_f16 v19, v18
    v_rcp_f16 v22, v21
    v_rcp_f16_sdwa v20, v18 dst_sel:DWORD dst_unused:UNUSED_PAD src0_sel:WORD_1
    v_mfma_f32_32x32x16_bf16 v[96:111], v[64:67], v[132:135], v[96:111]
    ds_read_b64_tr_b16 v[64:65], v9 offset:2048
    ds_read_b64_tr_b16 v[66:67], v9 offset:2304
    v_rcp_f16_sdwa v23, v21 dst_sel:DWORD dst_unused:UNUSED_PAD src0_sel:WORD_1
    v_fma_mix_f32 v19, v84, v19, 0 op_sel_hi:[0,1,0]
    v_fma_mix_f32 v22, v86, v22, 0 op_sel_hi:[0,1,0]
    v_fma_mix_f32 v20, v85, v20, 0 op_sel_hi:[0,1,0]
    v_fma_mix_f32 v23, v87, v23, 0 op_sel_hi:[0,1,0]
    v_cvt_pk_bf16_f32 v26, v19, v20
    v_cvt_pk_bf16_f32 v27, v22, v23
    v_cvt_pk_f16_f32 v18, v88, v89
    v_mfma_f32_32x32x16_bf16 v[96:111], v[68:71], v[140:143], v[96:111]
    ds_read_b64_tr_b16 v[68:69], v9 offset:3072
    ds_read_b64_tr_b16 v[70:71], v9 offset:3328
    v_cvt_pk_f16_f32 v21, v90, v91
    v_pk_fma_f16 v19, v18, v18, s49
    v_pk_fma_f16 v22, v21, v21, s49
    v_pk_mul_f16 v18, v18, v19
    v_pk_mul_f16 v21, v21, v22
    v_exp_f16 v19, v18
    v_exp_f16 v22, v21
    v_exp_f16_sdwa v19, v18 dst_sel:WORD_1 dst_unused:UNUSED_PRESERVE src0_sel:WORD_1
    v_mfma_f32_32x32x16_bf16 v[160:175], v[32:35], v[24:27], v[160:175]
    s_sub_u32 s78, 82816, s41
    s_add_u32 m0, s78, s88
    s_add_u32 s79, s42, s46
    buffer_load_dwordx4 v11, s[24:27], s79 offen sc1 lds
    v_exp_f16_sdwa v22, v21 dst_sel:WORD_1 dst_unused:UNUSED_PRESERVE src0_sel:WORD_1
    v_pk_fma_f16 v18, v19, s50, s50
    v_pk_fma_f16 v21, v22, s50, s50
    v_rcp_f16 v19, v18
    v_rcp_f16 v22, v21
    v_rcp_f16_sdwa v20, v18 dst_sel:DWORD dst_unused:UNUSED_PAD src0_sel:WORD_1
    v_mfma_f32_32x32x16_bf16 v[96:111], v[72:75], v[148:151], v[96:111]
    ds_read_b64_tr_b16 v[72:73], v9 offset:4096
    ds_read_b64_tr_b16 v[74:75], v9 offset:4352
    v_rcp_f16_sdwa v23, v21 dst_sel:DWORD dst_unused:UNUSED_PAD src0_sel:WORD_1
    v_fma_mix_f32 v19, v88, v19, 0 op_sel_hi:[0,1,0]
    v_fma_mix_f32 v22, v90, v22, 0 op_sel_hi:[0,1,0]
    v_fma_mix_f32 v20, v89, v20, 0 op_sel_hi:[0,1,0]
    v_fma_mix_f32 v23, v91, v23, 0 op_sel_hi:[0,1,0]
    v_cvt_pk_bf16_f32 v28, v19, v20
    v_cvt_pk_bf16_f32 v29, v22, v23
    v_cvt_pk_f16_f32 v18, v92, v93
    s_waitcnt lgkmcnt(5)
    s_nop 0
    v_mfma_f32_32x32x16_bf16 v[176:191], v[36:39], v[24:27], v[176:191]
    s_add_u32 m0, m0, s89
    s_add_u32 s79, s79, s45
    buffer_load_dwordx4 v11, s[24:27], s79 offen sc1 lds
    v_cvt_pk_f16_f32 v21, v94, v95
    v_pk_fma_f16 v19, v18, v18, s49
    v_pk_fma_f16 v22, v21, v21, s49
    v_pk_mul_f16 v18, v18, v19
    v_pk_mul_f16 v21, v21, v22
    v_exp_f16 v19, v18
    v_exp_f16 v22, v21
    v_exp_f16_sdwa v19, v18 dst_sel:WORD_1 dst_unused:UNUSED_PRESERVE src0_sel:WORD_1
    v_mfma_f32_32x32x16_bf16 v[96:111], v[76:79], v[156:159], v[96:111]
    ds_read_b64_tr_b16 v[76:77], v9 offset:5120
    ds_read_b64_tr_b16 v[78:79], v9 offset:5376
    v_exp_f16_sdwa v22, v21 dst_sel:WORD_1 dst_unused:UNUSED_PRESERVE src0_sel:WORD_1
    v_pk_fma_f16 v18, v19, s50, s50
    v_pk_fma_f16 v21, v22, s50, s50
    v_rcp_f16 v19, v18
    v_rcp_f16 v22, v21
    v_rcp_f16_sdwa v20, v18 dst_sel:DWORD dst_unused:UNUSED_PAD src0_sel:WORD_1
    v_mfma_f32_32x32x16_bf16 v[192:207], v[40:43], v[24:27], v[192:207]
    s_add_u32 m0, m0, s89
    s_add_u32 s79, s79, s45
    buffer_load_dwordx4 v11, s[24:27], s79 offen sc1 lds
    s_add_u32 s42, s42, s43
    s_cmp_eq_u32 s42, s44
    s_cselect_b32 s42, 0, s42
    s_nop 0
    v_rcp_f16_sdwa v23, v21 dst_sel:DWORD dst_unused:UNUSED_PAD src0_sel:WORD_1
    v_fma_mix_f32 v19, v92, v19, 0 op_sel_hi:[0,1,0]
    v_fma_mix_f32 v22, v94, v22, 0 op_sel_hi:[0,1,0]
    v_fma_mix_f32 v20, v93, v20, 0 op_sel_hi:[0,1,0]
    v_fma_mix_f32 v23, v95, v23, 0 op_sel_hi:[0,1,0]
    v_cvt_pk_bf16_f32 v30, v19, v20
    v_cvt_pk_bf16_f32 v31, v22, v23
    s_setprio 2
    s_nop 0
    v_cvt_pk_f16_f32 v18, v96, v97
    v_cvt_pk_f16_f32 v21, v98, v99
    v_mfma_f32_32x32x16_bf16 v[160:175], v[44:47], v[28:31], v[160:175]
    v_pk_fma_f16 v19, v18, v18, s49
    v_pk_fma_f16 v22, v21, v21, s49
    v_pk_mul_f16 v18, v18, v19
    v_pk_mul_f16 v21, v21, v22
    v_exp_f16 v19, v18
    v_exp_f16 v22, v21
    v_exp_f16_sdwa v19, v18 dst_sel:WORD_1 dst_unused:UNUSED_PRESERVE src0_sel:WORD_1
    v_mfma_f32_32x32x16_bf16 v[80:95], v[56:59], v[112:115], 0
    s_add_u32 s78, s78, 12288
    s_add_u32 m0, s78, s88
    s_add_u32 s79, s42, s46
    buffer_load_dwordx4 v11, s[24:27], s79 offen sc1 lds
    v_exp_f16_sdwa v22, v21 dst_sel:WORD_1 dst_unused:UNUSED_PRESERVE src0_sel:WORD_1
    v_pk_fma_f16 v18, v19, s50, s50
    v_pk_fma_f16 v21, v22, s50, s50
    v_rcp_f16 v19, v18
    v_rcp_f16 v22, v21
    v_rcp_f16_sdwa v20, v18 dst_sel:DWORD dst_unused:UNUSED_PAD src0_sel:WORD_1
    v_mfma_f32_32x32x16_bf16 v[176:191], v[48:51], v[28:31], v[176:191]
    v_rcp_f16_sdwa v23, v21 dst_sel:DWORD dst_unused:UNUSED_PAD src0_sel:WORD_1
    v_fma_mix_f32 v19, v96, v19, 0 op_sel_hi:[0,1,0]
    v_fma_mix_f32 v22, v98, v22, 0 op_sel_hi:[0,1,0]
    v_fma_mix_f32 v20, v97, v20, 0 op_sel_hi:[0,1,0]
    v_fma_mix_f32 v23, v99, v23, 0 op_sel_hi:[0,1,0]
    v_cvt_pk_bf16_f32 v24, v19, v20
    v_cvt_pk_bf16_f32 v25, v22, v23
    v_cvt_pk_f16_f32 v18, v100, v101
    v_cvt_pk_f16_f32 v21, v102, v103
    v_mfma_f32_32x32x16_bf16 v[80:95], v[60:63], v[120:123], v[80:95]
    s_add_u32 m0, m0, s89
    s_add_u32 s79, s79, s45
    buffer_load_dwordx4 v11, s[24:27], s79 offen sc1 lds
    v_pk_fma_f16 v19, v18, v18, s49
    v_pk_fma_f16 v22, v21, v21, s49
    v_pk_mul_f16 v18, v18, v19
    v_pk_mul_f16 v21, v21, v22
    v_exp_f16 v19, v18
    v_exp_f16 v22, v21
    v_exp_f16_sdwa v19, v18 dst_sel:WORD_1 dst_unused:UNUSED_PRESERVE src0_sel:WORD_1
    v_mfma_f32_32x32x16_bf16 v[192:207], v[52:55], v[28:31], v[192:207]
    v_exp_f16_sdwa v22, v21 dst_sel:WORD_1 dst_unused:UNUSED_PRESERVE src0_sel:WORD_1
    v_pk_fma_f16 v18, v19, s50, s50
    v_pk_fma_f16 v21, v22, s50, s50
    v_rcp_f16 v19, v18
    v_rcp_f16 v22, v21
    v_rcp_f16_sdwa v20, v18 dst_sel:DWORD dst_unused:UNUSED_PAD src0_sel:WORD_1
    s_waitcnt lgkmcnt(0)
    s_nop 0
    v_mfma_f32_32x32x16_bf16 v[80:95], v[64:67], v[128:131], v[80:95]
    s_add_u32 m0, m0, s89
    s_add_u32 s79, s79, s45
    buffer_load_dwordx4 v11, s[24:27], s79 offen sc1 lds
    s_add_u32 s42, s42, s43
    s_cmp_eq_u32 s42, s44
    s_cselect_b32 s42, 0, s42
    s_nop 0
    v_rcp_f16_sdwa v23, v21 dst_sel:DWORD dst_unused:UNUSED_PAD src0_sel:WORD_1
    v_fma_mix_f32 v19, v100, v19, 0 op_sel_hi:[0,1,0]
    v_fma_mix_f32 v22, v102, v22, 0 op_sel_hi:[0,1,0]
    v_fma_mix_f32 v20, v101, v20, 0 op_sel_hi:[0,1,0]
    v_fma_mix_f32 v23, v103, v23, 0 op_sel_hi:[0,1,0]
    v_cvt_pk_bf16_f32 v26, v19, v20
    v_cvt_pk_bf16_f32 v27, v22, v23
    v_cvt_pk_f16_f32 v18, v104, v105
    v_mfma_f32_32x32x16_bf16 v[80:95], v[68:71], v[136:139], v[80:95]
    v_cvt_pk_f16_f32 v21, v106, v107
    v_pk_fma_f16 v19, v18, v18, s49
    v_pk_fma_f16 v22, v21, v21, s49
    v_pk_mul_f16 v18, v18, v19
    v_pk_mul_f16 v21, v21, v22
    v_exp_f16 v19, v18
    v_exp_f16 v22, v21
    v_exp_f16_sdwa v19, v18 dst_sel:WORD_1 dst_unused:UNUSED_PRESERVE src0_sel:WORD_1
    v_mfma_f32_32x32x16_bf16 v[208:223], v[32:35], v[24:27], v[208:223]
    v_exp_f16_sdwa v22, v21 dst_sel:WORD_1 dst_unused:UNUSED_PRESERVE src0_sel:WORD_1
    v_pk_fma_f16 v18, v19, s50, s50
    v_pk_fma_f16 v21, v22, s50, s50
    v_rcp_f16 v19, v18
    v_rcp_f16 v22, v21
    v_rcp_f16_sdwa v20, v18 dst_sel:DWORD dst_unused:UNUSED_PAD src0_sel:WORD_1
    v_mfma_f32_32x32x16_bf16 v[80:95], v[72:75], v[144:147], v[80:95]
    s_lshl_b32 s71, s39, 5
    s_add_u32 s71, s71, s64
    s_sub_u32 s71, s71, 2
    s_nop 0
    s_mul_i32 s85, s71, 98304
    s_mul_i32 s72, s38, 6144
    s_add_u32 s85, s85, s72
    s_nop 0
    s_cmp_lt_u32 s71, 512
    s_cselect_b32 s85, s85, 0x80000000
    s_cmp_ge_u32 s64, 24
    s_cselect_b32 s72, 24, 0
    s_sub_u32 s71, s64, s72
    s_cmp_ge_u32 s71, 12
    s_cselect_b32 s72, 12, 0
    s_sub_u32 s71, s71, s72
    s_and_b32 s72, s64, 4
    s_lshl_b32 s72, s72, 1
    s_mul_i32 s71, s71, 7104
    s_add_u32 s71, s71, s72
    s_nop 0
    s_add_u32 s86, s71, 78272
    s_mov_b64 exec, s[80:81]
    s_mov_b32 m0, s86
    s_sub_u32 s71, s85, s70
    s_nop 0
    buffer_load_dwordx4 v12, s[16:19], s71 offen nt lds
    s_add_u32 m0, s86, 784
    s_add_u32 s71, s85, 384
    buffer_load_dwordx4 v14, s[16:19], s71 offen nt lds
    s_add_u32 m0, s86, 1568
    s_add_u32 s71, s85, 1152
    buffer_load_dwordx4 v14, s[16:19], s71 offen nt lds
    s_mov_b64 exec, -1
    s_nop 0
    v_rcp_f16_sdwa v23, v21 dst_sel:DWORD dst_unused:UNUSED_PAD src0_sel:WORD_1
    v_fma_mix_f32 v19, v104, v19, 0 op_sel_hi:[0,1,0]
    v_fma_mix_f32 v22, v106, v22, 0 op_sel_hi:[0,1,0]
    v_fma_mix_f32 v20, v105, v20, 0 op_sel_hi:[0,1,0]
    v_fma_mix_f32 v23, v107, v23, 0 op_sel_hi:[0,1,0]
    v_cvt_pk_bf16_f32 v28, v19, v20
    v_cvt_pk_bf16_f32 v29, v22, v23
    v_cvt_pk_f16_f32 v18, v108, v109
    v_mfma_f32_32x32x16_bf16 v[224:239], v[36:39], v[24:27], v[224:239]
    v_cvt_pk_f16_f32 v21, v110, v111
    v_pk_fma_f16 v19, v18, v18, s49
    v_pk_fma_f16 v22, v21, v21, s49
    v_pk_mul_f16 v18, v18, v19
    v_pk_mul_f16 v21, v21, v22
    v_exp_f16 v19, v18
    v_exp_f16 v22, v21
    v_exp_f16_sdwa v19, v18 dst_sel:WORD_1 dst_unused:UNUSED_PRESERVE src0_sel:WORD_1
    v_mfma_f32_32x32x16_bf16 v[80:95], v[76:79], v[152:155], v[80:95]
    v_exp_f16_sdwa v22, v21 dst_sel:WORD_1 dst_unused:UNUSED_PRESERVE src0_sel:WORD_1
    v_pk_fma_f16 v18, v19, s50, s50
    v_pk_fma_f16 v21, v22, s50, s50
    v_rcp_f16 v19, v18
    v_rcp_f16 v22, v21
    v_rcp_f16_sdwa v20, v18 dst_sel:DWORD dst_unused:UNUSED_PAD src0_sel:WORD_1
    v_mfma_f32_32x32x16_bf16 v[240:255], v[40:43], v[24:27], v[240:255]
    s_mov_b64 exec, s[80:81]
    s_nop 0
    s_add_u32 m0, s86, 2352
    s_add_u32 s71, s85, 1920
    buffer_load_dwordx4 v14, s[16:19], s71 offen nt lds
    s_add_u32 m0, s86, 3136
    s_add_u32 s71, s85, 2688
    buffer_load_dwordx4 v14, s[16:19], s71 offen nt lds
    s_add_u32 m0, s86, 3920
    s_add_u32 s71, s85, 3456
    buffer_load_dwordx4 v14, s[16:19], s71 offen nt lds
    s_mov_b64 exec, -1
    s_nop 0
    v_rcp_f16_sdwa v23, v21 dst_sel:DWORD dst_unused:UNUSED_PAD src0_sel:WORD_1
    v_fma_mix_f32 v19, v108, v19, 0 op_sel_hi:[0,1,0]
    v_fma_mix_f32 v22, v110, v22, 0 op_sel_hi:[0,1,0]
    v_fma_mix_f32 v20, v109, v20, 0 op_sel_hi:[0,1,0]
    v_fma_mix_f32 v23, v111, v23, 0 op_sel_hi:[0,1,0]
    v_cvt_pk_bf16_f32 v30, v19, v20
    v_cvt_pk_bf16_f32 v31, v22, v23
    s_setprio 1
    s_nop 0
    v_cvt_pk_f16_f32 v18, v80, v81
    v_cvt_pk_f16_f32 v21, v82, v83
    v_mfma_f32_32x32x16_bf16 v[208:223], v[44:47], v[28:31], v[208:223]
    ds_read_b64_tr_b16 v[44:45], v10 offset:21504
    ds_read_b64_tr_b16 v[46:47], v10 offset:23040
    v_pk_fma_f16 v19, v18, v18, s49
    v_pk_fma_f16 v22, v21, v21, s49
    v_pk_mul_f16 v18, v18, v19
    v_pk_mul_f16 v21, v21, v22
    v_exp_f16 v19, v18
    v_exp_f16 v22, v21
    v_exp_f16_sdwa v19, v18 dst_sel:WORD_1 dst_unused:UNUSED_PRESERVE src0_sel:WORD_1
    v_mfma_f32_32x32x16_bf16 v[96:111], v[56:59], v[116:119], 0
    ds_read_b64_tr_b16 v[32:33], v10 offset:18432
    ds_read_b64_tr_b16 v[34:35], v10 offset:19968
    ds_read_b64_tr_b16 v[56:57], v9 offset:12288
    ds_read_b64_tr_b16 v[58:59], v9 offset:12544
    v_exp_f16_sdwa v22, v21 dst_sel:WORD_1 dst_unused:UNUSED_PRESERVE src0_sel:WORD_1
    v_pk_fma_f16 v18, v19, s50, s50
    v_pk_fma_f16 v21, v22, s50, s50
    v_rcp_f16 v19, v18
    v_rcp_f16 v22, v21
    v_rcp_f16_sdwa v20, v18 dst_sel:DWORD dst_unused:UNUSED_PAD src0_sel:WORD_1
    v_mfma_f32_32x32x16_bf16 v[224:239], v[48:51], v[28:31], v[224:239]
    ds_read_b64_tr_b16 v[36:37], v10 offset:18496
    ds_read_b64_tr_b16 v[38:39], v10 offset:20032
    ds_read_b64_tr_b16 v[48:49], v10 offset:21568
    ds_read_b64_tr_b16 v[50:51], v10 offset:23104
    v_rcp_f16_sdwa v23, v21 dst_sel:DWORD dst_unused:UNUSED_PAD src0_sel:WORD_1
    v_fma_mix_f32 v19, v80, v19, 0 op_sel_hi:[0,1,0]
    v_fma_mix_f32 v22, v82, v22, 0 op_sel_hi:[0,1,0]
    v_fma_mix_f32 v20, v81, v20, 0 op_sel_hi:[0,1,0]
    v_fma_mix_f32 v23, v83, v23, 0 op_sel_hi:[0,1,0]
    v_cvt_pk_bf16_f32 v24, v19, v20
    v_cvt_pk_bf16_f32 v25, v22, v23
    v_cvt_pk_f16_f32 v18, v84, v85
    v_cvt_pk_f16_f32 v21, v86, v87
    v_mfma_f32_32x32x16_bf16 v[96:111], v[60:63], v[124:127], v[96:111]
    ds_read_b64_tr_b16 v[40:41], v10 offset:18560
    ds_read_b64_tr_b16 v[42:43], v10 offset:20096
    ds_read_b64_tr_b16 v[60:61], v9 offset:13312
    ds_read_b64_tr_b16 v[62:63], v9 offset:13568
    v_pk_fma_f16 v19, v18, v18, s49
    v_pk_fma_f16 v22, v21, v21, s49
    v_pk_mul_f16 v18, v18, v19
    v_pk_mul_f16 v21, v21, v22
    v_exp_f16 v19, v18
    v_exp_f16 v22, v21
    v_exp_f16_sdwa v19, v18 dst_sel:WORD_1 dst_unused:UNUSED_PRESERVE src0_sel:WORD_1
    v_mfma_f32_32x32x16_bf16 v[240:255], v[52:55], v[28:31], v[240:255]
    ds_read_b64_tr_b16 v[52:53], v10 offset:21632
    s_waitcnt lgkmcnt(8)
    s_nop 0
    ds_read_b64_tr_b16 v[54:55], v10 offset:23168
    v_exp_f16_sdwa v22, v21 dst_sel:WORD_1 dst_unused:UNUSED_PRESERVE src0_sel:WORD_1
    v_pk_fma_f16 v18, v19, s50, s50
    v_pk_fma_f16 v21, v22, s50, s50
    v_rcp_f16 v19, v18
    v_rcp_f16 v22, v21
    v_rcp_f16_sdwa v20, v18 dst_sel:DWORD dst_unused:UNUSED_PAD src0_sel:WORD_1
    v_mfma_f32_32x32x16_bf16 v[96:111], v[64:67], v[132:135], v[96:111]
    ds_read_b64_tr_b16 v[64:65], v9 offset:14336
    ds_read_b64_tr_b16 v[66:67], v9 offset:14592
    v_rcp_f16_sdwa v23, v21 dst_sel:DWORD dst_unused:UNUSED_PAD src0_sel:WORD_1
    v_fma_mix_f32 v19, v84, v19, 0 op_sel_hi:[0,1,0]
    v_fma_mix_f32 v22, v86, v22, 0 op_sel_hi:[0,1,0]
    v_fma_mix_f32 v20, v85, v20, 0 op_sel_hi:[0,1,0]
    v_fma_mix_f32 v23, v87, v23, 0 op_sel_hi:[0,1,0]
    v_cvt_pk_bf16_f32 v26, v19, v20
    v_cvt_pk_bf16_f32 v27, v22, v23
    v_cvt_pk_f16_f32 v18, v88, v89
    v_mfma_f32_32x32x16_bf16 v[96:111], v[68:71], v[140:143], v[96:111]
    ds_read_b64_tr_b16 v[68:69], v9 offset:15360
    ds_read_b64_tr_b16 v[70:71], v9 offset:15616
    v_cvt_pk_f16_f32 v21, v90, v91
    v_pk_fma_f16 v19, v18, v18, s49
    v_pk_fma_f16 v22, v21, v21, s49
    v_pk_mul_f16 v18, v18, v19
    v_pk_mul_f16 v21, v21, v22
    v_exp_f16 v19, v18
    v_exp_f16 v22, v21
    v_exp_f16_sdwa v19, v18 dst_sel:WORD_1 dst_unused:UNUSED_PRESERVE src0_sel:WORD_1
    v_mfma_f32_32x32x16_bf16 v[160:175], v[32:35], v[24:27], v[160:175]
    s_mov_b64 exec, s[80:81]
    s_nop 0
    s_add_u32 m0, s86, 4704
    s_add_u32 s71, s85, 4224
    buffer_load_dwordx4 v14, s[16:19], s71 offen nt lds
    s_add_u32 m0, s86, 5488
    s_add_u32 s71, s85, 4992
    buffer_load_dwordx4 v14, s[16:19], s71 offen nt lds
    s_add_u32 m0, s86, 6272
    s_add_u32 s71, s85, 5760
    buffer_load_dwordx4 v13, s[16:19], s71 offen nt lds
    s_mov_b64 exec, -1
    s_add_u32 s64, s64, 1
    v_exp_f16_sdwa v22, v21 dst_sel:WORD_1 dst_unused:UNUSED_PRESERVE src0_sel:WORD_1
    v_pk_fma_f16 v18, v19, s50, s50
    v_pk_fma_f16 v21, v22, s50, s50
    v_rcp_f16 v19, v18
    v_rcp_f16 v22, v21
    v_rcp_f16_sdwa v20, v18 dst_sel:DWORD dst_unused:UNUSED_PAD src0_sel:WORD_1
    v_mfma_f32_32x32x16_bf16 v[96:111], v[72:75], v[148:151], v[96:111]
    ds_read_b64_tr_b16 v[72:73], v9 offset:16384
    ds_read_b64_tr_b16 v[74:75], v9 offset:16640
    v_rcp_f16_sdwa v23, v21 dst_sel:DWORD dst_unused:UNUSED_PAD src0_sel:WORD_1
    v_fma_mix_f32 v19, v88, v19, 0 op_sel_hi:[0,1,0]
    v_fma_mix_f32 v22, v90, v22, 0 op_sel_hi:[0,1,0]
    v_fma_mix_f32 v20, v89, v20, 0 op_sel_hi:[0,1,0]
    v_fma_mix_f32 v23, v91, v23, 0 op_sel_hi:[0,1,0]
    v_cvt_pk_bf16_f32 v28, v19, v20
    v_cvt_pk_bf16_f32 v29, v22, v23
    v_cvt_pk_f16_f32 v18, v92, v93
    s_waitcnt lgkmcnt(5)
    s_nop 0
    v_mfma_f32_32x32x16_bf16 v[176:191], v[36:39], v[24:27], v[176:191]
    v_cvt_pk_f16_f32 v21, v94, v95
    v_pk_fma_f16 v19, v18, v18, s49
    v_pk_fma_f16 v22, v21, v21, s49
    v_pk_mul_f16 v18, v18, v19
    v_pk_mul_f16 v21, v21, v22
    v_exp_f16 v19, v18
    v_exp_f16 v22, v21
    v_exp_f16_sdwa v19, v18 dst_sel:WORD_1 dst_unused:UNUSED_PRESERVE src0_sel:WORD_1
    v_mfma_f32_32x32x16_bf16 v[96:111], v[76:79], v[156:159], v[96:111]
    ds_read_b64_tr_b16 v[76:77], v9 offset:17408
    ds_read_b64_tr_b16 v[78:79], v9 offset:17664
    v_exp_f16_sdwa v22, v21 dst_sel:WORD_1 dst_unused:UNUSED_PRESERVE src0_sel:WORD_1
    v_pk_fma_f16 v18, v19, s50, s50
    v_pk_fma_f16 v21, v22, s50, s50
    v_rcp_f16 v19, v18
    v_rcp_f16 v22, v21
    v_rcp_f16_sdwa v20, v18 dst_sel:DWORD dst_unused:UNUSED_PAD src0_sel:WORD_1
    v_mfma_f32_32x32x16_bf16 v[192:207], v[40:43], v[24:27], v[192:207]
    s_lshl_b32 s71, s39, 5
    s_add_u32 s71, s71, s64
    s_sub_u32 s71, s71, 2
    s_nop 0
    s_mul_i32 s85, s71, 98304
    s_mul_i32 s72, s38, 6144
    s_add_u32 s85, s85, s72
    s_nop 0
    s_cmp_lt_u32 s71, 512
    s_cselect_b32 s85, s85, 0x80000000
    s_cmp_ge_u32 s64, 24
    s_cselect_b32 s72, 24, 0
    s_sub_u32 s71, s64, s72
    s_cmp_ge_u32 s71, 12
    s_cselect_b32 s72, 12, 0
    s_sub_u32 s71, s71, s72
    s_and_b32 s72, s64, 4
    s_lshl_b32 s72, s72, 1
    s_mul_i32 s71, s71, 7104
    s_add_u32 s71, s71, s72
    s_nop 0
    s_add_u32 s86, s71, 78272
    s_mov_b64 exec, s[80:81]
    s_mov_b32 m0, s86
    s_sub_u32 s71, s85, s70
    s_nop 0
    buffer_load_dwordx4 v12, s[16:19], s71 offen nt lds
    s_add_u32 m0, s86, 784
    s_add_u32 s71, s85, 384
    buffer_load_dwordx4 v14, s[16:19], s71 offen nt lds
    s_add_u32 m0, s86, 1568
    s_add_u32 s71, s85, 1152
    buffer_load_dwordx4 v14, s[16:19], s71 offen nt lds
    s_mov_b64 exec, -1
    s_nop 0
    v_rcp_f16_sdwa v23, v21 dst_sel:DWORD dst_unused:UNUSED_PAD src0_sel:WORD_1
    v_fma_mix_f32 v19, v92, v19, 0 op_sel_hi:[0,1,0]
    v_fma_mix_f32 v22, v94, v22, 0 op_sel_hi:[0,1,0]
    v_fma_mix_f32 v20, v93, v20, 0 op_sel_hi:[0,1,0]
    v_fma_mix_f32 v23, v95, v23, 0 op_sel_hi:[0,1,0]
    v_cvt_pk_bf16_f32 v30, v19, v20
    v_cvt_pk_bf16_f32 v31, v22, v23
    s_setprio 0
    s_nop 0
    v_cvt_pk_f16_f32 v18, v96, v97
    v_cvt_pk_f16_f32 v21, v98, v99
    v_mfma_f32_32x32x16_bf16 v[160:175], v[44:47], v[28:31], v[160:175]
    v_pk_fma_f16 v19, v18, v18, s49
    v_pk_fma_f16 v22, v21, v21, s49
    v_pk_mul_f16 v18, v18, v19
    v_pk_mul_f16 v21, v21, v22
    v_exp_f16 v19, v18
    v_exp_f16 v22, v21
    v_exp_f16_sdwa v19, v18 dst_sel:WORD_1 dst_unused:UNUSED_PRESERVE src0_sel:WORD_1
    v_mfma_f32_32x32x16_bf16 v[80:95], v[56:59], v[112:115], 0
    v_exp_f16_sdwa v22, v21 dst_sel:WORD_1 dst_unused:UNUSED_PRESERVE src0_sel:WORD_1
    v_pk_fma_f16 v18, v19, s50, s50
    v_pk_fma_f16 v21, v22, s50, s50
    v_rcp_f16 v19, v18
    v_rcp_f16 v22, v21
    v_rcp_f16_sdwa v20, v18 dst_sel:DWORD dst_unused:UNUSED_PAD src0_sel:WORD_1
    v_mfma_f32_32x32x16_bf16 v[176:191], v[48:51], v[28:31], v[176:191]
    v_rcp_f16_sdwa v23, v21 dst_sel:DWORD dst_unused:UNUSED_PAD src0_sel:WORD_1
    v_fma_mix_f32 v19, v96, v19, 0 op_sel_hi:[0,1,0]
    v_fma_mix_f32 v22, v98, v22, 0 op_sel_hi:[0,1,0]
    v_fma_mix_f32 v20, v97, v20, 0 op_sel_hi:[0,1,0]
    v_fma_mix_f32 v23, v99, v23, 0 op_sel_hi:[0,1,0]
    v_cvt_pk_bf16_f32 v24, v19, v20
    v_cvt_pk_bf16_f32 v25, v22, v23
    v_cvt_pk_f16_f32 v18, v100, v101
    v_cvt_pk_f16_f32 v21, v102, v103
    v_mfma_f32_32x32x16_bf16 v[80:95], v[60:63], v[120:123], v[80:95]
    s_mov_b64 exec, s[80:81]
    s_nop 0
    s_add_u32 m0, s86, 2352
    s_add_u32 s71, s85, 1920
    buffer_load_dwordx4 v14, s[16:19], s71 offen nt lds
    s_add_u32 m0, s86, 3136
    s_add_u32 s71, s85, 2688
    buffer_load_dwordx4 v14, s[16:19], s71 offen nt lds
    s_add_u32 m0, s86, 3920
    s_add_u32 s71, s85, 3456
    buffer_load_dwordx4 v14, s[16:19], s71 offen nt lds
    s_mov_b64 exec, -1
    s_nop 0
    v_pk_fma_f16 v19, v18, v18, s49
    v_pk_fma_f16 v22, v21, v21, s49
    v_pk_mul_f16 v18, v18, v19
    v_pk_mul_f16 v21, v21, v22
    v_exp_f16 v19, v18
    v_exp_f16 v22, v21
    v_exp_f16_sdwa v19, v18 dst_sel:WORD_1 dst_unused:UNUSED_PRESERVE src0_sel:WORD_1
    v_mfma_f32_32x32x16_bf16 v[192:207], v[52:55], v[28:31], v[192:207]
    v_exp_f16_sdwa v22, v21 dst_sel:WORD_1 dst_unused:UNUSED_PRESERVE src0_sel:WORD_1
    v_pk_fma_f16 v18, v19, s50, s50
    v_pk_fma_f16 v21, v22, s50, s50
    v_rcp_f16 v19, v18
    v_rcp_f16 v22, v21
    v_rcp_f16_sdwa v20, v18 dst_sel:DWORD dst_unused:UNUSED_PAD src0_sel:WORD_1
    s_waitcnt lgkmcnt(0)
    s_nop 0
    v_mfma_f32_32x32x16_bf16 v[80:95], v[64:67], v[128:131], v[80:95]
    v_rcp_f16_sdwa v23, v21 dst_sel:DWORD dst_unused:UNUSED_PAD src0_sel:WORD_1
    v_fma_mix_f32 v19, v100, v19, 0 op_sel_hi:[0,1,0]
    v_fma_mix_f32 v22, v102, v22, 0 op_sel_hi:[0,1,0]
    v_fma_mix_f32 v20, v101, v20, 0 op_sel_hi:[0,1,0]
    v_fma_mix_f32 v23, v103, v23, 0 op_sel_hi:[0,1,0]
    v_cvt_pk_bf16_f32 v26, v19, v20
    v_cvt_pk_bf16_f32 v27, v22, v23
    v_cvt_pk_f16_f32 v18, v104, v105
    v_mfma_f32_32x32x16_bf16 v[80:95], v[68:71], v[136:139], v[80:95]
    v_cvt_pk_f16_f32 v21, v106, v107
    v_pk_fma_f16 v19, v18, v18, s49
    v_pk_fma_f16 v22, v21, v21, s49
    v_pk_mul_f16 v18, v18, v19
    v_pk_mul_f16 v21, v21, v22
    v_exp_f16 v19, v18
    v_exp_f16 v22, v21
    v_exp_f16_sdwa v19, v18 dst_sel:WORD_1 dst_unused:UNUSED_PRESERVE src0_sel:WORD_1
    v_mfma_f32_32x32x16_bf16 v[208:223], v[32:35], v[24:27], v[208:223]
    s_mov_b64 exec, s[80:81]
    s_nop 0
    s_add_u32 m0, s86, 4704
    s_add_u32 s71, s85, 4224
    buffer_load_dwordx4 v14, s[16:19], s71 offen nt lds
    s_add_u32 m0, s86, 5488
    s_add_u32 s71, s85, 4992
    buffer_load_dwordx4 v14, s[16:19], s71 offen nt lds
    s_add_u32 m0, s86, 6272
    s_add_u32 s71, s85, 5760
    buffer_load_dwordx4 v13, s[16:19], s71 offen nt lds
    s_mov_b64 exec, -1
    s_add_u32 s64, s64, 7
    v_exp_f16_sdwa v22, v21 dst_sel:WORD_1 dst_unused:UNUSED_PRESERVE src0_sel:WORD_1
    v_pk_fma_f16 v18, v19, s50, s50
    v_pk_fma_f16 v21, v22, s50, s50
    v_rcp_f16 v19, v18
    v_rcp_f16 v22, v21
    v_rcp_f16_sdwa v20, v18 dst_sel:DWORD dst_unused:UNUSED_PAD src0_sel:WORD_1
    v_mfma_f32_32x32x16_bf16 v[80:95], v[72:75], v[144:147], v[80:95]
    v_rcp_f16_sdwa v23, v21 dst_sel:DWORD dst_unused:UNUSED_PAD src0_sel:WORD_1
    v_fma_mix_f32 v19, v104, v19, 0 op_sel_hi:[0,1,0]
    v_fma_mix_f32 v22, v106, v22, 0 op_sel_hi:[0,1,0]
    v_fma_mix_f32 v20, v105, v20, 0 op_sel_hi:[0,1,0]
    v_fma_mix_f32 v23, v107, v23, 0 op_sel_hi:[0,1,0]
    v_cvt_pk_bf16_f32 v28, v19, v20
    v_cvt_pk_bf16_f32 v29, v22, v23
    v_cvt_pk_f16_f32 v18, v108, v109
    v_mfma_f32_32x32x16_bf16 v[224:239], v[36:39], v[24:27], v[224:239]
    v_cvt_pk_f16_f32 v21, v110, v111
    v_pk_fma_f16 v19, v18, v18, s49
    v_pk_fma_f16 v22, v21, v21, s49
    v_pk_mul_f16 v18, v18, v19
    v_pk_mul_f16 v21, v21, v22
    v_exp_f16 v19, v18
    v_exp_f16 v22, v21
    v_exp_f16_sdwa v19, v18 dst_sel:WORD_1 dst_unused:UNUSED_PRESERVE src0_sel:WORD_1
    v_mfma_f32_32x32x16_bf16 v[80:95], v[76:79], v[152:155], v[80:95]
    v_exp_f16_sdwa v22, v21 dst_sel:WORD_1 dst_unused:UNUSED_PRESERVE src0_sel:WORD_1
    v_pk_fma_f16 v18, v19, s50, s50
    v_pk_fma_f16 v21, v22, s50, s50
    v_rcp_f16 v19, v18
    v_rcp_f16 v22, v21
    v_rcp_f16_sdwa v20, v18 dst_sel:DWORD dst_unused:UNUSED_PAD src0_sel:WORD_1
    v_mfma_f32_32x32x16_bf16 v[240:255], v[40:43], v[24:27], v[240:255]
    v_rcp_f16_sdwa v23, v21 dst_sel:DWORD dst_unused:UNUSED_PAD src0_sel:WORD_1
    v_fma_mix_f32 v19, v108, v19, 0 op_sel_hi:[0,1,0]
    v_fma_mix_f32 v22, v110, v22, 0 op_sel_hi:[0,1,0]
    v_fma_mix_f32 v20, v109, v20, 0 op_sel_hi:[0,1,0]
    v_fma_mix_f32 v23, v111, v23, 0 op_sel_hi:[0,1,0]
    v_cvt_pk_bf16_f32 v30, v19, v20
    v_cvt_pk_bf16_f32 v31, v22, v23
    s_mov_b32 s66, 1
    s_mov_b32 s67, 1
    s_cmp_eq_u32 s47, 0
    s_cselect_b32 s48, 1, 5
    s_waitcnt vmcnt(18)
    s_branch Lnowait0R
.p2align 6
LloopAR:
    s_waitcnt vmcnt(0)
Lnowait0R:
    s_barrier
    s_sub_u32 s41, 82816, s41
Lbody0R:
    v_add_u32_e64 v9, s41, v7
    v_add_u32 v10, s41, v8
    s_setprio 3
    v_cvt_pk_f16_f32 v18, v80, v81
    v_cvt_pk_f16_f32 v21, v82, v83
    v_mfma_f32_32x32x16_bf16 v[208:223], v[44:47], v[28:31], v[208:223]
    ds_read_b64_tr_b16 v[44:45], v10 offset:9216
    ds_read_b64_tr_b16 v[46:47], v10 offset:10752
    v_pk_fma_f16 v19, v18, v18, s49
    v_pk_fma_f16 v22, v21, v21, s49
    v_pk_mul_f16 v18, v18, v19
    v_pk_mul_f16 v21, v21, v22
    v_exp_f16 v19, v18
    v_exp_f16 v22, v21
    v_exp_f16_sdwa v19, v18 dst_sel:WORD_1 dst_unused:UNUSED_PRESERVE src0_sel:WORD_1
    v_mfma_f32_32x32x16_bf16 v[96:111], v[56:59], v[116:119], 0
    ds_read_b64_tr_b16 v[32:33], v10 offset:6144
    ds_read_b64_tr_b16 v[34:35], v10 offset:7680
    ds_read_b64_tr_b16 v[56:57], v9 offset:0
    ds_read_b64_tr_b16 v[58:59], v9 offset:256
    v_exp_f16_sdwa v22, v21 dst_sel:WORD_1 dst_unused:UNUSED_PRESERVE src0_sel:WORD_1
    v_pk_fma_f16 v18, v19, s50, s50
    v_pk_fma_f16 v21, v22, s50, s50
    v_rcp_f16 v19, v18
    v_rcp_f16 v22, v21
    v_rcp_f16_sdwa v20, v18 dst_sel:DWORD dst_unused:UNUSED_PAD src0_sel:WORD_1
    v_mfma_f32_32x32x16_bf16 v[224:239], v[48:51], v[28:31], v[224:239]
    ds_read_b64_tr_b16 v[36:37], v10 offset:6208
    ds_read_b64_tr_b16 v[38:39], v10 offset:7744
    ds_read_b64_tr_b16 v[48:49], v10 offset:9280
    ds_read_b64_tr_b16 v[50:51], v10 offset:10816
    v_rcp_f16_sdwa v23, v21 dst_sel:DWORD dst_unused:UNUSED_PAD src0_sel:WORD_1
    v_fma_mix_f32 v19, v80, v19, 0 op_sel_hi:[0,1,0]
    v_fma_mix_f32 v22, v82, v22, 0 op_sel_hi:[0,1,0]
    v_fma_mix_f32 v20, v81, v20, 0 op_sel_hi:[0,1,0]
    v_fma_mix_f32 v23, v83, v23, 0 op_sel_hi:[0,1,0]
    v_cvt_pk_bf16_f32 v24, v19, v20
    v_cvt_pk_bf16_f32 v25, v22, v23
    v_cvt_pk_f16_f32 v18, v84, v85
    v_cvt_pk_f16_f32 v21, v86, v87
    v_mfma_f32_32x32x16_bf16 v[96:111], v[60:63], v[124:127], v[96:111]
    ds_read_b64_tr_b16 v[40:41], v10 offset:6272
    ds_read_b64_tr_b16 v[42:43], v10 offset:7808
    ds_read_b64_tr_b16 v[60:61], v9 offset:1024
    ds_read_b64_tr_b16 v[62:63], v9 offset:1280
    v_pk_fma_f16 v19, v18, v18, s49
    v_pk_fma_f16 v22, v21, v21, s49
    v_pk_mul_f16 v18, v18, v19
    v_pk_mul_f16 v21, v21, v22
    v_exp_f16 v19, v18
    v_exp_f16 v22, v21
    v_exp_f16_sdwa v19, v18 dst_sel:WORD_1 dst_unused:UNUSED_PRESERVE src0_sel:WORD_1
    v_mfma_f32_32x32x16_bf16 v[240:255], v[52:55], v[28:31], v[240:255]
    ds_read_b64_tr_b16 v[52:53], v10 offset:9344
    s_waitcnt lgkmcnt(8)
    s_nop 0
    ds_read_b64_tr_b16 v[54:55], v10 offset:10880
    v_exp_f16_sdwa v22, v21 dst_sel:WORD_1 dst_unused:UNUSED_PRESERVE src0_sel:WORD_1
    v_pk_fma_f16 v18, v19, s50, s50
    v_pk_fma_f16 v21, v22, s50, s50
    v_rcp_f16 v19, v18
    v_rcp_f16 v22, v21
    v_rcp_f16_sdwa v20, v18 dst_sel:DWORD dst_unused:UNUSED_PAD src0_sel:WORD_1
    v_mfma_f32_32x32x16_bf16 v[96:111], v[64:67], v[132:135], v[96:111]
    ds_read_b64_tr_b16 v[64:65], v9 offset:2048
    ds_read_b64_tr_b16 v[66:67], v9 offset:2304
    v_rcp_f16_sdwa v23, v21 dst_sel:DWORD dst_unused:UNUSED_PAD src0_sel:WORD_1
    v_fma_mix_f32 v19, v84, v19, 0 op_sel_hi:[0,1,0]
    v_fma_mix_f32 v22, v86, v22, 0 op_sel_hi:[0,1,0]
    v_fma_mix_f32 v20, v85, v20, 0 op_sel_hi:[0,1,0]
    v_fma_mix_f32 v23, v87, v23, 0 op_sel_hi:[0,1,0]
    v_cvt_pk_bf16_f32 v26, v19, v20
    v_cvt_pk_bf16_f32 v27, v22, v23
    v_cvt_pk_f16_f32 v18, v88, v89
    v_mfma_f32_32x32x16_bf16 v[96:111], v[68:71], v[140:143], v[96:111]
    ds_read_b64_tr_b16 v[68:69], v9 offset:3072
    ds_read_b64_tr_b16 v[70:71], v9 offset:3328
    v_cvt_pk_f16_f32 v21, v90, v91
    v_pk_fma_f16 v19, v18, v18, s49
    v_pk_fma_f16 v22, v21, v21, s49
    v_pk_mul_f16 v18, v18, v19
    v_pk_mul_f16 v21, v21, v22
    v_exp_f16 v19, v18
    v_exp_f16 v22, v21
    v_exp_f16_sdwa v19, v18 dst_sel:WORD_1 dst_unused:UNUSED_PRESERVE src0_sel:WORD_1
    v_mfma_f32_32x32x16_bf16 v[160:175], v[32:35], v[24:27], v[160:175]
    s_sub_u32 s78, 82816, s41
    s_add_u32 m0, s78, s88
    s_add_u32 s79, s42, s46
    buffer_load_dwordx4 v11, s[24:27], s79 offen sc1 lds
    v_exp_f16_sdwa v22, v21 dst_sel:WORD_1 dst_unused:UNUSED_PRESERVE src0_sel:WORD_1
    v_pk_fma_f16 v18, v19, s50, s50
    v_pk_fma_f16 v21, v22, s50, s50
    v_rcp_f16 v19, v18
    v_rcp_f16 v22, v21
    v_rcp_f16_sdwa v20, v18 dst_sel:DWORD dst_unused:UNUSED_PAD src0_sel:WORD_1
    v_mfma_f32_32x32x16_bf16 v[96:111], v[72:75], v[148:151], v[96:111]
    ds_read_b64_tr_b16 v[72:73], v9 offset:4096
    ds_read_b64_tr_b16 v[74:75], v9 offset:4352
    v_rcp_f16_sdwa v23, v21 dst_sel:DWORD dst_unused:UNUSED_PAD src0_sel:WORD_1
    v_fma_mix_f32 v19, v88, v19, 0 op_sel_hi:[0,1,0]
    v_fma_mix_f32 v22, v90, v22, 0 op_sel_hi:[0,1,0]
    v_fma_mix_f32 v20, v89, v20, 0 op_sel_hi:[0,1,0]
    v_fma_mix_f32 v23, v91, v23, 0 op_sel_hi:[0,1,0]
    v_cvt_pk_bf16_f32 v28, v19, v20
    v_cvt_pk_bf16_f32 v29, v22, v23
    v_cvt_pk_f16_f32 v18, v92, v93
    s_waitcnt lgkmcnt(5)
    s_nop 0
    v_mfma_f32_32x32x16_bf16 v[176:191], v[36:39], v[24:27], v[176:191]
    s_add_u32 m0, m0, s89
    s_add_u32 s79, s79, s45
    buffer_load_dwordx4 v11, s[24:27], s79 offen sc1 lds
    v_cvt_pk_f16_f32 v21, v94, v95
    v_pk_fma_f16 v19, v18, v18, s49
    v_pk_fma_f16 v22, v21, v21, s49
    v_pk_mul_f16 v18, v18, v19
    v_pk_mul_f16 v21, v21, v22
    v_exp_f16 v19, v18
    v_exp_f16 v22, v21
    v_exp_f16_sdwa v19, v18 dst_sel:WORD_1 dst_unused:UNUSED_PRESERVE src0_sel:WORD_1
    v_mfma_f32_32x32x16_bf16 v[96:111], v[76:79], v[156:159], v[96:111]
    ds_read_b64_tr_b16 v[76:77], v9 offset:5120
    ds_read_b64_tr_b16 v[78:79], v9 offset:5376
    v_exp_f16_sdwa v22, v21 dst_sel:WORD_1 dst_unused:UNUSED_PRESERVE src0_sel:WORD_1
    v_pk_fma_f16 v18, v19, s50, s50
    v_pk_fma_f16 v21, v22, s50, s50
    v_rcp_f16 v19, v18
    v_rcp_f16 v22, v21
    v_rcp_f16_sdwa v20, v18 dst_sel:DWORD dst_unused:UNUSED_PAD src0_sel:WORD_1
    v_mfma_f32_32x32x16_bf16 v[192:207], v[40:43], v[24:27], v[192:207]
    s_add_u32 m0, m0, s89
    s_add_u32 s79, s79, s45
    buffer_load_dwordx4 v11, s[24:27], s79 offen sc1 lds
    s_add_u32 s42, s42, s43
    s_cmp_eq_u32 s42, s44
    s_cselect_b32 s42, 0, s42
    s_nop 0
    v_rcp_f16_sdwa v23, v21 dst_sel:DWORD dst_unused:UNUSED_PAD src0_sel:WORD_1
    v_fma_mix_f32 v19, v92, v19, 0 op_sel_hi:[0,1,0]
    v_fma_mix_f32 v22, v94, v22, 0 op_sel_hi:[0,1,0]
    v_fma_mix_f32 v20, v93, v20, 0 op_sel_hi:[0,1,0]
    v_fma_mix_f32 v23, v95, v23, 0 op_sel_hi:[0,1,0]
    v_cvt_pk_bf16_f32 v30, v19, v20
    v_cvt_pk_bf16_f32 v31, v22, v23
    s_setprio 2
    s_nop 0
    v_cvt_pk_f16_f32 v18, v96, v97
    v_cvt_pk_f16_f32 v21, v98, v99
    v_mfma_f32_32x32x16_bf16 v[160:175], v[44:47], v[28:31], v[160:175]
    v_pk_fma_f16 v19, v18, v18, s49
    v_pk_fma_f16 v22, v21, v21, s49
    v_pk_mul_f16 v18, v18, v19
    v_pk_mul_f16 v21, v21, v22
    v_exp_f16 v19, v18
    v_exp_f16 v22, v21
    v_exp_f16_sdwa v19, v18 dst_sel:WORD_1 dst_unused:UNUSED_PRESERVE src0_sel:WORD_1
    v_mfma_f32_32x32x16_bf16 v[80:95], v[56:59], v[112:115], 0
    s_add_u32 s78, s78, 12288
    s_add_u32 m0, s78, s88
    s_add_u32 s79, s42, s46
    buffer_load_dwordx4 v11, s[24:27], s79 offen sc1 lds
    v_exp_f16_sdwa v22, v21 dst_sel:WORD_1 dst_unused:UNUSED_PRESERVE src0_sel:WORD_1
    v_pk_fma_f16 v18, v19, s50, s50
    v_pk_fma_f16 v21, v22, s50, s50
    v_rcp_f16 v19, v18
    v_rcp_f16 v22, v21
    v_rcp_f16_sdwa v20, v18 dst_sel:DWORD dst_unused:UNUSED_PAD src0_sel:WORD_1
    v_mfma_f32_32x32x16_bf16 v[176:191], v[48:51], v[28:31], v[176:191]
    v_rcp_f16_sdwa v23, v21 dst_sel:DWORD dst_unused:UNUSED_PAD src0_sel:WORD_1
    v_fma_mix_f32 v19, v96, v19, 0 op_sel_hi:[0,1,0]
    v_fma_mix_f32 v22, v98, v22, 0 op_sel_hi:[0,1,0]
    v_fma_mix_f32 v20, v97, v20, 0 op_sel_hi:[0,1,0]
    v_fma_mix_f32 v23, v99, v23, 0 op_sel_hi:[0,1,0]
    v_cvt_pk_bf16_f32 v24, v19, v20
    v_cvt_pk_bf16_f32 v25, v22, v23
    v_cvt_pk_f16_f32 v18, v100, v101
    v_cvt_pk_f16_f32 v21, v102, v103
    v_mfma_f32_32x32x16_bf16 v[80:95], v[60:63], v[120:123], v[80:95]
    s_add_u32 m0, m0, s89
    s_add_u32 s79, s79, s45
    buffer_load_dwordx4 v11, s[24:27], s79 offen sc1 lds
    v_pk_fma_f16 v19, v18, v18, s49
    v_pk_fma_f16 v22, v21, v21, s49
    v_pk_mul_f16 v18, v18, v19
    v_pk_mul_f16 v21, v21, v22
    v_exp_f16 v19, v18
    v_exp_f16 v22, v21
    v_exp_f16_sdwa v19, v18 dst_sel:WORD_1 dst_unused:UNUSED_PRESERVE src0_sel:WORD_1
    v_mfma_f32_32x32x16_bf16 v[192:207], v[52:55], v[28:31], v[192:207]
    v_exp_f16_sdwa v22, v21 dst_sel:WORD_1 dst_unused:UNUSED_PRESERVE src0_sel:WORD_1
    v_pk_fma_f16 v18, v19, s50, s50
    v_pk_fma_f16 v21, v22, s50, s50
    v_rcp_f16 v19, v18
    v_rcp_f16 v22, v21
    v_rcp_f16_sdwa v20, v18 dst_sel:DWORD dst_unused:UNUSED_PAD src0_sel:WORD_1
    s_waitcnt lgkmcnt(0)
    s_nop 0
    v_mfma_f32_32x32x16_bf16 v[80:95], v[64:67], v[128:131], v[80:95]
    s_add_u32 m0, m0, s89
    s_add_u32 s79, s79, s45
    buffer_load_dwordx4 v11, s[24:27], s79 offen sc1 lds
    s_add_u32 s42, s42, s43
    s_cmp_eq_u32 s42, s44
    s_cselect_b32 s42, 0, s42
    s_nop 0
    v_rcp_f16_sdwa v23, v21 dst_sel:DWORD dst_unused:UNUSED_PAD src0_sel:WORD_1
    v_fma_mix_f32 v19, v100, v19, 0 op_sel_hi:[0,1,0]
    v_fma_mix_f32 v22, v102, v22, 0 op_sel_hi:[0,1,0]
    v_fma_mix_f32 v20, v101, v20, 0 op_sel_hi:[0,1,0]
    v_fma_mix_f32 v23, v103, v23, 0 op_sel_hi:[0,1,0]
    v_cvt_pk_bf16_f32 v26, v19, v20
    v_cvt_pk_bf16_f32 v27, v22, v23
    v_cvt_pk_f16_f32 v18, v104, v105
    v_mfma_f32_32x32x16_bf16 v[80:95], v[68:71], v[136:139], v[80:95]
    v_cvt_pk_f16_f32 v21, v106, v107
    v_pk_fma_f16 v19, v18, v18, s49
    v_pk_fma_f16 v22, v21, v21, s49
    v_pk_mul_f16 v18, v18, v19
    v_pk_mul_f16 v21, v21, v22
    v_exp_f16 v19, v18
    v_exp_f16 v22, v21
    v_exp_f16_sdwa v19, v18 dst_sel:WORD_1 dst_unused:UNUSED_PRESERVE src0_sel:WORD_1
    v_mfma_f32_32x32x16_bf16 v[208:223], v[32:35], v[24:27], v[208:223]
    v_exp_f16_sdwa v22, v21 dst_sel:WORD_1 dst_unused:UNUSED_PRESERVE src0_sel:WORD_1
    v_pk_fma_f16 v18, v19, s50, s50
    v_pk_fma_f16 v21, v22, s50, s50
    v_rcp_f16 v19, v18
    v_rcp_f16 v22, v21
    v_rcp_f16_sdwa v20, v18 dst_sel:DWORD dst_unused:UNUSED_PAD src0_sel:WORD_1
    v_mfma_f32_32x32x16_bf16 v[80:95], v[72:75], v[144:147], v[80:95]
    v_rcp_f16_sdwa v23, v21 dst_sel:DWORD dst_unused:UNUSED_PAD src0_sel:WORD_1
    v_fma_mix_f32 v19, v104, v19, 0 op_sel_hi:[0,1,0]
    v_fma_mix_f32 v22, v106, v22, 0 op_sel_hi:[0,1,0]
    v_fma_mix_f32 v20, v105, v20, 0 op_sel_hi:[0,1,0]
    v_fma_mix_f32 v23, v107, v23, 0 op_sel_hi:[0,1,0]
    v_cvt_pk_bf16_f32 v28, v19, v20
    v_cvt_pk_bf16_f32 v29, v22, v23
    v_cvt_pk_f16_f32 v18, v108, v109
    v_mfma_f32_32x32x16_bf16 v[224:239], v[36:39], v[24:27], v[224:239]
    v_cvt_pk_f16_f32 v21, v110, v111
    v_pk_fma_f16 v19, v18, v18, s49
    v_pk_fma_f16 v22, v21, v21, s49
    v_pk_mul_f16 v18, v18, v19
    v_pk_mul_f16 v21, v21, v22
    v_exp_f16 v19, v18
    v_exp_f16 v22, v21
    v_exp_f16_sdwa v19, v18 dst_sel:WORD_1 dst_unused:UNUSED_PRESERVE src0_sel:WORD_1
    v_mfma_f32_32x32x16_bf16 v[80:95], v[76:79], v[152:155], v[80:95]
    v_exp_f16_sdwa v22, v21 dst_sel:WORD_1 dst_unused:UNUSED_PRESERVE src0_sel:WORD_1
    v_pk_fma_f16 v18, v19, s50, s50
    v_pk_fma_f16 v21, v22, s50, s50
    v_rcp_f16 v19, v18
    v_rcp_f16 v22, v21
    v_rcp_f16_sdwa v20, v18 dst_sel:DWORD dst_unused:UNUSED_PAD src0_sel:WORD_1
    v_mfma_f32_32x32x16_bf16 v[240:255], v[40:43], v[24:27], v[240:255]
    v_rcp_f16_sdwa v23, v21 dst_sel:DWORD dst_unused:UNUSED_PAD src0_sel:WORD_1
    v_fma_mix_f32 v19, v108, v19, 0 op_sel_hi:[0,1,0]
    v_fma_mix_f32 v22, v110, v22, 0 op_sel_hi:[0,1,0]
    v_fma_mix_f32 v20, v109, v20, 0 op_sel_hi:[0,1,0]
    v_fma_mix_f32 v23, v111, v23, 0 op_sel_hi:[0,1,0]
    v_cvt_pk_bf16_f32 v30, v19, v20
    v_cvt_pk_bf16_f32 v31, v22, v23
    s_setprio 1
    s_nop 0
    v_cvt_pk_f16_f32 v18, v80, v81
    v_cvt_pk_f16_f32 v21, v82, v83
    v_mfma_f32_32x32x16_bf16 v[208:223], v[44:47], v[28:31], v[208:223]
    ds_read_b64_tr_b16 v[44:45], v10 offset:21504
    ds_read_b64_tr_b16 v[46:47], v10 offset:23040
    v_pk_fma_f16 v19, v18, v18, s49
    v_pk_fma_f16 v22, v21, v21, s49
    v_pk_mul_f16 v18, v18, v19
    v_pk_mul_f16 v21, v21, v22
    v_exp_f16 v19, v18
    v_exp_f16 v22, v21
    v_exp_f16_sdwa v19, v18 dst_sel:WORD_1 dst_unused:UNUSED_PRESERVE src0_sel:WORD_1
    v_mfma_f32_32x32x16_bf16 v[96:111], v[56:59], v[116:119], 0
    ds_read_b64_tr_b16 v[32:33], v10 offset:18432
    ds_read_b64_tr_b16 v[34:35], v10 offset:19968
    ds_read_b64_tr_b16 v[56:57], v9 offset:12288
    ds_read_b64_tr_b16 v[58:59], v9 offset:12544
    v_exp_f16_sdwa v22, v21 dst_sel:WORD_1 dst_unused:UNUSED_PRESERVE src0_sel:WORD_1
    v_pk_fma_f16 v18, v19, s50, s50
    v_pk_fma_f16 v21, v22, s50, s50
    v_rcp_f16 v19, v18
    v_rcp_f16 v22, v21
    v_rcp_f16_sdwa v20, v18 dst_sel:DWORD dst_unused:UNUSED_PAD src0_sel:WORD_1
    v_mfma_f32_32x32x16_bf16 v[224:239], v[48:51], v[28:31], v[224:239]
    ds_read_b64_tr_b16 v[36:37], v10 offset:18496
    ds_read_b64_tr_b16 v[38:39], v10 offset:20032
    ds_read_b64_tr_b16 v[48:49], v10 offset:21568
    ds_read_b64_tr_b16 v[50:51], v10 offset:23104
    v_rcp_f16_sdwa v23, v21 dst_sel:DWORD dst_unused:UNUSED_PAD src0_sel:WORD_1
    v_fma_mix_f32 v19, v80, v19, 0 op_sel_hi:[0,1,0]
    v_fma_mix_f32 v22, v82, v22, 0 op_sel_hi:[0,1,0]
    v_fma_mix_f32 v20, v81, v20, 0 op_sel_hi:[0,1,0]
    v_fma_mix_f32 v23, v83, v23, 0 op_sel_hi:[0,1,0]
    v_cvt_pk_bf16_f32 v24, v19, v20
    v_cvt_pk_bf16_f32 v25, v22, v23
    v_cvt_pk_f16_f32 v18, v84, v85
    v_cvt_pk_f16_f32 v21, v86, v87
    v_mfma_f32_32x32x16_bf16 v[96:111], v[60:63], v[124:127], v[96:111]
    ds_read_b64_tr_b16 v[40:41], v10 offset:18560
    ds_read_b64_tr_b16 v[42:43], v10 offset:20096
    ds_read_b64_tr_b16 v[60:61], v9 offset:13312
    ds_read_b64_tr_b16 v[62:63], v9 offset:13568
    v_pk_fma_f16 v19, v18, v18, s49
    v_pk_fma_f16 v22, v21, v21, s49
    v_pk_mul_f16 v18, v18, v19
    v_pk_mul_f16 v21, v21, v22
    v_exp_f16 v19, v18
    v_exp_f16 v22, v21
    v_exp_f16_sdwa v19, v18 dst_sel:WORD_1 dst_unused:UNUSED_PRESERVE src0_sel:WORD_1
    v_mfma_f32_32x32x16_bf16 v[240:255], v[52:55], v[28:31], v[240:255]
    ds_read_b64_tr_b16 v[52:53], v10 offset:21632
    s_waitcnt lgkmcnt(8)
    s_nop 0
    ds_read_b64_tr_b16 v[54:55], v10 offset:23168
    v_exp_f16_sdwa v22, v21 dst_sel:WORD_1 dst_unused:UNUSED_PRESERVE src0_sel:WORD_1
    v_pk_fma_f16 v18, v19, s50, s50
    v_pk_fma_f16 v21, v22, s50, s50
    v_rcp_f16 v19, v18
    v_rcp_f16 v22, v21
    v_rcp_f16_sdwa v20, v18 dst_sel:DWORD dst_unused:UNUSED_PAD src0_sel:WORD_1
    v_mfma_f32_32x32x16_bf16 v[96:111], v[64:67], v[132:135], v[96:111]
    ds_read_b64_tr_b16 v[64:65], v9 offset:14336
    ds_read_b64_tr_b16 v[66:67], v9 offset:14592
    v_rcp_f16_sdwa v23, v21 dst_sel:DWORD dst_unused:UNUSED_PAD src0_sel:WORD_1
    v_fma_mix_f32 v19, v84, v19, 0 op_sel_hi:[0,1,0]
    v_fma_mix_f32 v22, v86, v22, 0 op_sel_hi:[0,1,0]
    v_fma_mix_f32 v20, v85, v20, 0 op_sel_hi:[0,1,0]
    v_fma_mix_f32 v23, v87, v23, 0 op_sel_hi:[0,1,0]
    v_cvt_pk_bf16_f32 v26, v19, v20
    v_cvt_pk_bf16_f32 v27, v22, v23
    v_cvt_pk_f16_f32 v18, v88, v89
    v_mfma_f32_32x32x16_bf16 v[96:111], v[68:71], v[140:143], v[96:111]
    ds_read_b64_tr_b16 v[68:69], v9 offset:15360
    ds_read_b64_tr_b16 v[70:71], v9 offset:15616
    v_cvt_pk_f16_f32 v21, v90, v91
    v_pk_fma_f16 v19, v18, v18, s49
    v_pk_fma_f16 v22, v21, v21, s49
    v_pk_mul_f16 v18, v18, v19
    v_pk_mul_f16 v21, v21, v22
    v_exp_f16 v19, v18
    v_exp_f16 v22, v21
    v_exp_f16_sdwa v19, v18 dst_sel:WORD_1 dst_unused:UNUSED_PRESERVE src0_sel:WORD_1
    v_mfma_f32_32x32x16_bf16 v[160:175], v[32:35], v[24:27], v[160:175]
    v_exp_f16_sdwa v22, v21 dst_sel:WORD_1 dst_unused:UNUSED_PRESERVE src0_sel:WORD_1
    v_pk_fma_f16 v18, v19, s50, s50
    v_pk_fma_f16 v21, v22, s50, s50
    v_rcp_f16 v19, v18
    v_rcp_f16 v22, v21
    v_rcp_f16_sdwa v20, v18 dst_sel:DWORD dst_unused:UNUSED_PAD src0_sel:WORD_1
    v_mfma_f32_32x32x16_bf16 v[96:111], v[72:75], v[148:151], v[96:111]
    ds_read_b64_tr_b16 v[72:73], v9 offset:16384
    ds_read_b64_tr_b16 v[74:75], v9 offset:16640
    v_rcp_f16_sdwa v23, v21 dst_sel:DWORD dst_unused:UNUSED_PAD src0_sel:WORD_1
    v_fma_mix_f32 v19, v88, v19, 0 op_sel_hi:[0,1,0]
    v_fma_mix_f32 v22, v90, v22, 0 op_sel_hi:[0,1,0]
    v_fma_mix_f32 v20, v89, v20, 0 op_sel_hi:[0,1,0]
    v_fma_mix_f32 v23, v91, v23, 0 op_sel_hi:[0,1,0]
    v_cvt_pk_bf16_f32 v28, v19, v20
    v_cvt_pk_bf16_f32 v29, v22, v23
    v_cvt_pk_f16_f32 v18, v92, v93
    s_waitcnt lgkmcnt(5)
    s_nop 0
    v_mfma_f32_32x32x16_bf16 v[176:191], v[36:39], v[24:27], v[176:191]
    v_cvt_pk_f16_f32 v21, v94, v95
    v_pk_fma_f16 v19, v18, v18, s49
    v_pk_fma_f16 v22, v21, v21, s49
    v_pk_mul_f16 v18, v18, v19
    v_pk_mul_f16 v21, v21, v22
    v_exp_f16 v19, v18
    v_exp_f16 v22, v21
    v_exp_f16_sdwa v19, v18 dst_sel:WORD_1 dst_unused:UNUSED_PRESERVE src0_sel:WORD_1
    v_mfma_f32_32x32x16_bf16 v[96:111], v[76:79], v[156:159], v[96:111]
    ds_read_b64_tr_b16 v[76:77], v9 offset:17408
    ds_read_b64_tr_b16 v[78:79], v9 offset:17664
    v_exp_f16_sdwa v22, v21 dst_sel:WORD_1 dst_unused:UNUSED_PRESERVE src0_sel:WORD_1
    v_pk_fma_f16 v18, v19, s50, s50
    v_pk_fma_f16 v21, v22, s50, s50
    v_rcp_f16 v19, v18
    v_rcp_f16 v22, v21
    v_rcp_f16_sdwa v20, v18 dst_sel:DWORD dst_unused:UNUSED_PAD src0_sel:WORD_1
    v_mfma_f32_32x32x16_bf16 v[192:207], v[40:43], v[24:27], v[192:207]
    v_rcp_f16_sdwa v23, v21 dst_sel:DWORD dst_unused:UNUSED_PAD src0_sel:WORD_1
    v_fma_mix_f32 v19, v92, v19, 0 op_sel_hi:[0,1,0]
    v_fma_mix_f32 v22, v94, v22, 0 op_sel_hi:[0,1,0]
    v_fma_mix_f32 v20, v93, v20, 0 op_sel_hi:[0,1,0]
    v_fma_mix_f32 v23, v95, v23, 0 op_sel_hi:[0,1,0]
    v_cvt_pk_bf16_f32 v30, v19, v20
    v_cvt_pk_bf16_f32 v31, v22, v23
    s_setprio 0
    s_nop 0
    v_cvt_pk_f16_f32 v18, v96, v97
    v_cvt_pk_f16_f32 v21, v98, v99
    v_mfma_f32_32x32x16_bf16 v[160:175], v[44:47], v[28:31], v[160:175]
    v_pk_fma_f16 v19, v18, v18, s49
    v_pk_fma_f16 v22, v21, v21, s49
    v_pk_mul_f16 v18, v18, v19
    v_pk_mul_f16 v21, v21, v22
    v_exp_f16 v19, v18
    v_exp_f16 v22, v21
    v_exp_f16_sdwa v19, v18 dst_sel:WORD_1 dst_unused:UNUSED_PRESERVE src0_sel:WORD_1
    v_mfma_f32_32x32x16_bf16 v[80:95], v[56:59], v[112:115], 0
    v_exp_f16_sdwa v22, v21 dst_sel:WORD_1 dst_unused:UNUSED_PRESERVE src0_sel:WORD_1
    v_pk_fma_f16 v18, v19, s50, s50
    v_pk_fma_f16 v21, v22, s50, s50
    v_rcp_f16 v19, v18
    v_rcp_f16 v22, v21
    v_rcp_f16_sdwa v20, v18 dst_sel:DWORD dst_unused:UNUSED_PAD src0_sel:WORD_1
    v_mfma_f32_32x32x16_bf16 v[176:191], v[48:51], v[28:31], v[176:191]
    v_rcp_f16_sdwa v23, v21 dst_sel:DWORD dst_unused:UNUSED_PAD src0_sel:WORD_1
    v_fma_mix_f32 v19, v96, v19, 0 op_sel_hi:[0,1,0]
    v_fma_mix_f32 v22, v98, v22, 0 op_sel_hi:[0,1,0]
    v_fma_mix_f32 v20, v97, v20, 0 op_sel_hi:[0,1,0]
    v_fma_mix_f32 v23, v99, v23, 0 op_sel_hi:[0,1,0]
    v_cvt_pk_bf16_f32 v24, v19, v20
    v_cvt_pk_bf16_f32 v25, v22, v23
    v_cvt_pk_f16_f32 v18, v100, v101
    v_cvt_pk_f16_f32 v21, v102, v103
    v_mfma_f32_32x32x16_bf16 v[80:95], v[60:63], v[120:123], v[80:95]
    v_pk_fma_f16 v19, v18, v18, s49
    v_pk_fma_f16 v22, v21, v21, s49
    v_pk_mul_f16 v18, v18, v19
    v_pk_mul_f16 v21, v21, v22
    v_exp_f16 v19, v18
    v_exp_f16 v22, v21
    v_exp_f16_sdwa v19, v18 dst_sel:WORD_1 dst_unused:UNUSED_PRESERVE src0_sel:WORD_1
    v_mfma_f32_32x32x16_bf16 v[192:207], v[52:55], v[28:31], v[192:207]
    v_exp_f16_sdwa v22, v21 dst_sel:WORD_1 dst_unused:UNUSED_PRESERVE src0_sel:WORD_1
    v_pk_fma_f16 v18, v19, s50, s50
    v_pk_fma_f16 v21, v22, s50, s50
    v_rcp_f16 v19, v18
    v_rcp_f16 v22, v21
    v_rcp_f16_sdwa v20, v18 dst_sel:DWORD dst_unused:UNUSED_PAD src0_sel:WORD_1
    s_waitcnt lgkmcnt(0)
    s_nop 0
    v_mfma_f32_32x32x16_bf16 v[80:95], v[64:67], v[128:131], v[80:95]
    v_rcp_f16_sdwa v23, v21 dst_sel:DWORD dst_unused:UNUSED_PAD src0_sel:WORD_1
    v_fma_mix_f32 v19, v100, v19, 0 op_sel_hi:[0,1,0]
    v_fma_mix_f32 v22, v102, v22, 0 op_sel_hi:[0,1,0]
    v_fma_mix_f32 v20, v101, v20, 0 op_sel_hi:[0,1,0]
    v_fma_mix_f32 v23, v103, v23, 0 op_sel_hi:[0,1,0]
    v_cvt_pk_bf16_f32 v26, v19, v20
    v_cvt_pk_bf16_f32 v27, v22, v23
    v_cvt_pk_f16_f32 v18, v104, v105
    v_mfma_f32_32x32x16_bf16 v[80:95], v[68:71], v[136:139], v[80:95]
    v_cvt_pk_f16_f32 v21, v106, v107
    v_pk_fma_f16 v19, v18, v18, s49
    v_pk_fma_f16 v22, v21, v21, s49
    v_pk_mul_f16 v18, v18, v19
    v_pk_mul_f16 v21, v21, v22
    v_exp_f16 v19, v18
    v_exp_f16 v22, v21
    v_exp_f16_sdwa v19, v18 dst_sel:WORD_1 dst_unused:UNUSED_PRESERVE src0_sel:WORD_1
    v_mfma_f32_32x32x16_bf16 v[208:223], v[32:35], v[24:27], v[208:223]
    v_exp_f16_sdwa v22, v21 dst_sel:WORD_1 dst_unused:UNUSED_PRESERVE src0_sel:WORD_1
    v_pk_fma_f16 v18, v19, s50, s50
    v_pk_fma_f16 v21, v22, s50, s50
    v_rcp_f16 v19, v18
    v_rcp_f16 v22, v21
    v_rcp_f16_sdwa v20, v18 dst_sel:DWORD dst_unused:UNUSED_PAD src0_sel:WORD_1
    v_mfma_f32_32x32x16_bf16 v[80:95], v[72:75], v[144:147], v[80:95]
    v_rcp_f16_sdwa v23, v21 dst_sel:DWORD dst_unused:UNUSED_PAD src0_sel:WORD_1
    v_fma_mix_f32 v19, v104, v19, 0 op_sel_hi:[0,1,0]
    v_fma_mix_f32 v22, v106, v22, 0 op_sel_hi:[0,1,0]
    v_fma_mix_f32 v20, v105, v20, 0 op_sel_hi:[0,1,0]
    v_fma_mix_f32 v23, v107, v23, 0 op_sel_hi:[0,1,0]
    v_cvt_pk_bf16_f32 v28, v19, v20
    v_cvt_pk_bf16_f32 v29, v22, v23
    v_cvt_pk_f16_f32 v18, v108, v109
    v_mfma_f32_32x32x16_bf16 v[224:239], v[36:39], v[24:27], v[224:239]
    v_cvt_pk_f16_f32 v21, v110, v111
    v_pk_fma_f16 v19, v18, v18, s49
    v_pk_fma_f16 v22, v21, v21, s49
    v_pk_mul_f16 v18, v18, v19
    v_pk_mul_f16 v21, v21, v22
    v_exp_f16 v19, v18
    v_exp_f16 v22, v21
    v_exp_f16_sdwa v19, v18 dst_sel:WORD_1 dst_unused:UNUSED_PRESERVE src0_sel:WORD_1
    v_mfma_f32_32x32x16_bf16 v[80:95], v[76:79], v[152:155], v[80:95]
    v_exp_f16_sdwa v22, v21 dst_sel:WORD_1 dst_unused:UNUSED_PRESERVE src0_sel:WORD_1
    v_pk_fma_f16 v18, v19, s50, s50
    v_pk_fma_f16 v21, v22, s50, s50
    v_rcp_f16 v19, v18
    v_rcp_f16 v22, v21
    v_rcp_f16_sdwa v20, v18 dst_sel:DWORD dst_unused:UNUSED_PAD src0_sel:WORD_1
    v_mfma_f32_32x32x16_bf16 v[240:255], v[40:43], v[24:27], v[240:255]
    v_rcp_f16_sdwa v23, v21 dst_sel:DWORD dst_unused:UNUSED_PAD src0_sel:WORD_1
    v_fma_mix_f32 v19, v108, v19, 0 op_sel_hi:[0,1,0]
    v_fma_mix_f32 v22, v110, v22, 0 op_sel_hi:[0,1,0]
    v_fma_mix_f32 v20, v109, v20, 0 op_sel_hi:[0,1,0]
    v_fma_mix_f32 v23, v111, v23, 0 op_sel_hi:[0,1,0]
    v_cvt_pk_bf16_f32 v30, v19, v20
    v_cvt_pk_bf16_f32 v31, v22, v23
    s_sub_u32 s48, s48, 1
    s_cmp_lg_u32 s48, 0
    s_cbranch_scc1 LloopAR
    s_mov_b32 s48, 9
    s_cmp_eq_u32 s66, 0
    s_cbranch_scc1 LloopXR
    s_add_u32 s63, s63, 4
    s_cmp_ge_u32 s63, 12
    s_cselect_b32 s63, 0, s63
    s_add_u32 s47, s47, 1
    s_cmp_eq_u32 s47, 1
    s_cbranch_scc1 LouterR
    s_waitcnt vmcnt(0)
    s_barrier
    s_sub_u32 s41, 82816, s41
    s_sub_u32 s78, 82816, s41
    s_add_u32 m0, s78, s88
    s_add_u32 s79, s42, s46
    buffer_load_dwordx4 v11, s[24:27], s79 offen sc1 lds
    s_add_u32 m0, m0, s89
    s_add_u32 s79, s79, s45
    buffer_load_dwordx4 v11, s[24:27], s79 offen sc1 lds
    s_add_u32 m0, m0, s89
    s_add_u32 s79, s79, s45
    buffer_load_dwordx4 v11, s[24:27], s79 offen sc1 lds
    s_add_u32 s42, s42, s43
    s_cmp_eq_u32 s42, s44
    s_cselect_b32 s42, 0, s42
    s_nop 0
    s_add_u32 s78, s78, 12288
    s_add_u32 m0, s78, s88
    s_add_u32 s79, s42, s46
    buffer_load_dwordx4 v11, s[24:27], s79 offen sc1 lds
    s_add_u32 m0, m0, s89
    s_add_u32 s79, s79, s45
    buffer_load_dwordx4 v11, s[24:27], s79 offen sc1 lds
    s_add_u32 m0, m0, s89
    s_add_u32 s79, s79, s45
    buffer_load_dwordx4 v11, s[24:27], s79 offen sc1 lds
    s_add_u32 s42, s42, s43
    s_cmp_eq_u32 s42, s44
    s_cselect_b32 s42, 0, s42
    s_nop 0
    v_cvt_pk_bf16_f32 v112, v160, v161
    v_cvt_pk_bf16_f32 v113, v162, v163
    v_mfma_f32_32x32x16_bf16 v[208:223], v[44:47], v[28:31], v[208:223]
    v_cvt_pk_bf16_f32 v114, v164, v165
    v_cvt_pk_bf16_f32 v115, v166, v167
    v_cvt_pk_bf16_f32 v116, v168, v169
    v_cvt_pk_bf16_f32 v117, v170, v171
    v_cvt_pk_bf16_f32 v118, v172, v173
    v_cvt_pk_bf16_f32 v119, v174, v175
    v_cvt_pk_bf16_f32 v120, v176, v177
    v_mfma_f32_32x32x16_bf16 v[224:239], v[48:51], v[28:31], v[224:239]
    v_cvt_pk_bf16_f32 v121, v178, v179
    v_cvt_pk_bf16_f32 v122, v180, v181
    v_cvt_pk_bf16_f32 v123, v182, v183
    v_cvt_pk_bf16_f32 v124, v184, v185
    v_cvt_pk_bf16_f32 v125, v186, v187
    v_cvt_pk_bf16_f32 v126, v188, v189
    v_cvt_pk_bf16_f32 v127, v190, v191
    v_mfma_f32_32x32x16_bf16 v[240:255], v[52:55], v[28:31], v[240:255]
    v_permlane16_swap_b32 v112, v116
    v_permlane16_swap_b32 v113, v117
    v_permlane16_swap_b32 v114, v118
    v_permlane16_swap_b32 v115, v119
    buffer_store_dwordx4 v[112:115], v6, s[20:23], s51 offen offset:0 sc0 sc1
    buffer_store_dwordx4 v[116:119], v6, s[20:23], s51 offen offset:3072 sc0 sc1
    v_cvt_pk_bf16_f32 v128, v192, v193
    v_cvt_pk_bf16_f32 v129, v194, v195
    v_cvt_pk_bf16_f32 v130, v196, v197
    v_cvt_pk_bf16_f32 v131, v198, v199
    v_cvt_pk_bf16_f32 v132, v200, v201
    v_cvt_pk_bf16_f32 v133, v202, v203
    v_cvt_pk_bf16_f32 v134, v204, v205
    v_cvt_pk_bf16_f32 v135, v206, v207
    v_permlane16_swap_b32 v120, v124
    v_permlane16_swap_b32 v121, v125
    v_permlane16_swap_b32 v122, v126
    v_permlane16_swap_b32 v123, v127
    buffer_store_dwordx4 v[120:123], v6, s[20:23], s51 offen offset:64 sc0 sc1
    buffer_store_dwordx4 v[124:127], v6, s[20:23], s51 offen offset:3136 sc0 sc1
    v_cvt_pk_bf16_f32 v136, v208, v209
    v_cvt_pk_bf16_f32 v137, v210, v211
    v_cvt_pk_bf16_f32 v138, v212, v213
    v_cvt_pk_bf16_f32 v139, v214, v215
    v_cvt_pk_bf16_f32 v140, v216, v217
    v_cvt_pk_bf16_f32 v141, v218, v219
    v_cvt_pk_bf16_f32 v142, v220, v221
    v_cvt_pk_bf16_f32 v143, v222, v223
    v_permlane16_swap_b32 v128, v132
    v_permlane16_swap_b32 v129, v133
    v_permlane16_swap_b32 v130, v134
    v_permlane16_swap_b32 v131, v135
    buffer_store_dwordx4 v[128:131], v6, s[20:23], s51 offen offset:128 sc0 sc1
    buffer_store_dwordx4 v[132:135], v6, s[20:23], s51 offen offset:3200 sc0 sc1
    s_waitcnt vmcnt(6)
    s_barrier
    s_sub_u32 s41, 82816, s41
    s_sub_u32 s78, 82816, s41
    s_add_u32 m0, s78, s88
    s_add_u32 s79, s42, s46
    buffer_load_dwordx4 v11, s[24:27], s79 offen sc1 lds
    s_add_u32 m0, m0, s89
    s_add_u32 s79, s79, s45
    buffer_load_dwordx4 v11, s[24:27], s79 offen sc1 lds
    s_add_u32 m0, m0, s89
    s_add_u32 s79, s79, s45
    buffer_load_dwordx4 v11, s[24:27], s79 offen sc1 lds
    s_add_u32 s42, s42, s43
    s_cmp_eq_u32 s42, s44
    s_cselect_b32 s42, 0, s42
    s_nop 0
    s_add_u32 s78, s78, 12288
    s_add_u32 m0, s78, s88
    s_add_u32 s79, s42, s46
    buffer_load_dwordx4 v11, s[24:27], s79 offen sc1 lds
    s_add_u32 m0, m0, s89
    s_add_u32 s79, s79, s45
    buffer_load_dwordx4 v11, s[24:27], s79 offen sc1 lds
    s_add_u32 m0, m0, s89
    s_add_u32 s79, s79, s45
    buffer_load_dwordx4 v11, s[24:27], s79 offen sc1 lds
    s_add_u32 s42, s42, s43
    s_cmp_eq_u32 s42, s44
    s_cselect_b32 s42, 0, s42
    s_nop 0
    v_cvt_pk_bf16_f32 v144, v224, v225
    v_cvt_pk_bf16_f32 v145, v226, v227
    v_cvt_pk_bf16_f32 v146, v228, v229
    v_cvt_pk_bf16_f32 v147, v230, v231
    v_cvt_pk_bf16_f32 v148, v232, v233
    v_cvt_pk_bf16_f32 v149, v234, v235
    v_cvt_pk_bf16_f32 v150, v236, v237
    v_cvt_pk_bf16_f32 v151, v238, v239
    v_permlane16_swap_b32 v136, v140
    v_permlane16_swap_b32 v137, v141
    v_permlane16_swap_b32 v138, v142
    v_permlane16_swap_b32 v139, v143
    buffer_store_dwordx4 v[136:139], v6, s[20:23], s52 offen offset:0 sc0 sc1
    buffer_store_dwordx4 v[140:143], v6, s[20:23], s52 offen offset:3072 sc0 sc1
    v_cvt_pk_bf16_f32 v152, v240, v241
    v_cvt_pk_bf16_f32 v153, v242, v243
    v_cvt_pk_bf16_f32 v154, v244, v245
    v_cvt_pk_bf16_f32 v155, v246, v247
    v_cvt_pk_bf16_f32 v156, v248, v249
    v_cvt_pk_bf16_f32 v157, v250, v251
    v_cvt_pk_bf16_f32 v158, v252, v253
    v_cvt_pk_bf16_f32 v159, v254, v255
    v_permlane16_swap_b32 v144, v148
    v_permlane16_swap_b32 v145, v149
    v_permlane16_swap_b32 v146, v150
    v_permlane16_swap_b32 v147, v151
    buffer_store_dwordx4 v[144:147], v6, s[20:23], s52 offen offset:64 sc0 sc1
    buffer_store_dwordx4 v[148:151], v6, s[20:23], s52 offen offset:3136 sc0 sc1
    v_permlane16_swap_b32 v152, v156
    v_permlane16_swap_b32 v153, v157
    v_permlane16_swap_b32 v154, v158
    v_permlane16_swap_b32 v155, v159
    buffer_store_dwordx4 v[152:155], v6, s[20:23], s52 offen offset:128 sc0 sc1
    buffer_store_dwordx4 v[156:159], v6, s[20:23], s52 offen offset:3200 sc0 sc1
    s_waitcnt vmcnt(6)
    s_barrier
    s_sub_u32 s41, 82816, s41
    s_sub_u32 s78, 82816, s41
    s_add_u32 m0, s78, s88
    s_add_u32 s79, s42, s46
    buffer_load_dwordx4 v11, s[24:27], s79 offen sc1 lds
    s_add_u32 m0, m0, s89
    s_add_u32 s79, s79, s45
    buffer_load_dwordx4 v11, s[24:27], s79 offen sc1 lds
    s_add_u32 m0, m0, s89
    s_add_u32 s79, s79, s45
    buffer_load_dwordx4 v11, s[24:27], s79 offen sc1 lds
    s_add_u32 s42, s42, s43
    s_cmp_eq_u32 s42, s44
    s_cselect_b32 s42, 0, s42
    s_nop 0
    s_add_u32 s78, s78, 12288
    s_add_u32 m0, s78, s88
    s_add_u32 s79, s42, s46
    buffer_load_dwordx4 v11, s[24:27], s79 offen sc1 lds
    s_add_u32 m0, m0, s89
    s_add_u32 s79, s79, s45
    buffer_load_dwordx4 v11, s[24:27], s79 offen sc1 lds
    s_add_u32 m0, m0, s89
    s_add_u32 s79, s79, s45
    buffer_load_dwordx4 v11, s[24:27], s79 offen sc1 lds
    s_add_u32 s42, s42, s43
    s_cmp_eq_u32 s42, s44
    s_cselect_b32 s42, 0, s42
    s_waitcnt vmcnt(0)
    s_barrier
    s_nop 0
    s_sub_u32 s41, 82816, s41
    s_branch Lfin
.p2align 6
LloopNR:
    s_waitcnt vmcnt(0)
Lnowait2R:
    s_barrier
    s_sub_u32 s41, 82816, s41
Lbody2R:
    v_add_u32_e64 v9, s41, v7
    v_add_u32 v10, s41, v8
    s_setprio 3
    v_cvt_pk_f16_f32 v18, v80, v81
    v_cvt_pk_f16_f32 v21, v82, v83
    v_mfma_f32_32x32x16_bf16 v[208:223], v[44:47], v[28:31], v[208:223]
    ds_read_b64_tr_b16 v[44:45], v10 offset:9216
    ds_read_b64_tr_b16 v[46:47], v10 offset:10752
    v_pk_fma_f16 v19, v18, v18, s49
    v_pk_fma_f16 v22, v21, v21, s49
    v_pk_mul_f16 v18, v18, v19
    v_pk_mul_f16 v21, v21, v22
    v_exp_f16 v19, v18
    v_exp_f16 v22, v21
    v_exp_f16_sdwa v19, v18 dst_sel:WORD_1 dst_unused:UNUSED_PRESERVE src0_sel:WORD_1
    v_mfma_f32_32x32x16_bf16 v[96:111], v[56:59], v[116:119], 0
    ds_read_b64_tr_b16 v[32:33], v10 offset:6144
    ds_read_b64_tr_b16 v[34:35], v10 offset:7680
    ds_read_b64_tr_b16 v[56:57], v9 offset:0
    ds_read_b64_tr_b16 v[58:59], v9 offset:256
    v_exp_f16_sdwa v22, v21 dst_sel:WORD_1 dst_unused:UNUSED_PRESERVE src0_sel:WORD_1
    v_pk_fma_f16 v18, v19, s50, s50
    v_pk_fma_f16 v21, v22, s50, s50
    v_rcp_f16 v19, v18
    v_rcp_f16 v22, v21
    v_rcp_f16_sdwa v20, v18 dst_sel:DWORD dst_unused:UNUSED_PAD src0_sel:WORD_1
    v_mfma_f32_32x32x16_bf16 v[224:239], v[48:51], v[28:31], v[224:239]
    ds_read_b64_tr_b16 v[36:37], v10 offset:6208
    ds_read_b64_tr_b16 v[38:39], v10 offset:7744
    ds_read_b64_tr_b16 v[48:49], v10 offset:9280
    ds_read_b64_tr_b16 v[50:51], v10 offset:10816
    v_rcp_f16_sdwa v23, v21 dst_sel:DWORD dst_unused:UNUSED_PAD src0_sel:WORD_1
    v_fma_mix_f32 v19, v80, v19, 0 op_sel_hi:[0,1,0]
    v_fma_mix_f32 v22, v82, v22, 0 op_sel_hi:[0,1,0]
    v_fma_mix_f32 v20, v81, v20, 0 op_sel_hi:[0,1,0]
    v_fma_mix_f32 v23, v83, v23, 0 op_sel_hi:[0,1,0]
    v_cvt_pk_bf16_f32 v24, v19, v20
    v_cvt_pk_bf16_f32 v25, v22, v23
    v_cvt_pk_f16_f32 v18, v84, v85
    v_cvt_pk_f16_f32 v21, v86, v87
    v_mfma_f32_32x32x16_bf16 v[96:111], v[60:63], v[124:127], v[96:111]
    ds_read_b64_tr_b16 v[40:41], v10 offset:6272
    ds_read_b64_tr_b16 v[42:43], v10 offset:7808
    ds_read_b64_tr_b16 v[60:61], v9 offset:1024
    ds_read_b64_tr_b16 v[62:63], v9 offset:1280
    v_pk_fma_f16 v19, v18, v18, s49
    v_pk_fma_f16 v22, v21, v21, s49
    v_pk_mul_f16 v18, v18, v19
    v_pk_mul_f16 v21, v21, v22
    v_exp_f16 v19, v18
    v_exp_f16 v22, v21
    v_exp_f16_sdwa v19, v18 dst_sel:WORD_1 dst_unused:UNUSED_PRESERVE src0_sel:WORD_1
    v_mfma_f32_32x32x16_bf16 v[240:255], v[52:55], v[28:31], v[240:255]
    ds_read_b64_tr_b16 v[52:53], v10 offset:9344
    s_waitcnt lgkmcnt(8)
    s_nop 0
    ds_read_b64_tr_b16 v[54:55], v10 offset:10880
    v_exp_f16_sdwa v22, v21 dst_sel:WORD_1 dst_unused:UNUSED_PRESERVE src0_sel:WORD_1
    v_pk_fma_f16 v18, v19, s50, s50
    v_pk_fma_f16 v21, v22, s50, s50
    v_rcp_f16 v19, v18
    v_rcp_f16 v22, v21
    v_rcp_f16_sdwa v20, v18 dst_sel:DWORD dst_unused:UNUSED_PAD src0_sel:WORD_1
    v_mfma_f32_32x32x16_bf16 v[96:111], v[64:67], v[132:135], v[96:111]
    ds_read_b64_tr_b16 v[64:65], v9 offset:2048
    ds_read_b64_tr_b16 v[66:67], v9 offset:2304
    v_rcp_f16_sdwa v23, v21 dst_sel:DWORD dst_unused:UNUSED_PAD src0_sel:WORD_1
    v_fma_mix_f32 v19, v84, v19, 0 op_sel_hi:[0,1,0]
    v_fma_mix_f32 v22, v86, v22, 0 op_sel_hi:[0,1,0]
    v_fma_mix_f32 v20, v85, v20, 0 op_sel_hi:[0,1,0]
    v_fma_mix_f32 v23, v87, v23, 0 op_sel_hi:[0,1,0]
    v_cvt_pk_bf16_f32 v26, v19, v20
    v_cvt_pk_bf16_f32 v27, v22, v23
    v_cvt_pk_f16_f32 v18, v88, v89
    v_mfma_f32_32x32x16_bf16 v[96:111], v[68:71], v[140:143], v[96:111]
    ds_read_b64_tr_b16 v[68:69], v9 offset:3072
    ds_read_b64_tr_b16 v[70:71], v9 offset:3328
    v_cvt_pk_f16_f32 v21, v90, v91
    v_pk_fma_f16 v19, v18, v18, s49
    v_pk_fma_f16 v22, v21, v21, s49
    v_pk_mul_f16 v18, v18, v19
    v_pk_mul_f16 v21, v21, v22
    v_exp_f16 v19, v18
    v_exp_f16 v22, v21
    v_exp_f16_sdwa v19, v18 dst_sel:WORD_1 dst_unused:UNUSED_PRESERVE src0_sel:WORD_1
    v_mfma_f32_32x32x16_bf16 v[160:175], v[32:35], v[24:27], v[160:175]
    v_exp_f16_sdwa v22, v21 dst_sel:WORD_1 dst_unused:UNUSED_PRESERVE src0_sel:WORD_1
    v_pk_fma_f16 v18, v19, s50, s50
    v_pk_fma_f16 v21, v22, s50, s50
    v_rcp_f16 v19, v18
    v_rcp_f16 v22, v21
    v_rcp_f16_sdwa v20, v18 dst_sel:DWORD dst_unused:UNUSED_PAD src0_sel:WORD_1
    v_mfma_f32_32x32x16_bf16 v[96:111], v[72:75], v[148:151], v[96:111]
    ds_read_b64_tr_b16 v[72:73], v9 offset:4096
    ds_read_b64_tr_b16 v[74:75], v9 offset:4352
    v_rcp_f16_sdwa v23, v21 dst_sel:DWORD dst_unused:UNUSED_PAD src0_sel:WORD_1
    v_fma_mix_f32 v19, v88, v19, 0 op_sel_hi:[0,1,0]
    v_fma_mix_f32 v22, v90, v22, 0 op_sel_hi:[0,1,0]
    v_fma_mix_f32 v20, v89, v20, 0 op_sel_hi:[0,1,0]
    v_fma_mix_f32 v23, v91, v23, 0 op_sel_hi:[0,1,0]
    v_cvt_pk_bf16_f32 v28, v19, v20
    v_cvt_pk_bf16_f32 v29, v22, v23
    v_cvt_pk_f16_f32 v18, v92, v93
    s_waitcnt lgkmcnt(5)
    s_nop 0
    v_mfma_f32_32x32x16_bf16 v[176:191], v[36:39], v[24:27], v[176:191]
    v_cvt_pk_f16_f32 v21, v94, v95
    v_pk_fma_f16 v19, v18, v18, s49
    v_pk_fma_f16 v22, v21, v21, s49
    v_pk_mul_f16 v18, v18, v19
    v_pk_mul_f16 v21, v21, v22
    v_exp_f16 v19, v18
    v_exp_f16 v22, v21
    v_exp_f16_sdwa v19, v18 dst_sel:WORD_1 dst_unused:UNUSED_PRESERVE src0_sel:WORD_1
    v_mfma_f32_32x32x16_bf16 v[96:111], v[76:79], v[156:159], v[96:111]
    ds_read_b64_tr_b16 v[76:77], v9 offset:5120
    ds_read_b64_tr_b16 v[78:79], v9 offset:5376
    v_exp_f16_sdwa v22, v21 dst_sel:WORD_1 dst_unused:UNUSED_PRESERVE src0_sel:WORD_1
    v_pk_fma_f16 v18, v19, s50, s50
    v_pk_fma_f16 v21, v22, s50, s50
    v_rcp_f16 v19, v18
    v_rcp_f16 v22, v21
    v_rcp_f16_sdwa v20, v18 dst_sel:DWORD dst_unused:UNUSED_PAD src0_sel:WORD_1
    v_mfma_f32_32x32x16_bf16 v[192:207], v[40:43], v[24:27], v[192:207]
    v_rcp_f16_sdwa v23, v21 dst_sel:DWORD dst_unused:UNUSED_PAD src0_sel:WORD_1
    v_fma_mix_f32 v19, v92, v19, 0 op_sel_hi:[0,1,0]
    v_fma_mix_f32 v22, v94, v22, 0 op_sel_hi:[0,1,0]
    v_fma_mix_f32 v20, v93, v20, 0 op_sel_hi:[0,1,0]
    v_fma_mix_f32 v23, v95, v23, 0 op_sel_hi:[0,1,0]
    v_cvt_pk_bf16_f32 v30, v19, v20
    v_cvt_pk_bf16_f32 v31, v22, v23
    s_setprio 2
    s_nop 0
    v_cvt_pk_f16_f32 v18, v96, v97
    v_cvt_pk_f16_f32 v21, v98, v99
    v_mfma_f32_32x32x16_bf16 v[160:175], v[44:47], v[28:31], v[160:175]
    v_pk_fma_f16 v19, v18, v18, s49
    v_pk_fma_f16 v22, v21, v21, s49
    v_pk_mul_f16 v18, v18, v19
    v_pk_mul_f16 v21, v21, v22
    v_exp_f16 v19, v18
    v_exp_f16 v22, v21
    v_exp_f16_sdwa v19, v18 dst_sel:WORD_1 dst_unused:UNUSED_PRESERVE src0_sel:WORD_1
    v_mfma_f32_32x32x16_bf16 v[80:95], v[56:59], v[112:115], 0
    v_exp_f16_sdwa v22, v21 dst_sel:WORD_1 dst_unused:UNUSED_PRESERVE src0_sel:WORD_1
    v_pk_fma_f16 v18, v19, s50, s50
    v_pk_fma_f16 v21, v22, s50, s50
    v_rcp_f16 v19, v18
    v_rcp_f16 v22, v21
    v_rcp_f16_sdwa v20, v18 dst_sel:DWORD dst_unused:UNUSED_PAD src0_sel:WORD_1
    v_mfma_f32_32x32x16_bf16 v[176:191], v[48:51], v[28:31], v[176:191]
    v_rcp_f16_sdwa v23, v21 dst_sel:DWORD dst_unused:UNUSED_PAD src0_sel:WORD_1
    v_fma_mix_f32 v19, v96, v19, 0 op_sel_hi:[0,1,0]
    v_fma_mix_f32 v22, v98, v22, 0 op_sel_hi:[0,1,0]
    v_fma_mix_f32 v20, v97, v20, 0 op_sel_hi:[0,1,0]
    v_fma_mix_f32 v23, v99, v23, 0 op_sel_hi:[0,1,0]
    v_cvt_pk_bf16_f32 v24, v19, v20
    v_cvt_pk_bf16_f32 v25, v22, v23
    v_cvt_pk_f16_f32 v18, v100, v101
    v_cvt_pk_f16_f32 v21, v102, v103
    v_mfma_f32_32x32x16_bf16 v[80:95], v[60:63], v[120:123], v[80:95]
    v_pk_fma_f16 v19, v18, v18, s49
    v_pk_fma_f16 v22, v21, v21, s49
    v_pk_mul_f16 v18, v18, v19
    v_pk_mul_f16 v21, v21, v22
    v_exp_f16 v19, v18
    v_exp_f16 v22, v21
    v_exp_f16_sdwa v19, v18 dst_sel:WORD_1 dst_unused:UNUSED_PRESERVE src0_sel:WORD_1
    v_mfma_f32_32x32x16_bf16 v[192:207], v[52:55], v[28:31], v[192:207]
    v_exp_f16_sdwa v22, v21 dst_sel:WORD_1 dst_unused:UNUSED_PRESERVE src0_sel:WORD_1
    v_pk_fma_f16 v18, v19, s50, s50
    v_pk_fma_f16 v21, v22, s50, s50
    v_rcp_f16 v19, v18
    v_rcp_f16 v22, v21
    v_rcp_f16_sdwa v20, v18 dst_sel:DWORD dst_unused:UNUSED_PAD src0_sel:WORD_1
    s_waitcnt lgkmcnt(0)
    s_nop 0
    v_mfma_f32_32x32x16_bf16 v[80:95], v[64:67], v[128:131], v[80:95]
    v_rcp_f16_sdwa v23, v21 dst_sel:DWORD dst_unused:UNUSED_PAD src0_sel:WORD_1
    v_fma_mix_f32 v19, v100, v19, 0 op_sel_hi:[0,1,0]
    v_fma_mix_f32 v22, v102, v22, 0 op_sel_hi:[0,1,0]
    v_fma_mix_f32 v20, v101, v20, 0 op_sel_hi:[0,1,0]
    v_fma_mix_f32 v23, v103, v23, 0 op_sel_hi:[0,1,0]
    v_cvt_pk_bf16_f32 v26, v19, v20
    v_cvt_pk_bf16_f32 v27, v22, v23
    v_cvt_pk_f16_f32 v18, v104, v105
    v_mfma_f32_32x32x16_bf16 v[80:95], v[68:71], v[136:139], v[80:95]
    v_cvt_pk_f16_f32 v21, v106, v107
    v_pk_fma_f16 v19, v18, v18, s49
    v_pk_fma_f16 v22, v21, v21, s49
    v_pk_mul_f16 v18, v18, v19
    v_pk_mul_f16 v21, v21, v22
    v_exp_f16 v19, v18
    v_exp_f16 v22, v21
    v_exp_f16_sdwa v19, v18 dst_sel:WORD_1 dst_unused:UNUSED_PRESERVE src0_sel:WORD_1
    v_mfma_f32_32x32x16_bf16 v[208:223], v[32:35], v[24:27], v[208:223]
    v_exp_f16_sdwa v22, v21 dst_sel:WORD_1 dst_unused:UNUSED_PRESERVE src0_sel:WORD_1
    v_pk_fma_f16 v18, v19, s50, s50
    v_pk_fma_f16 v21, v22, s50, s50
    v_rcp_f16 v19, v18
    v_rcp_f16 v22, v21
    v_rcp_f16_sdwa v20, v18 dst_sel:DWORD dst_unused:UNUSED_PAD src0_sel:WORD_1
    v_mfma_f32_32x32x16_bf16 v[80:95], v[72:75], v[144:147], v[80:95]
    v_rcp_f16_sdwa v23, v21 dst_sel:DWORD dst_unused:UNUSED_PAD src0_sel:WORD_1
    v_fma_mix_f32 v19, v104, v19, 0 op_sel_hi:[0,1,0]
    v_fma_mix_f32 v22, v106, v22, 0 op_sel_hi:[0,1,0]
    v_fma_mix_f32 v20, v105, v20, 0 op_sel_hi:[0,1,0]
    v_fma_mix_f32 v23, v107, v23, 0 op_sel_hi:[0,1,0]
    v_cvt_pk_bf16_f32 v28, v19, v20
    v_cvt_pk_bf16_f32 v29, v22, v23
    v_cvt_pk_f16_f32 v18, v108, v109
    v_mfma_f32_32x32x16_bf16 v[224:239], v[36:39], v[24:27], v[224:239]
    v_cvt_pk_f16_f32 v21, v110, v111
    v_pk_fma_f16 v19, v18, v18, s49
    v_pk_fma_f16 v22, v21, v21, s49
    v_pk_mul_f16 v18, v18, v19
    v_pk_mul_f16 v21, v21, v22
    v_exp_f16 v19, v18
    v_exp_f16 v22, v21
    v_exp_f16_sdwa v19, v18 dst_sel:WORD_1 dst_unused:UNUSED_PRESERVE src0_sel:WORD_1
    v_mfma_f32_32x32x16_bf16 v[80:95], v[76:79], v[152:155], v[80:95]
    v_exp_f16_sdwa v22, v21 dst_sel:WORD_1 dst_unused:UNUSED_PRESERVE src0_sel:WORD_1
    v_pk_fma_f16 v18, v19, s50, s50
    v_pk_fma_f16 v21, v22, s50, s50
    v_rcp_f16 v19, v18
    v_rcp_f16 v22, v21
    v_rcp_f16_sdwa v20, v18 dst_sel:DWORD dst_unused:UNUSED_PAD src0_sel:WORD_1
    v_mfma_f32_32x32x16_bf16 v[240:255], v[40:43], v[24:27], v[240:255]
    v_rcp_f16_sdwa v23, v21 dst_sel:DWORD dst_unused:UNUSED_PAD src0_sel:WORD_1
    v_fma_mix_f32 v19, v108, v19, 0 op_sel_hi:[0,1,0]
    v_fma_mix_f32 v22, v110, v22, 0 op_sel_hi:[0,1,0]
    v_fma_mix_f32 v20, v109, v20, 0 op_sel_hi:[0,1,0]
    v_fma_mix_f32 v23, v111, v23, 0 op_sel_hi:[0,1,0]
    v_cvt_pk_bf16_f32 v30, v19, v20
    v_cvt_pk_bf16_f32 v31, v22, v23
    s_setprio 1
    s_nop 0
    v_cvt_pk_f16_f32 v18, v80, v81
    v_cvt_pk_f16_f32 v21, v82, v83
    v_mfma_f32_32x32x16_bf16 v[208:223], v[44:47], v[28:31], v[208:223]
    ds_read_b64_tr_b16 v[44:45], v10 offset:21504
    ds_read_b64_tr_b16 v[46:47], v10 offset:23040
    v_pk_fma_f16 v19, v18, v18, s49
    v_pk_fma_f16 v22, v21, v21, s49
    v_pk_mul_f16 v18, v18, v19
    v_pk_mul_f16 v21, v21, v22
    v_exp_f16 v19, v18
    v_exp_f16 v22, v21
    v_exp_f16_sdwa v19, v18 dst_sel:WORD_1 dst_unused:UNUSED_PRESERVE src0_sel:WORD_1
    v_mfma_f32_32x32x16_bf16 v[96:111], v[56:59], v[116:119], 0
    ds_read_b64_tr_b16 v[32:33], v10 offset:18432
    ds_read_b64_tr_b16 v[34:35], v10 offset:19968
    ds_read_b64_tr_b16 v[56:57], v9 offset:12288
    ds_read_b64_tr_b16 v[58:59], v9 offset:12544
    v_exp_f16_sdwa v22, v21 dst_sel:WORD_1 dst_unused:UNUSED_PRESERVE src0_sel:WORD_1
    v_pk_fma_f16 v18, v19, s50, s50
    v_pk_fma_f16 v21, v22, s50, s50
    v_rcp_f16 v19, v18
    v_rcp_f16 v22, v21
    v_rcp_f16_sdwa v20, v18 dst_sel:DWORD dst_unused:UNUSED_PAD src0_sel:WORD_1
    v_mfma_f32_32x32x16_bf16 v[224:239], v[48:51], v[28:31], v[224:239]
    ds_read_b64_tr_b16 v[36:37], v10 offset:18496
    ds_read_b64_tr_b16 v[38:39], v10 offset:20032
    ds_read_b64_tr_b16 v[48:49], v10 offset:21568
    ds_read_b64_tr_b16 v[50:51], v10 offset:23104
    v_rcp_f16_sdwa v23, v21 dst_sel:DWORD dst_unused:UNUSED_PAD src0_sel:WORD_1
    v_fma_mix_f32 v19, v80, v19, 0 op_sel_hi:[0,1,0]
    v_fma_mix_f32 v22, v82, v22, 0 op_sel_hi:[0,1,0]
    v_fma_mix_f32 v20, v81, v20, 0 op_sel_hi:[0,1,0]
    v_fma_mix_f32 v23, v83, v23, 0 op_sel_hi:[0,1,0]
    v_cvt_pk_bf16_f32 v24, v19, v20
    v_cvt_pk_bf16_f32 v25, v22, v23
    v_cvt_pk_f16_f32 v18, v84, v85
    v_cvt_pk_f16_f32 v21, v86, v87
    v_mfma_f32_32x32x16_bf16 v[96:111], v[60:63], v[124:127], v[96:111]
    ds_read_b64_tr_b16 v[40:41], v10 offset:18560
    ds_read_b64_tr_b16 v[42:43], v10 offset:20096
    ds_read_b64_tr_b16 v[60:61], v9 offset:13312
    ds_read_b64_tr_b16 v[62:63], v9 offset:13568
    v_pk_fma_f16 v19, v18, v18, s49
    v_pk_fma_f16 v22, v21, v21, s49
    v_pk_mul_f16 v18, v18, v19
    v_pk_mul_f16 v21, v21, v22
    v_exp_f16 v19, v18
    v_exp_f16 v22, v21
    v_exp_f16_sdwa v19, v18 dst_sel:WORD_1 dst_unused:UNUSED_PRESERVE src0_sel:WORD_1
    v_mfma_f32_32x32x16_bf16 v[240:255], v[52:55], v[28:31], v[240:255]
    ds_read_b64_tr_b16 v[52:53], v10 offset:21632
    s_waitcnt lgkmcnt(8)
    s_nop 0
    ds_read_b64_tr_b16 v[54:55], v10 offset:23168
    v_exp_f16_sdwa v22, v21 dst_sel:WORD_1 dst_unused:UNUSED_PRESERVE src0_sel:WORD_1
    v_pk_fma_f16 v18, v19, s50, s50
    v_pk_fma_f16 v21, v22, s50, s50
    v_rcp_f16 v19, v18
    v_rcp_f16 v22, v21
    v_rcp_f16_sdwa v20, v18 dst_sel:DWORD dst_unused:UNUSED_PAD src0_sel:WORD_1
    v_mfma_f32_32x32x16_bf16 v[96:111], v[64:67], v[132:135], v[96:111]
    ds_read_b64_tr_b16 v[64:65], v9 offset:14336
    ds_read_b64_tr_b16 v[66:67], v9 offset:14592
    v_rcp_f16_sdwa v23, v21 dst_sel:DWORD dst_unused:UNUSED_PAD src0_sel:WORD_1
    v_fma_mix_f32 v19, v84, v19, 0 op_sel_hi:[0,1,0]
    v_fma_mix_f32 v22, v86, v22, 0 op_sel_hi:[0,1,0]
    v_fma_mix_f32 v20, v85, v20, 0 op_sel_hi:[0,1,0]
    v_fma_mix_f32 v23, v87, v23, 0 op_sel_hi:[0,1,0]
    v_cvt_pk_bf16_f32 v26, v19, v20
    v_cvt_pk_bf16_f32 v27, v22, v23
    v_cvt_pk_f16_f32 v18, v88, v89
    v_mfma_f32_32x32x16_bf16 v[96:111], v[68:71], v[140:143], v[96:111]
    ds_read_b64_tr_b16 v[68:69], v9 offset:15360
    ds_read_b64_tr_b16 v[70:71], v9 offset:15616
    v_cvt_pk_f16_f32 v21, v90, v91
    v_pk_fma_f16 v19, v18, v18, s49
    v_pk_fma_f16 v22, v21, v21, s49
    v_pk_mul_f16 v18, v18, v19
    v_pk_mul_f16 v21, v21, v22
    v_exp_f16 v19, v18
    v_exp_f16 v22, v21
    v_exp_f16_sdwa v19, v18 dst_sel:WORD_1 dst_unused:UNUSED_PRESERVE src0_sel:WORD_1
    v_mfma_f32_32x32x16_bf16 v[160:175], v[32:35], v[24:27], v[160:175]
    v_exp_f16_sdwa v22, v21 dst_sel:WORD_1 dst_unused:UNUSED_PRESERVE src0_sel:WORD_1
    v_pk_fma_f16 v18, v19, s50, s50
    v_pk_fma_f16 v21, v22, s50, s50
    v_rcp_f16 v19, v18
    v_rcp_f16 v22, v21
    v_rcp_f16_sdwa v20, v18 dst_sel:DWORD dst_unused:UNUSED_PAD src0_sel:WORD_1
    v_mfma_f32_32x32x16_bf16 v[96:111], v[72:75], v[148:151], v[96:111]
    ds_read_b64_tr_b16 v[72:73], v9 offset:16384
    ds_read_b64_tr_b16 v[74:75], v9 offset:16640
    v_rcp_f16_sdwa v23, v21 dst_sel:DWORD dst_unused:UNUSED_PAD src0_sel:WORD_1
    v_fma_mix_f32 v19, v88, v19, 0 op_sel_hi:[0,1,0]
    v_fma_mix_f32 v22, v90, v22, 0 op_sel_hi:[0,1,0]
    v_fma_mix_f32 v20, v89, v20, 0 op_sel_hi:[0,1,0]
    v_fma_mix_f32 v23, v91, v23, 0 op_sel_hi:[0,1,0]
    v_cvt_pk_bf16_f32 v28, v19, v20
    v_cvt_pk_bf16_f32 v29, v22, v23
    v_cvt_pk_f16_f32 v18, v92, v93
    s_waitcnt lgkmcnt(5)
    s_nop 0
    v_mfma_f32_32x32x16_bf16 v[176:191], v[36:39], v[24:27], v[176:191]
    v_cvt_pk_f16_f32 v21, v94, v95
    v_pk_fma_f16 v19, v18, v18, s49
    v_pk_fma_f16 v22, v21, v21, s49
    v_pk_mul_f16 v18, v18, v19
    v_pk_mul_f16 v21, v21, v22
    v_exp_f16 v19, v18
    v_exp_f16 v22, v21
    v_exp_f16_sdwa v19, v18 dst_sel:WORD_1 dst_unused:UNUSED_PRESERVE src0_sel:WORD_1
    v_mfma_f32_32x32x16_bf16 v[96:111], v[76:79], v[156:159], v[96:111]
    ds_read_b64_tr_b16 v[76:77], v9 offset:17408
    ds_read_b64_tr_b16 v[78:79], v9 offset:17664
    v_exp_f16_sdwa v22, v21 dst_sel:WORD_1 dst_unused:UNUSED_PRESERVE src0_sel:WORD_1
    v_pk_fma_f16 v18, v19, s50, s50
    v_pk_fma_f16 v21, v22, s50, s50
    v_rcp_f16 v19, v18
    v_rcp_f16 v22, v21
    v_rcp_f16_sdwa v20, v18 dst_sel:DWORD dst_unused:UNUSED_PAD src0_sel:WORD_1
    v_mfma_f32_32x32x16_bf16 v[192:207], v[40:43], v[24:27], v[192:207]
    v_rcp_f16_sdwa v23, v21 dst_sel:DWORD dst_unused:UNUSED_PAD src0_sel:WORD_1
    v_fma_mix_f32 v19, v92, v19, 0 op_sel_hi:[0,1,0]
    v_fma_mix_f32 v22, v94, v22, 0 op_sel_hi:[0,1,0]
    v_fma_mix_f32 v20, v93, v20, 0 op_sel_hi:[0,1,0]
    v_fma_mix_f32 v23, v95, v23, 0 op_sel_hi:[0,1,0]
    v_cvt_pk_bf16_f32 v30, v19, v20
    v_cvt_pk_bf16_f32 v31, v22, v23
    s_setprio 0
    s_nop 0
    v_cvt_pk_f16_f32 v18, v96, v97
    v_cvt_pk_f16_f32 v21, v98, v99
    v_mfma_f32_32x32x16_bf16 v[160:175], v[44:47], v[28:31], v[160:175]
    v_pk_fma_f16 v19, v18, v18, s49
    v_pk_fma_f16 v22, v21, v21, s49
    v_pk_mul_f16 v18, v18, v19
    v_pk_mul_f16 v21, v21, v22
    v_exp_f16 v19, v18
    v_exp_f16 v22, v21
    v_exp_f16_sdwa v19, v18 dst_sel:WORD_1 dst_unused:UNUSED_PRESERVE src0_sel:WORD_1
    v_mfma_f32_32x32x16_bf16 v[80:95], v[56:59], v[112:115], 0
    v_exp_f16_sdwa v22, v21 dst_sel:WORD_1 dst_unused:UNUSED_PRESERVE src0_sel:WORD_1
    v_pk_fma_f16 v18, v19, s50, s50
    v_pk_fma_f16 v21, v22, s50, s50
    v_rcp_f16 v19, v18
    v_rcp_f16 v22, v21
    v_rcp_f16_sdwa v20, v18 dst_sel:DWORD dst_unused:UNUSED_PAD src0_sel:WORD_1
    v_mfma_f32_32x32x16_bf16 v[176:191], v[48:51], v[28:31], v[176:191]
    v_rcp_f16_sdwa v23, v21 dst_sel:DWORD dst_unused:UNUSED_PAD src0_sel:WORD_1
    v_fma_mix_f32 v19, v96, v19, 0 op_sel_hi:[0,1,0]
    v_fma_mix_f32 v22, v98, v22, 0 op_sel_hi:[0,1,0]
    v_fma_mix_f32 v20, v97, v20, 0 op_sel_hi:[0,1,0]
    v_fma_mix_f32 v23, v99, v23, 0 op_sel_hi:[0,1,0]
    v_cvt_pk_bf16_f32 v24, v19, v20
    v_cvt_pk_bf16_f32 v25, v22, v23
    v_cvt_pk_f16_f32 v18, v100, v101
    v_cvt_pk_f16_f32 v21, v102, v103
    v_mfma_f32_32x32x16_bf16 v[80:95], v[60:63], v[120:123], v[80:95]
    v_pk_fma_f16 v19, v18, v18, s49
    v_pk_fma_f16 v22, v21, v21, s49
    v_pk_mul_f16 v18, v18, v19
    v_pk_mul_f16 v21, v21, v22
    v_exp_f16 v19, v18
    v_exp_f16 v22, v21
    v_exp_f16_sdwa v19, v18 dst_sel:WORD_1 dst_unused:UNUSED_PRESERVE src0_sel:WORD_1
    v_mfma_f32_32x32x16_bf16 v[192:207], v[52:55], v[28:31], v[192:207]
    v_exp_f16_sdwa v22, v21 dst_sel:WORD_1 dst_unused:UNUSED_PRESERVE src0_sel:WORD_1
    v_pk_fma_f16 v18, v19, s50, s50
    v_pk_fma_f16 v21, v22, s50, s50
    v_rcp_f16 v19, v18
    v_rcp_f16 v22, v21
    v_rcp_f16_sdwa v20, v18 dst_sel:DWORD dst_unused:UNUSED_PAD src0_sel:WORD_1
    s_waitcnt lgkmcnt(0)
    s_nop 0
    v_mfma_f32_32x32x16_bf16 v[80:95], v[64:67], v[128:131], v[80:95]
    v_rcp_f16_sdwa v23, v21 dst_sel:DWORD dst_unused:UNUSED_PAD src0_sel:WORD_1
    v_fma_mix_f32 v19, v100, v19, 0 op_sel_hi:[0,1,0]
    v_fma_mix_f32 v22, v102, v22, 0 op_sel_hi:[0,1,0]
    v_fma_mix_f32 v20, v101, v20, 0 op_sel_hi:[0,1,0]
    v_fma_mix_f32 v23, v103, v23, 0 op_sel_hi:[0,1,0]
    v_cvt_pk_bf16_f32 v26, v19, v20
    v_cvt_pk_bf16_f32 v27, v22, v23
    v_cvt_pk_f16_f32 v18, v104, v105
    v_mfma_f32_32x32x16_bf16 v[80:95], v[68:71], v[136:139], v[80:95]
    v_cvt_pk_f16_f32 v21, v106, v107
    v_pk_fma_f16 v19, v18, v18, s49
    v_pk_fma_f16 v22, v21, v21, s49
    v_pk_mul_f16 v18, v18, v19
    v_pk_mul_f16 v21, v21, v22
    v_exp_f16 v19, v18
    v_exp_f16 v22, v21
    v_exp_f16_sdwa v19, v18 dst_sel:WORD_1 dst_unused:UNUSED_PRESERVE src0_sel:WORD_1
    v_mfma_f32_32x32x16_bf16 v[208:223], v[32:35], v[24:27], v[208:223]
    v_exp_f16_sdwa v22, v21 dst_sel:WORD_1 dst_unused:UNUSED_PRESERVE src0_sel:WORD_1
    v_pk_fma_f16 v18, v19, s50, s50
    v_pk_fma_f16 v21, v22, s50, s50
    v_rcp_f16 v19, v18
    v_rcp_f16 v22, v21
    v_rcp_f16_sdwa v20, v18 dst_sel:DWORD dst_unused:UNUSED_PAD src0_sel:WORD_1
    v_mfma_f32_32x32x16_bf16 v[80:95], v[72:75], v[144:147], v[80:95]
    v_rcp_f16_sdwa v23, v21 dst_sel:DWORD dst_unused:UNUSED_PAD src0_sel:WORD_1
    v_fma_mix_f32 v19, v104, v19, 0 op_sel_hi:[0,1,0]
    v_fma_mix_f32 v22, v106, v22, 0 op_sel_hi:[0,1,0]
    v_fma_mix_f32 v20, v105, v20, 0 op_sel_hi:[0,1,0]
    v_fma_mix_f32 v23, v107, v23, 0 op_sel_hi:[0,1,0]
    v_cvt_pk_bf16_f32 v28, v19, v20
    v_cvt_pk_bf16_f32 v29, v22, v23
    v_cvt_pk_f16_f32 v18, v108, v109
    v_mfma_f32_32x32x16_bf16 v[224:239], v[36:39], v[24:27], v[224:239]
    v_cvt_pk_f16_f32 v21, v110, v111
    v_pk_fma_f16 v19, v18, v18, s49
    v_pk_fma_f16 v22, v21, v21, s49
    v_pk_mul_f16 v18, v18, v19
    v_pk_mul_f16 v21, v21, v22
    v_exp_f16 v19, v18
    v_exp_f16 v22, v21
    v_exp_f16_sdwa v19, v18 dst_sel:WORD_1 dst_unused:UNUSED_PRESERVE src0_sel:WORD_1
    v_mfma_f32_32x32x16_bf16 v[80:95], v[76:79], v[152:155], v[80:95]
    v_exp_f16_sdwa v22, v21 dst_sel:WORD_1 dst_unused:UNUSED_PRESERVE src0_sel:WORD_1
    v_pk_fma_f16 v18, v19, s50, s50
    v_pk_fma_f16 v21, v22, s50, s50
    v_rcp_f16 v19, v18
    v_rcp_f16 v22, v21
    v_rcp_f16_sdwa v20, v18 dst_sel:DWORD dst_unused:UNUSED_PAD src0_sel:WORD_1
    v_mfma_f32_32x32x16_bf16 v[240:255], v[40:43], v[24:27], v[240:255]
    v_rcp_f16_sdwa v23, v21 dst_sel:DWORD dst_unused:UNUSED_PAD src0_sel:WORD_1
    v_fma_mix_f32 v19, v108, v19, 0 op_sel_hi:[0,1,0]
    v_fma_mix_f32 v22, v110, v22, 0 op_sel_hi:[0,1,0]
    v_fma_mix_f32 v20, v109, v20, 0 op_sel_hi:[0,1,0]
    v_fma_mix_f32 v23, v111, v23, 0 op_sel_hi:[0,1,0]
    v_cvt_pk_bf16_f32 v30, v19, v20
    v_cvt_pk_bf16_f32 v31, v22, v23
    s_sub_u32 s48, s48, 1
    s_cmp_lg_u32 s48, 0
    s_cbranch_scc1 LloopNR
    s_cmp_lg_u32 s65, 0
    s_mov_b32 s65, 0
    s_mov_b32 s48, 2
    s_cbranch_scc1 LloopAR
    s_add_u32 s63, s63, 4
    s_cmp_ge_u32 s63, 12
    s_cselect_b32 s63, 0, s63
    s_add_u32 s47, s47, 1
    s_cmp_eq_u32 s47, 1
    s_cbranch_scc1 LouterR
    s_waitcnt vmcnt(0)
    s_barrier
    s_nop 0
    s_sub_u32 s41, 82816, s41
Lbody3R:
    v_add_u32 v9, s41, v7
    v_add_u32 v10, s41, v8
    s_sub_u32 s71, 82816, s41
    v_add_u32_e64 v15, s71, v7
    ds_read_b64_tr_b16 v[56:57], v9 offset:0
    ds_read_b64_tr_b16 v[58:59], v9 offset:256
    ds_read_b64_tr_b16 v[60:61], v9 offset:1024
    ds_read_b64_tr_b16 v[62:63], v9 offset:1280
    ds_read_b64_tr_b16 v[64:65], v9 offset:2048
    ds_read_b64_tr_b16 v[66:67], v9 offset:2304
    v_cvt_pk_f16_f32 v18, v80, v81
    v_cvt_pk_f16_f32 v21, v82, v83
    v_mfma_f32_32x32x16_bf16 v[208:223], v[44:47], v[28:31], v[208:223]
    ds_read_b64_tr_b16 v[44:45], v10 offset:9216
    ds_read_b64_tr_b16 v[46:47], v10 offset:10752
    ds_read_b64_tr_b16 v[68:69], v9 offset:3072
    ds_read_b64_tr_b16 v[70:71], v9 offset:3328
    v_pk_fma_f16 v19, v18, v18, s49
    v_pk_fma_f16 v22, v21, v21, s49
    v_pk_mul_f16 v18, v18, v19
    v_pk_mul_f16 v21, v21, v22
    v_exp_f16 v19, v18
    v_exp_f16 v22, v21
    v_exp_f16_sdwa v19, v18 dst_sel:WORD_1 dst_unused:UNUSED_PRESERVE src0_sel:WORD_1
    v_mfma_f32_32x32x16_bf16 v[224:239], v[48:51], v[28:31], v[224:239]
    ds_read_b64_tr_b16 v[48:49], v10 offset:9280
    ds_read_b64_tr_b16 v[50:51], v10 offset:10816
    ds_read_b64_tr_b16 v[72:73], v9 offset:4096
    ds_read_b64_tr_b16 v[74:75], v9 offset:4352
    ds_read_b64_tr_b16 v[32:33], v10 offset:6144
    s_waitcnt lgkmcnt(8)
    s_nop 0
    ds_read_b64_tr_b16 v[34:35], v10 offset:7680
    v_exp_f16_sdwa v22, v21 dst_sel:WORD_1 dst_unused:UNUSED_PRESERVE src0_sel:WORD_1
    v_pk_fma_f16 v18, v19, s50, s50
    v_pk_fma_f16 v21, v22, s50, s50
    v_rcp_f16 v19, v18
    v_rcp_f16 v22, v21
    v_rcp_f16_sdwa v20, v18 dst_sel:DWORD dst_unused:UNUSED_PAD src0_sel:WORD_1
    v_mfma_f32_32x32x16_bf16 v[240:255], v[52:55], v[28:31], v[240:255]
    ds_read_b64_tr_b16 v[52:53], v10 offset:9344
    ds_read_b64_tr_b16 v[54:55], v10 offset:10880
    ds_read_b64_tr_b16 v[76:77], v9 offset:5120
    ds_read_b64_tr_b16 v[78:79], v9 offset:5376
    ds_read_b64_tr_b16 v[36:37], v10 offset:6208
    ds_read_b64_tr_b16 v[38:39], v10 offset:7744
    v_rcp_f16_sdwa v23, v21 dst_sel:DWORD dst_unused:UNUSED_PAD src0_sel:WORD_1
    v_fma_mix_f32 v19, v80, v19, 0 op_sel_hi:[0,1,0]
    v_fma_mix_f32 v22, v82, v22, 0 op_sel_hi:[0,1,0]
    v_fma_mix_f32 v20, v81, v20, 0 op_sel_hi:[0,1,0]
    v_fma_mix_f32 v23, v83, v23, 0 op_sel_hi:[0,1,0]
    v_cvt_pk_bf16_f32 v24, v19, v20
    v_cvt_pk_bf16_f32 v25, v22, v23
    v_cvt_pk_f16_f32 v18, v84, v85
    v_cvt_pk_f16_f32 v21, v86, v87
    v_mfma_f32_32x32x16_bf16 v[96:111], v[56:59], v[112:115], 0
    s_waitcnt lgkmcnt(8)
    s_nop 0
    ds_read_b64_tr_b16 v[56:57], v15 offset:12288
    ds_read_b64_tr_b16 v[58:59], v15 offset:12544
    ds_read_b64_tr_b16 v[40:41], v10 offset:6272
    ds_read_b64_tr_b16 v[42:43], v10 offset:7808
    v_pk_fma_f16 v19, v18, v18, s49
    v_pk_fma_f16 v22, v21, v21, s49
    v_pk_mul_f16 v18, v18, v19
    v_pk_mul_f16 v21, v21, v22
    v_exp_f16 v19, v18
    v_exp_f16 v22, v21
    v_exp_f16_sdwa v19, v18 dst_sel:WORD_1 dst_unused:UNUSED_PRESERVE src0_sel:WORD_1
    v_mfma_f32_32x32x16_bf16 v[96:111], v[60:63], v[120:123], v[96:111]
    ds_read_b64_tr_b16 v[60:61], v15 offset:13312
    ds_read_b64_tr_b16 v[62:63], v15 offset:13568
    v_exp_f16_sdwa v22, v21 dst_sel:WORD_1 dst_unused:UNUSED_PRESERVE src0_sel:WORD_1
    v_pk_fma_f16 v18, v19, s50, s50
    v_pk_fma_f16 v21, v22, s50, s50
    v_rcp_f16 v19, v18
    v_rcp_f16 v22, v21
    v_rcp_f16_sdwa v20, v18 dst_sel:DWORD dst_unused:UNUSED_PAD src0_sel:WORD_1
    v_mfma_f32_32x32x16_bf16 v[96:111], v[64:67], v[128:131], v[96:111]
    ds_read_b64_tr_b16 v[64:65], v15 offset:14336
    s_waitcnt lgkmcnt(8)
    s_nop 0
    ds_read_b64_tr_b16 v[66:67], v15 offset:14592
    v_rcp_f16_sdwa v23, v21 dst_sel:DWORD dst_unused:UNUSED_PAD src0_sel:WORD_1
    v_fma_mix_f32 v19, v84, v19, 0 op_sel_hi:[0,1,0]
    v_fma_mix_f32 v22, v86, v22, 0 op_sel_hi:[0,1,0]
    v_fma_mix_f32 v20, v85, v20, 0 op_sel_hi:[0,1,0]
    v_fma_mix_f32 v23, v87, v23, 0 op_sel_hi:[0,1,0]
    v_cvt_pk_bf16_f32 v26, v19, v20
    v_cvt_pk_bf16_f32 v27, v22, v23
    v_cvt_pk_f16_f32 v18, v88, v89
    v_mfma_f32_32x32x16_bf16 v[96:111], v[68:71], v[136:139], v[96:111]
    ds_read_b64_tr_b16 v[68:69], v15 offset:15360
    ds_read_b64_tr_b16 v[70:71], v15 offset:15616
    v_cvt_pk_f16_f32 v21, v90, v91
    v_pk_fma_f16 v19, v18, v18, s49
    v_pk_fma_f16 v22, v21, v21, s49
    v_pk_mul_f16 v18, v18, v19
    v_pk_mul_f16 v21, v21, v22
    v_exp_f16 v19, v18
    v_exp_f16 v22, v21
    v_exp_f16_sdwa v19, v18 dst_sel:WORD_1 dst_unused:UNUSED_PRESERVE src0_sel:WORD_1
    v_mfma_f32_32x32x16_bf16 v[160:175], v[32:35], v[24:27], v[160:175]
    ds_read_b64_tr_b16 v[32:33], v10 offset:18432
    ds_read_b64_tr_b16 v[34:35], v10 offset:19968
    v_exp_f16_sdwa v22, v21 dst_sel:WORD_1 dst_unused:UNUSED_PRESERVE src0_sel:WORD_1
    v_pk_fma_f16 v18, v19, s50, s50
    v_pk_fma_f16 v21, v22, s50, s50
    v_rcp_f16 v19, v18
    v_rcp_f16 v22, v21
    v_rcp_f16_sdwa v20, v18 dst_sel:DWORD dst_unused:UNUSED_PAD src0_sel:WORD_1
    v_mfma_f32_32x32x16_bf16 v[96:111], v[72:75], v[144:147], v[96:111]
    ds_read_b64_tr_b16 v[72:73], v15 offset:16384
    ds_read_b64_tr_b16 v[74:75], v15 offset:16640
    v_rcp_f16_sdwa v23, v21 dst_sel:DWORD dst_unused:UNUSED_PAD src0_sel:WORD_1
    v_fma_mix_f32 v19, v88, v19, 0 op_sel_hi:[0,1,0]
    v_fma_mix_f32 v22, v90, v22, 0 op_sel_hi:[0,1,0]
    v_fma_mix_f32 v20, v89, v20, 0 op_sel_hi:[0,1,0]
    v_fma_mix_f32 v23, v91, v23, 0 op_sel_hi:[0,1,0]
    v_cvt_pk_bf16_f32 v28, v19, v20
    v_cvt_pk_bf16_f32 v29, v22, v23
    v_cvt_pk_f16_f32 v18, v92, v93
    s_waitcnt lgkmcnt(6)
    s_nop 0
    v_mfma_f32_32x32x16_bf16 v[176:191], v[36:39], v[24:27], v[176:191]
    ds_read_b64_tr_b16 v[36:37], v10 offset:18496
    ds_read_b64_tr_b16 v[38:39], v10 offset:20032
    v_cvt_pk_f16_f32 v21, v94, v95
    v_pk_fma_f16 v19, v18, v18, s49
    v_pk_fma_f16 v22, v21, v21, s49
    v_pk_mul_f16 v18, v18, v19
    v_pk_mul_f16 v21, v21, v22
    v_exp_f16 v19, v18
    v_exp_f16 v22, v21
    v_exp_f16_sdwa v19, v18 dst_sel:WORD_1 dst_unused:UNUSED_PRESERVE src0_sel:WORD_1
    v_mfma_f32_32x32x16_bf16 v[96:111], v[76:79], v[152:155], v[96:111]
    ds_read_b64_tr_b16 v[76:77], v15 offset:17408
    ds_read_b64_tr_b16 v[78:79], v15 offset:17664
    v_exp_f16_sdwa v22, v21 dst_sel:WORD_1 dst_unused:UNUSED_PRESERVE src0_sel:WORD_1
    v_pk_fma_f16 v18, v19, s50, s50
    v_pk_fma_f16 v21, v22, s50, s50
    v_rcp_f16 v19, v18
    v_rcp_f16 v22, v21
    v_rcp_f16_sdwa v20, v18 dst_sel:DWORD dst_unused:UNUSED_PAD src0_sel:WORD_1
    v_mfma_f32_32x32x16_bf16 v[192:207], v[40:43], v[24:27], v[192:207]
    ds_read_b64_tr_b16 v[40:41], v10 offset:18560
    ds_read_b64_tr_b16 v[42:43], v10 offset:20096
    v_rcp_f16_sdwa v23, v21 dst_sel:DWORD dst_unused:UNUSED_PAD src0_sel:WORD_1
    v_fma_mix_f32 v19, v92, v19, 0 op_sel_hi:[0,1,0]
    v_fma_mix_f32 v22, v94, v22, 0 op_sel_hi:[0,1,0]
    v_fma_mix_f32 v20, v93, v20, 0 op_sel_hi:[0,1,0]
    v_fma_mix_f32 v23, v95, v23, 0 op_sel_hi:[0,1,0]
    v_cvt_pk_bf16_f32 v30, v19, v20
    v_cvt_pk_bf16_f32 v31, v22, v23
    v_cvt_pk_f16_f32 v18, v96, v97
    v_cvt_pk_f16_f32 v21, v98, v99
    v_mfma_f32_32x32x16_bf16 v[160:175], v[44:47], v[28:31], v[160:175]
    ds_read_b64_tr_b16 v[44:45], v10 offset:21504
    ds_read_b64_tr_b16 v[46:47], v10 offset:23040
    v_pk_fma_f16 v19, v18, v18, s49
    v_pk_fma_f16 v22, v21, v21, s49
    v_pk_mul_f16 v18, v18, v19
    v_pk_mul_f16 v21, v21, v22
    v_exp_f16 v19, v18
    v_exp_f16 v22, v21
    v_exp_f16_sdwa v19, v18 dst_sel:WORD_1 dst_unused:UNUSED_PRESERVE src0_sel:WORD_1
    v_mfma_f32_32x32x16_bf16 v[80:95], v[56:59], v[116:119], 0
    ds_read_b64_tr_b16 v[56:57], v9 offset:0
    s_waitcnt lgkmcnt(7)
    s_nop 0
    ds_read_b64_tr_b16 v[58:59], v9 offset:256
    v_exp_f16_sdwa v22, v21 dst_sel:WORD_1 dst_unused:UNUSED_PRESERVE src0_sel:WORD_1
    v_pk_fma_f16 v18, v19, s50, s50
    v_pk_fma_f16 v21, v22, s50, s50
    v_rcp_f16 v19, v18
    v_rcp_f16 v22, v21
    v_rcp_f16_sdwa v20, v18 dst_sel:DWORD dst_unused:UNUSED_PAD src0_sel:WORD_1
    v_mfma_f32_32x32x16_bf16 v[176:191], v[48:51], v[28:31], v[176:191]
    ds_read_b64_tr_b16 v[48:49], v10 offset:21568
    ds_read_b64_tr_b16 v[50:51], v10 offset:23104
    v_rcp_f16_sdwa v23, v21 dst_sel:DWORD dst_unused:UNUSED_PAD src0_sel:WORD_1
    v_fma_mix_f32 v19, v96, v19, 0 op_sel_hi:[0,1,0]
    v_fma_mix_f32 v22, v98, v22, 0 op_sel_hi:[0,1,0]
    v_fma_mix_f32 v20, v97, v20, 0 op_sel_hi:[0,1,0]
    v_fma_mix_f32 v23, v99, v23, 0 op_sel_hi:[0,1,0]
    v_cvt_pk_bf16_f32 v24, v19, v20
    v_cvt_pk_bf16_f32 v25, v22, v23
    v_cvt_pk_f16_f32 v18, v100, v101
    v_cvt_pk_f16_f32 v21, v102, v103
    v_mfma_f32_32x32x16_bf16 v[80:95], v[60:63], v[124:127], v[80:95]
    ds_read_b64_tr_b16 v[60:61], v9 offset:1024
    ds_read_b64_tr_b16 v[62:63], v9 offset:1280
    v_pk_fma_f16 v19, v18, v18, s49
    v_pk_fma_f16 v22, v21, v21, s49
    v_pk_mul_f16 v18, v18, v19
    v_pk_mul_f16 v21, v21, v22
    v_exp_f16 v19, v18
    v_exp_f16 v22, v21
    v_exp_f16_sdwa v19, v18 dst_sel:WORD_1 dst_unused:UNUSED_PRESERVE src0_sel:WORD_1
    v_mfma_f32_32x32x16_bf16 v[192:207], v[52:55], v[28:31], v[192:207]
    ds_read_b64_tr_b16 v[52:53], v10 offset:21632
    ds_read_b64_tr_b16 v[54:55], v10 offset:23168
    v_exp_f16_sdwa v22, v21 dst_sel:WORD_1 dst_unused:UNUSED_PRESERVE src0_sel:WORD_1
    v_pk_fma_f16 v18, v19, s50, s50
    v_pk_fma_f16 v21, v22, s50, s50
    v_rcp_f16 v19, v18
    v_rcp_f16 v22, v21
    v_rcp_f16_sdwa v20, v18 dst_sel:DWORD dst_unused:UNUSED_PAD src0_sel:WORD_1
    v_mfma_f32_32x32x16_bf16 v[80:95], v[64:67], v[132:135], v[80:95]
    ds_read_b64_tr_b16 v[64:65], v9 offset:2048
    s_waitcnt lgkmcnt(7)
    s_nop 0
    ds_read_b64_tr_b16 v[66:67], v9 offset:2304
    v_rcp_f16_sdwa v23, v21 dst_sel:DWORD dst_unused:UNUSED_PAD src0_sel:WORD_1
    v_fma_mix_f32 v19, v100, v19, 0 op_sel_hi:[0,1,0]
    v_fma_mix_f32 v22, v102, v22, 0 op_sel_hi:[0,1,0]
    v_fma_mix_f32 v20, v101, v20, 0 op_sel_hi:[0,1,0]
    v_fma_mix_f32 v23, v103, v23, 0 op_sel_hi:[0,1,0]
    v_cvt_pk_bf16_f32 v26, v19, v20
    v_cvt_pk_bf16_f32 v27, v22, v23
    v_cvt_pk_f16_f32 v18, v104, v105
    v_mfma_f32_32x32x16_bf16 v[80:95], v[68:71], v[140:143], v[80:95]
    ds_read_b64_tr_b16 v[68:69], v9 offset:3072
    ds_read_b64_tr_b16 v[70:71], v9 offset:3328
    v_cvt_pk_f16_f32 v21, v106, v107
    v_pk_fma_f16 v19, v18, v18, s49
    v_pk_fma_f16 v22, v21, v21, s49
    v_pk_mul_f16 v18, v18, v19
    v_pk_mul_f16 v21, v21, v22
    v_exp_f16 v19, v18
    v_exp_f16 v22, v21
    v_exp_f16_sdwa v19, v18 dst_sel:WORD_1 dst_unused:UNUSED_PRESERVE src0_sel:WORD_1
    v_mfma_f32_32x32x16_bf16 v[160:175], v[32:35], v[24:27], v[160:175]
    ds_read_b64_tr_b16 v[32:33], v10 offset:6144
    ds_read_b64_tr_b16 v[34:35], v10 offset:7680
    v_exp_f16_sdwa v22, v21 dst_sel:WORD_1 dst_unused:UNUSED_PRESERVE src0_sel:WORD_1
    v_pk_fma_f16 v18, v19, s50, s50
    v_pk_fma_f16 v21, v22, s50, s50
    v_rcp_f16 v19, v18
    v_rcp_f16 v22, v21
    v_rcp_f16_sdwa v20, v18 dst_sel:DWORD dst_unused:UNUSED_PAD src0_sel:WORD_1
    v_mfma_f32_32x32x16_bf16 v[80:95], v[72:75], v[148:151], v[80:95]
    ds_read_b64_tr_b16 v[72:73], v9 offset:4096
    ds_read_b64_tr_b16 v[74:75], v9 offset:4352
    v_rcp_f16_sdwa v23, v21 dst_sel:DWORD dst_unused:UNUSED_PAD src0_sel:WORD_1
    v_fma_mix_f32 v19, v104, v19, 0 op_sel_hi:[0,1,0]
    v_fma_mix_f32 v22, v106, v22, 0 op_sel_hi:[0,1,0]
    v_fma_mix_f32 v20, v105, v20, 0 op_sel_hi:[0,1,0]
    v_fma_mix_f32 v23, v107, v23, 0 op_sel_hi:[0,1,0]
    v_cvt_pk_bf16_f32 v28, v19, v20
    v_cvt_pk_bf16_f32 v29, v22, v23
    v_cvt_pk_f16_f32 v18, v108, v109
    v_mfma_f32_32x32x16_bf16 v[176:191], v[36:39], v[24:27], v[176:191]
    ds_read_b64_tr_b16 v[36:37], v10 offset:6208
    s_waitcnt lgkmcnt(7)
    s_nop 0
    ds_read_b64_tr_b16 v[38:39], v10 offset:7744
    v_cvt_pk_f16_f32 v21, v110, v111
    v_pk_fma_f16 v19, v18, v18, s49
    v_pk_fma_f16 v22, v21, v21, s49
    v_pk_mul_f16 v18, v18, v19
    v_pk_mul_f16 v21, v21, v22
    v_exp_f16 v19, v18
    v_exp_f16 v22, v21
    v_exp_f16_sdwa v19, v18 dst_sel:WORD_1 dst_unused:UNUSED_PRESERVE src0_sel:WORD_1
    v_mfma_f32_32x32x16_bf16 v[80:95], v[76:79], v[156:159], v[80:95]
    ds_read_b64_tr_b16 v[76:77], v9 offset:5120
    ds_read_b64_tr_b16 v[78:79], v9 offset:5376
    v_exp_f16_sdwa v22, v21 dst_sel:WORD_1 dst_unused:UNUSED_PRESERVE src0_sel:WORD_1
    v_pk_fma_f16 v18, v19, s50, s50
    v_pk_fma_f16 v21, v22, s50, s50
    v_rcp_f16 v19, v18
    v_rcp_f16 v22, v21
    v_rcp_f16_sdwa v20, v18 dst_sel:DWORD dst_unused:UNUSED_PAD src0_sel:WORD_1
    v_mfma_f32_32x32x16_bf16 v[192:207], v[40:43], v[24:27], v[192:207]
    ds_read_b64_tr_b16 v[40:41], v10 offset:6272
    ds_read_b64_tr_b16 v[42:43], v10 offset:7808
    v_rcp_f16_sdwa v23, v21 dst_sel:DWORD dst_unused:UNUSED_PAD src0_sel:WORD_1
    v_fma_mix_f32 v19, v108, v19, 0 op_sel_hi:[0,1,0]
    v_fma_mix_f32 v22, v110, v22, 0 op_sel_hi:[0,1,0]
    v_fma_mix_f32 v20, v109, v20, 0 op_sel_hi:[0,1,0]
    v_fma_mix_f32 v23, v111, v23, 0 op_sel_hi:[0,1,0]
    v_cvt_pk_bf16_f32 v30, v19, v20
    v_cvt_pk_bf16_f32 v31, v22, v23
    v_cvt_pk_f16_f32 v18, v80, v81
    v_cvt_pk_f16_f32 v21, v82, v83
    v_mfma_f32_32x32x16_bf16 v[160:175], v[44:47], v[28:31], v[160:175]
    ds_read_b64_tr_b16 v[44:45], v10 offset:9216
    ds_read_b64_tr_b16 v[46:47], v10 offset:10752
    v_pk_fma_f16 v19, v18, v18, s49
    v_pk_fma_f16 v22, v21, v21, s49
    v_pk_mul_f16 v18, v18, v19
    v_pk_mul_f16 v21, v21, v22
    v_exp_f16 v19, v18
    v_exp_f16 v22, v21
    v_exp_f16_sdwa v19, v18 dst_sel:WORD_1 dst_unused:UNUSED_PRESERVE src0_sel:WORD_1
    v_exp_f16_sdwa v22, v21 dst_sel:WORD_1 dst_unused:UNUSED_PRESERVE src0_sel:WORD_1
    v_pk_fma_f16 v18, v19, s50, s50
    v_pk_fma_f16 v21, v22, s50, s50
    v_rcp_f16_e64 v19, v18
    v_mfma_f32_32x32x16_bf16 v[176:191], v[48:51], v[28:31], v[176:191]
    ds_read_b64_tr_b16 v[48:49], v10 offset:9280
    s_waitcnt lgkmcnt(7)
    s_nop 0
    ds_read_b64_tr_b16 v[50:51], v10 offset:10816
    v_rcp_f16_e64 v22, v21
    v_rcp_f16_sdwa v20, v18 dst_sel:DWORD dst_unused:UNUSED_PAD src0_sel:WORD_1
    v_rcp_f16_sdwa v23, v21 dst_sel:DWORD dst_unused:UNUSED_PAD src0_sel:WORD_1
    v_fma_mix_f32 v19, v80, v19, 0 op_sel_hi:[0,1,0]
    v_fma_mix_f32 v22, v82, v22, 0 op_sel_hi:[0,1,0]
    v_fma_mix_f32 v20, v81, v20, 0 op_sel_hi:[0,1,0]
    v_fma_mix_f32 v23, v83, v23, 0 op_sel_hi:[0,1,0]
    v_cvt_pk_bf16_f32 v24, v19, v20
    v_cvt_pk_bf16_f32 v25, v22, v23
    v_cvt_pk_f16_f32 v18, v84, v85
    v_mfma_f32_32x32x16_bf16 v[192:207], v[52:55], v[28:31], v[192:207]
    ds_read_b64_tr_b16 v[52:53], v10 offset:9344
    ds_read_b64_tr_b16 v[54:55], v10 offset:10880
    v_cvt_pk_f16_f32 v21, v86, v87
    v_pk_fma_f16 v19, v18, v18, s49
    v_pk_fma_f16 v22, v21, v21, s49
    v_pk_mul_f16 v18, v18, v19
    v_pk_mul_f16 v21, v21, v22
    v_exp_f16_e64 v19, v18
    v_cvt_pk_bf16_f32 v112, v160, v161
    v_exp_f16_e64 v22, v21
    v_cvt_pk_bf16_f32 v113, v162, v163
    v_exp_f16_sdwa v19, v18 dst_sel:WORD_1 dst_unused:UNUSED_PRESERVE src0_sel:WORD_1
    v_cvt_pk_bf16_f32 v114, v164, v165
    v_exp_f16_sdwa v22, v21 dst_sel:WORD_1 dst_unused:UNUSED_PRESERVE src0_sel:WORD_1
    v_mfma_f32_32x32x16_bf16 v[96:111], v[56:59], v[116:119], 0
    v_cvt_pk_bf16_f32 v115, v166, v167
    v_pk_fma_f16 v18, v19, s50, s50
    v_cvt_pk_bf16_f32 v120, v168, v169
    v_pk_fma_f16 v21, v22, s50, s50
    v_rcp_f16_e64 v19, v18
    v_cvt_pk_bf16_f32 v121, v170, v171
    v_rcp_f16_e64 v22, v21
    v_cvt_pk_bf16_f32 v122, v172, v173
    v_rcp_f16_sdwa v20, v18 dst_sel:DWORD dst_unused:UNUSED_PAD src0_sel:WORD_1
    v_cvt_pk_bf16_f32 v123, v174, v175
    v_mfma_f32_32x32x16_bf16 v[96:111], v[60:63], v[124:127], v[96:111]
    v_rcp_f16_sdwa v23, v21 dst_sel:DWORD dst_unused:UNUSED_PAD src0_sel:WORD_1
    v_cvt_pk_bf16_f32 v128, v176, v177
    v_fma_mix_f32 v19, v84, v19, 0 op_sel_hi:[0,1,0]
    v_cvt_pk_bf16_f32 v129, v178, v179
    v_fma_mix_f32 v22, v86, v22, 0 op_sel_hi:[0,1,0]
    v_fma_mix_f32 v20, v85, v20, 0 op_sel_hi:[0,1,0]
    v_permlane16_swap_b32 v112, v120
    s_nop 0
    v_fma_mix_f32 v23, v87, v23, 0 op_sel_hi:[0,1,0]
    v_cvt_pk_bf16_f32 v26, v19, v20
    v_permlane16_swap_b32 v113, v121
    s_nop 0
    v_cvt_pk_bf16_f32 v27, v22, v23
    v_permlane16_swap_b32 v114, v122
    s_nop 0
    v_mfma_f32_32x32x16_bf16 v[96:111], v[64:67], v[132:135], v[96:111]
    v_cvt_pk_f16_f32 v18, v88, v89
    v_cvt_pk_f16_f32 v21, v90, v91
    v_permlane16_swap_b32 v115, v123
    s_nop 0
    v_pk_fma_f16 v19, v18, v18, s49
    v_pk_fma_f16 v22, v21, v21, s49
    buffer_store_dwordx4 v[112:115], v6, s[20:23], s51 offen offset:0 sc0 sc1
    v_pk_mul_f16 v18, v18, v19
    v_pk_mul_f16 v21, v21, v22
    buffer_store_dwordx4 v[120:123], v6, s[20:23], s51 offen offset:3072 sc0 sc1
    v_exp_f16_e64 v19, v18
    v_cvt_pk_bf16_f32 v130, v180, v181
    v_mfma_f32_32x32x16_bf16 v[96:111], v[68:71], v[140:143], v[96:111]
    v_exp_f16_e64 v22, v21
    v_cvt_pk_bf16_f32 v131, v182, v183
    v_exp_f16_sdwa v19, v18 dst_sel:WORD_1 dst_unused:UNUSED_PRESERVE src0_sel:WORD_1
    v_cvt_pk_bf16_f32 v136, v184, v185
    v_exp_f16_sdwa v22, v21 dst_sel:WORD_1 dst_unused:UNUSED_PRESERVE src0_sel:WORD_1
    v_cvt_pk_bf16_f32 v137, v186, v187
    v_pk_fma_f16 v18, v19, s50, s50
    v_cvt_pk_bf16_f32 v138, v188, v189
    v_pk_fma_f16 v21, v22, s50, s50
    v_rcp_f16_e64 v19, v18
    v_cvt_pk_bf16_f32 v139, v190, v191
    v_mfma_f32_32x32x16_bf16 v[208:223], v[32:35], v[24:27], v[208:223]
    ds_read_b64_tr_b16 v[32:33], v10 offset:18432
    ds_read_b64_tr_b16 v[34:35], v10 offset:19968
    v_rcp_f16_e64 v22, v21
    v_cvt_pk_bf16_f32 v144, v192, v193
    v_rcp_f16_sdwa v20, v18 dst_sel:DWORD dst_unused:UNUSED_PAD src0_sel:WORD_1
    v_cvt_pk_bf16_f32 v145, v194, v195
    v_rcp_f16_sdwa v23, v21 dst_sel:DWORD dst_unused:UNUSED_PAD src0_sel:WORD_1
    v_permlane16_swap_b32 v128, v136
    s_nop 0
    v_fma_mix_f32 v19, v88, v19, 0 op_sel_hi:[0,1,0]
    v_permlane16_swap_b32 v129, v137
    s_nop 0
    v_fma_mix_f32 v22, v90, v22, 0 op_sel_hi:[0,1,0]
    v_mfma_f32_32x32x16_bf16 v[96:111], v[72:75], v[148:151], v[96:111]
    v_fma_mix_f32 v20, v89, v20, 0 op_sel_hi:[0,1,0]
    v_permlane16_swap_b32 v130, v138
    s_nop 0
    v_fma_mix_f32 v23, v91, v23, 0 op_sel_hi:[0,1,0]
    v_cvt_pk_bf16_f32 v28, v19, v20
    v_permlane16_swap_b32 v131, v139
    s_nop 0
    v_cvt_pk_bf16_f32 v29, v22, v23
    buffer_store_dwordx4 v[128:131], v6, s[20:23], s51 offen offset:64 sc0 sc1
    v_cvt_pk_f16_f32 v18, v92, v93
    v_cvt_pk_f16_f32 v21, v94, v95
    buffer_store_dwordx4 v[136:139], v6, s[20:23], s51 offen offset:3136 sc0 sc1
    v_pk_fma_f16 v19, v18, v18, s49
    v_pk_fma_f16 v22, v21, v21, s49
    v_cvt_pk_bf16_f32 v146, v196, v197
    v_mfma_f32_32x32x16_bf16 v[224:239], v[36:39], v[24:27], v[224:239]
    ds_read_b64_tr_b16 v[36:37], v10 offset:18496
    ds_read_b64_tr_b16 v[38:39], v10 offset:20032
    v_pk_mul_f16 v18, v18, v19
    v_pk_mul_f16 v21, v21, v22
    v_cvt_pk_bf16_f32 v147, v198, v199
    v_exp_f16_e64 v19, v18
    v_cvt_pk_bf16_f32 v152, v200, v201
    v_exp_f16_e64 v22, v21
    v_cvt_pk_bf16_f32 v153, v202, v203
    v_exp_f16_sdwa v19, v18 dst_sel:WORD_1 dst_unused:UNUSED_PRESERVE src0_sel:WORD_1
    v_cvt_pk_bf16_f32 v154, v204, v205
    v_exp_f16_sdwa v22, v21 dst_sel:WORD_1 dst_unused:UNUSED_PRESERVE src0_sel:WORD_1
    s_waitcnt lgkmcnt(3)
    s_nop 0
    v_mfma_f32_32x32x16_bf16 v[96:111], v[76:79], v[156:159], v[96:111]
    v_cvt_pk_bf16_f32 v155, v206, v207
    v_pk_fma_f16 v18, v19, s50, s50
    v_mov_b32_e64 v15, 0
    v_pk_fma_f16 v21, v22, s50, s50
    v_rcp_f16 v19, v18
    v_mov_b32 v15, 0
    v_rcp_f16 v22, v21
    v_permlane16_swap_b32 v144, v152
    v_rcp_f16_sdwa v20, v18 dst_sel:DWORD dst_unused:UNUSED_PAD src0_sel:WORD_1
    v_permlane16_swap_b32 v145, v153
    s_nop 0
    v_mfma_f32_32x32x16_bf16 v[240:255], v[40:43], v[24:27], v[240:255]
    ds_read_b64_tr_b16 v[40:41], v10 offset:18560
    ds_read_b64_tr_b16 v[42:43], v10 offset:20096
    v_rcp_f16_sdwa v23, v21 dst_sel:DWORD dst_unused:UNUSED_PAD src0_sel:WORD_1
    v_permlane16_swap_b32 v146, v154
    s_nop 0
    v_fma_mix_f32 v19, v92, v19, 0 op_sel_hi:[0,1,0]
    v_permlane16_swap_b32 v147, v155
    s_nop 0
    v_fma_mix_f32 v22, v94, v22, 0 op_sel_hi:[0,1,0]
    v_fma_mix_f32 v20, v93, v20, 0 op_sel_hi:[0,1,0]
    buffer_store_dwordx4 v[144:147], v6, s[20:23], s51 offen offset:128 sc0 sc1
    v_fma_mix_f32 v23, v95, v23, 0 op_sel_hi:[0,1,0]
    v_cvt_pk_bf16_f32 v30, v19, v20
    buffer_store_dwordx4 v[152:155], v6, s[20:23], s51 offen offset:3200 sc0 sc1
    v_cvt_pk_bf16_f32 v31, v22, v23
    v_cvt_pk_f16_f32 v18, v96, v97
    v_cvt_pk_f16_f32 v21, v98, v99
    v_mfma_f32_32x32x16_bf16 v[208:223], v[44:47], v[28:31], v[208:223]
    ds_read_b64_tr_b16 v[44:45], v10 offset:21504
    ds_read_b64_tr_b16 v[46:47], v10 offset:23040
    v_pk_fma_f16 v19, v18, v18, s49
    v_pk_fma_f16 v22, v21, v21, s49
    v_pk_mul_f16 v18, v18, v19
    v_pk_mul_f16 v21, v21, v22
    v_exp_f16 v19, v18
    v_exp_f16 v22, v21
    v_exp_f16_sdwa v19, v18 dst_sel:WORD_1 dst_unused:UNUSED_PRESERVE src0_sel:WORD_1
    v_mfma_f32_32x32x16_bf16 v[224:239], v[48:51], v[28:31], v[224:239]
    ds_read_b64_tr_b16 v[48:49], v10 offset:21568
    ds_read_b64_tr_b16 v[50:51], v10 offset:23104
    v_exp_f16_sdwa v22, v21 dst_sel:WORD_1 dst_unused:UNUSED_PRESERVE src0_sel:WORD_1
    v_pk_fma_f16 v18, v19, s50, s50
    v_pk_fma_f16 v21, v22, s50, s50
    v_rcp_f16 v19, v18
    v_rcp_f16 v22, v21
    v_rcp_f16_sdwa v20, v18 dst_sel:DWORD dst_unused:UNUSED_PAD src0_sel:WORD_1
    v_mfma_f32_32x32x16_bf16 v[240:255], v[52:55], v[28:31], v[240:255]
    ds_read_b64_tr_b16 v[52:53], v10 offset:21632
    ds_read_b64_tr_b16 v[54:55], v10 offset:23168
    v_rcp_f16_sdwa v23, v21 dst_sel:DWORD dst_unused:UNUSED_PAD src0_sel:WORD_1
    v_fma_mix_f32 v19, v96, v19, 0 op_sel_hi:[0,1,0]
    v_fma_mix_f32 v22, v98, v22, 0 op_sel_hi:[0,1,0]
    v_fma_mix_f32 v20, v97, v20, 0 op_sel_hi:[0,1,0]
    v_fma_mix_f32 v23, v99, v23, 0 op_sel_hi:[0,1,0]
    v_cvt_pk_bf16_f32 v24, v19, v20
    v_cvt_pk_bf16_f32 v25, v22, v23
    v_cvt_pk_f16_f32 v18, v100, v101
    v_cvt_pk_f16_f32 v21, v102, v103
    v_pk_fma_f16 v19, v18, v18, s49
    v_pk_fma_f16 v22, v21, v21, s49
    v_pk_mul_f16 v18, v18, v19
    v_pk_mul_f16 v21, v21, v22
    v_exp_f16 v19, v18
    v_exp_f16 v22, v21
    v_exp_f16_sdwa v19, v18 dst_sel:WORD_1 dst_unused:UNUSED_PRESERVE src0_sel:WORD_1
    v_exp_f16_sdwa v22, v21 dst_sel:WORD_1 dst_unused:UNUSED_PRESERVE src0_sel:WORD_1
    v_pk_fma_f16 v18, v19, s50, s50
    v_pk_fma_f16 v21, v22, s50, s50
    v_rcp_f16 v19, v18
    v_rcp_f16 v22, v21
    v_rcp_f16_sdwa v20, v18 dst_sel:DWORD dst_unused:UNUSED_PAD src0_sel:WORD_1
    v_rcp_f16_sdwa v23, v21 dst_sel:DWORD dst_unused:UNUSED_PAD src0_sel:WORD_1
    v_fma_mix_f32 v19, v100, v19, 0 op_sel_hi:[0,1,0]
    v_fma_mix_f32 v22, v102, v22, 0 op_sel_hi:[0,1,0]
    v_fma_mix_f32 v20, v101, v20, 0 op_sel_hi:[0,1,0]
    v_fma_mix_f32 v23, v103, v23, 0 op_sel_hi:[0,1,0]
    v_cvt_pk_bf16_f32 v26, v19, v20
    v_cvt_pk_bf16_f32 v27, v22, v23
    v_cvt_pk_f16_f32 v18, v104, v105
    v_cvt_pk_f16_f32 v21, v106, v107
    v_pk_fma_f16 v19, v18, v18, s49
    v_pk_fma_f16 v22, v21, v21, s49
    v_pk_mul_f16 v18, v18, v19
    v_pk_mul_f16 v21, v21, v22
    v_exp_f16 v19, v18
    v_exp_f16 v22, v21
    v_exp_f16_sdwa v19, v18 dst_sel:WORD_1 dst_unused:UNUSED_PRESERVE src0_sel:WORD_1
    s_waitcnt lgkmcnt(0)
    s_nop 0
    v_mfma_f32_32x32x16_bf16 v[208:223], v[32:35], v[24:27], v[208:223]
    v_exp_f16_sdwa v22, v21 dst_sel:WORD_1 dst_unused:UNUSED_PRESERVE src0_sel:WORD_1
    v_pk_fma_f16 v18, v19, s50, s50
    v_pk_fma_f16 v21, v22, s50, s50
    v_rcp_f16 v19, v18
    v_rcp_f16 v22, v21
    v_rcp_f16_sdwa v20, v18 dst_sel:DWORD dst_unused:UNUSED_PAD src0_sel:WORD_1
    v_rcp_f16_sdwa v23, v21 dst_sel:DWORD dst_unused:UNUSED_PAD src0_sel:WORD_1
    v_fma_mix_f32 v19, v104, v19, 0 op_sel_hi:[0,1,0]
    v_fma_mix_f32 v22, v106, v22, 0 op_sel_hi:[0,1,0]
    v_fma_mix_f32 v20, v105, v20, 0 op_sel_hi:[0,1,0]
    v_fma_mix_f32 v23, v107, v23, 0 op_sel_hi:[0,1,0]
    v_cvt_pk_bf16_f32 v28, v19, v20
    v_cvt_pk_bf16_f32 v29, v22, v23
    v_cvt_pk_f16_f32 v18, v108, v109
    v_mfma_f32_32x32x16_bf16 v[224:239], v[36:39], v[24:27], v[224:239]
    v_cvt_pk_f16_f32 v21, v110, v111
    v_pk_fma_f16 v19, v18, v18, s49
    v_pk_fma_f16 v22, v21, v21, s49
    v_pk_mul_f16 v18, v18, v19
    v_pk_mul_f16 v21, v21, v22
    v_exp_f16 v19, v18
    v_exp_f16 v22, v21
    v_exp_f16_sdwa v19, v18 dst_sel:WORD_1 dst_unused:UNUSED_PRESERVE src0_sel:WORD_1
    v_exp_f16_sdwa v22, v21 dst_sel:WORD_1 dst_unused:UNUSED_PRESERVE src0_sel:WORD_1
    v_pk_fma_f16 v18, v19, s50, s50
    v_pk_fma_f16 v21, v22, s50, s50
    v_rcp_f16 v19, v18
    v_rcp_f16 v22, v21
    v_rcp_f16_sdwa v20, v18 dst_sel:DWORD dst_unused:UNUSED_PAD src0_sel:WORD_1
    v_mfma_f32_32x32x16_bf16 v[240:255], v[40:43], v[24:27], v[240:255]
    v_rcp_f16_sdwa v23, v21 dst_sel:DWORD dst_unused:UNUSED_PAD src0_sel:WORD_1
    v_fma_mix_f32 v19, v108, v19, 0 op_sel_hi:[0,1,0]
    v_fma_mix_f32 v22, v110, v22, 0 op_sel_hi:[0,1,0]
    v_fma_mix_f32 v20, v109, v20, 0 op_sel_hi:[0,1,0]
    v_fma_mix_f32 v23, v111, v23, 0 op_sel_hi:[0,1,0]
    v_cvt_pk_bf16_f32 v30, v19, v20
    v_cvt_pk_bf16_f32 v31, v22, v23
    v_mov_b32 v15, 0
    v_mov_b32 v15, 0
    v_mfma_f32_32x32x16_bf16 v[208:223], v[44:47], v[28:31], v[208:223]
    v_mfma_f32_32x32x16_bf16 v[224:239], v[48:51], v[28:31], v[224:239]
    v_mfma_f32_32x32x16_bf16 v[240:255], v[52:55], v[28:31], v[240:255]
    s_nop 9
    s_nop 0
    v_cvt_pk_bf16_f32 v136, v208, v209
    v_cvt_pk_bf16_f32 v137, v210, v211
    v_cvt_pk_bf16_f32 v138, v212, v213
    v_cvt_pk_bf16_f32 v139, v214, v215
    v_cvt_pk_bf16_f32 v140, v216, v217
    v_cvt_pk_bf16_f32 v141, v218, v219
    v_cvt_pk_bf16_f32 v142, v220, v221
    v_cvt_pk_bf16_f32 v143, v222, v223
    v_cvt_pk_bf16_f32 v144, v224, v225
    v_cvt_pk_bf16_f32 v145, v226, v227
    v_permlane16_swap_b32 v136, v140
    v_permlane16_swap_b32 v137, v141
    v_permlane16_swap_b32 v138, v142
    v_permlane16_swap_b32 v139, v143
    buffer_store_dwordx4 v[136:139], v6, s[20:23], s52 offen offset:0 sc0 sc1
    buffer_store_dwordx4 v[140:143], v6, s[20:23], s52 offen offset:3072 sc0 sc1
    v_cvt_pk_bf16_f32 v146, v228, v229
    v_cvt_pk_bf16_f32 v147, v230, v231
    v_cvt_pk_bf16_f32 v148, v232, v233
    v_cvt_pk_bf16_f32 v149, v234, v235
    v_cvt_pk_bf16_f32 v150, v236, v237
    v_cvt_pk_bf16_f32 v151, v238, v239
    v_cvt_pk_bf16_f32 v152, v240, v241
    v_cvt_pk_bf16_f32 v153, v242, v243
    v_permlane16_swap_b32 v144, v148
    v_permlane16_swap_b32 v145, v149
    v_permlane16_swap_b32 v146, v150
    v_permlane16_swap_b32 v147, v151
    buffer_store_dwordx4 v[144:147], v6, s[20:23], s52 offen offset:64 sc0 sc1
    buffer_store_dwordx4 v[148:151], v6, s[20:23], s52 offen offset:3136 sc0 sc1
    v_cvt_pk_bf16_f32 v154, v244, v245
    v_cvt_pk_bf16_f32 v155, v246, v247
    v_cvt_pk_bf16_f32 v156, v248, v249
    v_cvt_pk_bf16_f32 v157, v250, v251
    v_cvt_pk_bf16_f32 v158, v252, v253
    v_cvt_pk_bf16_f32 v159, v254, v255
    v_mov_b32 v15, 0
    v_mov_b32 v15, 0
    v_permlane16_swap_b32 v152, v156
    v_permlane16_swap_b32 v153, v157
    v_permlane16_swap_b32 v154, v158
    v_permlane16_swap_b32 v155, v159
    buffer_store_dwordx4 v[152:155], v6, s[20:23], s52 offen offset:128 sc0 sc1
    buffer_store_dwordx4 v[156:159], v6, s[20:23], s52 offen offset:3200 sc0 sc1
Lfin:
Lend:
    s_endpgm
.section .rodata,"a"
.p2align 6
.amdhsa_kernel standalone__modern_conv_block_replknet__vision_kernel
  .amdhsa_next_free_vgpr 256
  .amdhsa_next_free_sgpr 96
  .amdhsa_accum_offset 256
  .amdhsa_group_segment_fixed_size 0
  .amdhsa_kernarg_size 64
  .amdhsa_user_sgpr_count 2
  .amdhsa_user_sgpr_kernarg_segment_ptr 1
  .amdhsa_system_sgpr_workgroup_id_x 1
.end_amdhsa_kernel
```
